```python
import torch

def _softmax(x, axis=-1):
    return torch.softmax(x, dim=axis)
def _gelu(x):
    return torch.nn.functional.gelu(x, approximate="tanh")
def _silu(x):
    return torch.nn.functional.silu(x)
def _sigmoid(x):
    return torch.sigmoid(x)
def _layernorm(x, axis=-1, eps=1e-5):
    m = x.mean(dim=axis, keepdim=True)
    v = x.var(dim=axis, keepdim=True, unbiased=False)
    return (x - m) / torch.sqrt(v + eps)
def _scatter_add(tgt, idx, src, axis=0):
    return tgt.clone().index_add_(axis, idx, src)
def _segment_sum(src, seg, n):
    out = torch.zeros((n,) + src.shape[1:], dtype=src.dtype)
    return out.index_add_(0, seg, src)
def _pad(x, pw):
    flat = tuple(v for pair in reversed(pw) for v in pair)
    return torch.nn.functional.pad(x, flat)

kernel_name = 'parallel_sum__sliding_local_dilated__swiglu_ffn__prompt'

def setup_inputs():

    _w = (lambda a: (lambda t: t.to(torch.bfloat16) if t.is_floating_point() else t)(torch.as_tensor(a)))
    def _A_setup():
        B, S, D = 1, 2048, 448
        return {
            "x": _w((lambda *s: torch.randn(*s, dtype=torch.bfloat16) * 0.05)(B, S, D)),
            "wqkv": _w((lambda *s: torch.randn(*s, dtype=torch.bfloat16) * 0.05)(D, 3 * D)),
            "wo": _w((lambda *s: torch.randn(*s, dtype=torch.bfloat16) * 0.05)(D, D)),
        }
    _A_in = _A_setup()

    def _B_setup():
        B, S, D, F = 1, 2048, 448, 1792
        return {
            "x": _w((lambda *s: torch.randn(*s, dtype=torch.bfloat16) * 0.05)(B, S, D)),
            "w_gate": _w((lambda *s: torch.randn(*s, dtype=torch.bfloat16) * 0.05)(D, F)),
            "w_up": _w((lambda *s: torch.randn(*s, dtype=torch.bfloat16) * 0.05)(D, F)),
            "w_down": _w((lambda *s: torch.randn(*s, dtype=torch.bfloat16) * 0.05)(F, D)),
        }
    _B_in = _B_setup()

    return {
        "A_x": _A_in["x"],
        "A_wqkv": _A_in["wqkv"],
        "A_wo": _A_in["wo"],
        "B_x": _B_in["x"],
        "B_w_gate": _B_in["w_gate"],
        "B_w_up": _B_in["w_up"],
        "B_w_down": _B_in["w_down"],
    }

def reference(A_x, A_wqkv, A_wo, B_x, B_w_gate, B_w_up, B_w_down):
    def _A_ref(x, wqkv, wo):
        B, S, D = x.shape
        H = 16; Dh = D // H
        W, dil = 8, 2
        qkv = (lambda x, *d: x.permute(*d))((x @ wqkv).reshape(B, S, 3, H, Dh), 2, 0, 3, 1, 4)
        q, k, v = qkv[0], qkv[1], qkv[2]
        scale = Dh ** -0.5
        pos = torch.arange(S)
        off = torch.arange(W) * dil
        idx = pos[:, None] - off[None, :]
        mask = idx >= 0
        idx_c = torch.where(mask, idx, 0).reshape(-1)
        kg = k[:, :, idx_c, :].reshape(B, H, S, W, Dh)
        vg = v[:, :, idx_c, :].reshape(B, H, S, W, Dh)
        logits = torch.einsum("bhsd,bhswd->bhsw", q, kg) * scale
        logits = torch.where(mask[None, None, :, :], logits, -1e9)
        attn = _softmax(logits, axis=-1)
        o = torch.einsum("bhsw,bhswd->bhsd", attn, vg)
        return (lambda x, *d: x.permute(*d))(o, 0, 2, 1, 3).reshape(B, S, D) @ wo

    def _B_ref(x, w_gate, w_up, w_down):
        g = _silu(x @ w_gate)
        u = x @ w_up
        return (g * u) @ w_down

    x = A_x
    xn = _layernorm(x, axis=-1)
    return x + _A_ref(xn, A_wqkv, A_wo) + _B_ref(xn, B_w_gate, B_w_up, B_w_down)
```

```asm
; @launch grid=(256,1,1) block=(256,1,1) lds=163840
.amdgcn_target "amdgcn-amd-amdhsa--gfx950"
.text
.globl parallel_sum__sliding_local_dilated__swiglu_ffn__prompt_kernel
.type parallel_sum__sliding_local_dilated__swiglu_ffn__prompt_kernel,@function
.p2align 10
.fill 64, 4, 0xbf810000
.p2align 8
parallel_sum__sliding_local_dilated__swiglu_ffn__prompt_kernel:
    s_cmpk_ge_u32 s2, 256
    s_cbranch_scc1 L_done
    s_load_dwordx16 s[4:19], s[0:1], 0
    s_load_dwordx4 s[20:23], s[0:1], 64
    s_getpc_b64 s[76:77]
    v_lshrrev_b32 v1, 6, v0
    v_and_b32 v0, 63, v0
    s_lshr_b32 s61, s2, 3
    s_mul_i32 s62, s61, 11
    v_min_u32 v54, 10, v0
    v_readfirstlane_b32 s60, v1
    v_add_lshl_u32 v54, v54, s62, 7
    global_load_dword v37, v54, s[76:77] offset:896
    s_bfe_u32 s64, s2, 0x10002
    s_lshl_b32 s64, s64, 5
    s_add_u32 s64, s64, s61
    s_and_b32 s71, s2, 3
    s_lshl2_add_u32 s71, s64, s71
    s_andn2_b32 s64, s71, 1
    s_lshl1_add_u32 s64, s64, s60
    s_and_b32 s67, s2, 1
    s_lshl2_add_u32 s70, s64, s67
    s_mulk_i32 s70, 896
    v_lshrrev_b32 v46, 5, v0
    v_and_b32 v47, 31, v0
    v_mul_u32_u24 v48, 1792, v46
    v_cmp_gt_u32 vcc, 28, v47
    v_lshl_add_u32 v48, v47, 4, v48
    v_mov_b32 v49, 2147483632
    v_cndmask_b32 v48, v49, v48, vcc
    s_mov_b32 s26, 1835008
    s_mov_b32 s27, 0x20000
    s_and_b32 s68, s60, 1
    s_lshr_b32 s69, s60, 1
    s_lshl_b32 s63, s68, 2
    v_lshrrev_b32 v54, 3, v0
    v_and_b32 v1, 7, v0
    v_lshrrev_b32 v55, 4, v0
    v_mul_u32_u24 v54, 112, v54
    v_xor_b32 v1, s63, v1
    s_bfe_u32 s62, s2, 0x10002
    s_and_b32 s57, s2, 3
    v_xor_b32 v1, v1, v55
    s_cmp_eq_u32 s57, 3
    s_cselect_b32 s63, 28, 21
    s_cmp_lt_u32 s61, s63
    v_add_lshl_u32 v54, v54, v1, 4
    s_cbranch_scc1 L_ffn
    s_sub_u32 s61, s61, s63
    s_lshl_b32 s63, s57, 3
    s_lshr_b32 s63, 0x160b1900, s63
    s_and_b32 s63, s63, 31
    s_add_u32 s78, s61, s63
    s_or_b32 s61, s2, 4
    s_cmpk_eq_u32 s61, 255
    s_cbranch_scc1 L_idle0
    s_mul_i32 s57, s78, 57
    s_lshr_b32 s57, s57, 9
    s_sub_u32 s61, s62, s57
    s_mul_i32 s61, s61, 9
    s_add_u32 s56, s78, s61
    s_xor_b32 s57, s57, 1
    s_mul_i32 s75, s56, 9363
    s_lshr_b32 s75, s75, 16
    s_mul_i32 s75, s75, 7
    s_sub_u32 s74, s56, s75
    s_mul_i32 s75, s74, 172032
    s_mulk_i32 s74, 128
    v_lshl_add_u32 v56, v55, 1, s69
    v_lshlrev_b32 v56, 1, v56
    v_sub_u32 v57, v0, v56
    v_and_b32 v57, 15, v57
    v_cmp_gt_u32 vcc, 14, v57
    s_mul_i32 s61, s60, 48
    s_add_u32 s61, s61, s57
    s_mulk_i32 s61, 224
    v_mul_u32_u24 v58, 168, v55
    v_add_lshl_u32 v58, v57, v58, 4
    v_add_u32 v6, s61, v58
    v_cndmask_b32 v6, v49, v6, vcc
    v_add_u32 v5, 128, v6
    v_add_u32 v4, 256, v6
    s_mul_i32 s66, s60, 6144
    s_add_u32 s66, s66, 49920
    s_mov_b32 s30, 1204480
    s_mov_b32 s31, s27
    s_waitcnt lgkmcnt(0)
    s_mov_b64 s[24:25], s[4:5]
    buffer_load_dwordx4 v[38:41], v48, s[24:27], s70 offen
    buffer_load_dwordx4 v[42:45], v48, s[24:27], s70 offen offset:448
    s_sub_u32 s28, s6, 256
    s_subb_u32 s29, s7, 0
    s_branch L_attn
L_idle0:
    v_mov_b32 v4, 0
    v_mov_b32 v5, 0
    v_mov_b32 v6, 0
    v_mov_b32 v7, 0
    s_lshl_b32 s61, s60, 12
    s_add_u32 s61, s61, 9674752
    v_lshl_add_u32 v2, v0, 4, s61
    s_cmp_lg_u32 s62, 0
    s_waitcnt lgkmcnt(0)
    s_cbranch_scc1 L_idle1
    global_store_dwordx4 v2, v[4:7], s[22:23] offset:0 sc1
    global_store_dwordx4 v2, v[4:7], s[22:23] offset:1024 sc1
    global_store_dwordx4 v2, v[4:7], s[22:23] offset:2048 sc1
    global_store_dwordx4 v2, v[4:7], s[22:23] offset:3072 sc1
    s_branch L_idle
L_ffn:
    s_mul_i32 s63, s57, 21
    s_add_u32 s61, s61, s63
    s_mul_i32 s58, s62, 91
    s_add_u32 s58, s58, s61
    s_cmp_ge_u32 s61, 49
    s_cselect_b32 s64, 7, 0
    s_cselect_b32 s56, 43, 37
    s_cselect_b32 s63, 6, 7
    s_sub_u32 s61, s61, s64
    s_mul_i32 s57, s61, s56
    s_lshr_b32 s57, s57, 8
    s_mul_i32 s63, s63, s57
    s_sub_u32 s56, s61, s63
    s_sub_u32 s63, 12, s56
    s_sub_u32 s64, 13, s57
    s_cmp_eq_u32 s62, 0
    s_cselect_b32 s56, s56, s63
    s_cselect_b32 s57, s57, s64
    s_mul_i32 s75, s62, 688128
    s_mul_i32 s74, s62, 384
    v_and_b32 v57, 15, v0
    v_lshl_add_u32 v56, v55, 1, s69
    v_lshlrev_b32 v56, 1, v56
    v_xor_b32 v57, v57, v56
    s_mul_i32 s61, s60, 56
    s_add_u32 s61, s61, s57
    s_lshl_b32 s61, s61, 8
    v_mul_u32_u24 v58, 224, v55
    v_add_lshl_u32 v58, v57, v58, 4
    v_add_u32 v27, s61, v58
    s_mul_i32 s63, s56, 158
    s_lshl4_add_u32 s63, s69, s63
    s_add_u32 s63, s63, s68
    s_mulk_i32 s63, 896
    v_add_u32 v22, s63, v54
    v_add_u32 v23, 27648, v22
    v_add_u32 v24, 55296, v22
    v_add_u32 v25, 82944, v22
    v_add_u32 v26, 114688, v22
    s_mul_i32 s65, s60, 5120
    s_lshl_b32 s66, s60, 12
    s_add_u32 s66, s66, 62208
    s_mov_b32 s30, 1605632
    s_mov_b32 s31, s27
    s_mov_b32 s34, 1606656
    s_mov_b32 s35, s27
    s_waitcnt lgkmcnt(0)
    s_mov_b64 s[24:25], s[4:5]
    buffer_load_dwordx4 v[38:41], v48, s[24:27], s70 offen
    buffer_load_dwordx4 v[42:45], v48, s[24:27], s70 offen offset:448
    s_mov_b64 s[28:29], s[12:13]
    s_sub_u32 s32, s14, 1024
    s_subb_u32 s33, s15, 0
    s_add_u32 m0, s66, 0
    s_add_u32 s67, s75, 0
    buffer_load_dwordx4 v27, s[28:31], s67 offen offset:0 lds
    buffer_load_dwordx4 v27, s[32:35], s67 offen offset:1024 lds
    s_add_u32 s67, s75, 55296
    buffer_load_dwordx4 v27, s[28:31], s67 offen offset:2048 lds
    buffer_load_dwordx4 v27, s[32:35], s67 offen offset:3072 lds
    s_add_u32 m0, s65, 0
    s_nop 0
    buffer_load_dwordx4 v22, s[24:27], s74 offen offset:0 lds
    buffer_load_dwordx4 v23, s[24:27], s74 offen offset:1024 lds
    buffer_load_dwordx4 v24, s[24:27], s74 offen offset:2048 lds
L_f7:
    v_and_b32_e64 v56, 7, v0
    v_bfe_u32 v57, v0, 3, 1
    v_lshrrev_b32_e64 v58, 4, v0
    v_bfe_u32 v59, v0, 1, 3
    v_xor_b32 v58, v58, v59
    v_lshlrev_b32 v58, 4, v58
    v_lshl_add_u32 v58, v56, 7, v58
    v_mul_u32_u24 v57, 5120, v57
    v_add_u32 v28, v57, v58
    v_xor_b32 v29, 64, v28
    v_and_b32 v57, 15, v0
    v_cmp_eq_u32 vcc, 15, v57
    v_mov_b32 v59, 0x100
    v_lshlrev_b32 v56, 4, v56
    v_cndmask_b32 v59, 0, v59, vcc
    v_add_u32 v30, v28, v59
    v_add_u32 v31, v29, v59
    v_mov_b32 v58, 0x3f803f80
    v_mov_b32 v59, 0x3f803f80
    v_mov_b32 v60, 0x3f803f80
    v_mov_b32 v61, 0x3f803f80
    ds_write_b128 v56, v[58:61] offset:20608
    ds_write_b128 v56, v[58:61] offset:41344
    ds_write_b128 v56, v[58:61] offset:62080
    v_bfe_u32 v62, v0, 4, 1
    v_bfe_u32 v63, v0, 2, 2
    v_lshrrev_b32 v64, 5, v0
    v_and_b32 v65, 3, v0
    v_lshl_add_u32 v66, v63, 1, v62
    s_lshl_b32 s61, s60, 1
    v_xor_b32_e64 v66, s61, v66
    v_lshlrev_b32 v66, 5, v66
    v_lshl_add_u32 v66, v65, 3, v66
    v_lshl_add_u32 v66, v63, 8, v66
    v_lshl_add_u32 v66, v64, 11, v66
    v_lshl_add_u32 v66, v62, 13, v66
    v_add_u32 v32, 62208, v66
    v_xor_b32_e64 v33, 32, v32
    buffer_load_dwordx4 v25, s[24:27], s74 offen offset:3072 lds
    s_add_u32 m0, s65, 4096
    s_nop 0
    buffer_load_dwordx4 v26, s[24:27], s74 offen offset:0 lds
    s_mov_b64 s[36:37], s[22:23]
    s_mov_b32 s38, 9699328
    s_mov_b32 s39, 0x20000
    s_mov_b64 s[52:53], s[20:21]
    s_mov_b32 s54, 256
    s_mov_b32 s55, 0x20000
    s_mov_b64 s[48:49], s[18:19]
    s_mov_b32 s50, 1835008
    s_mov_b32 s51, 0x20000
    s_mul_i32 s61, s60, 401408
    s_add_u32 s40, s16, s61
    s_addc_u32 s41, s17, 0
    s_mul_i32 s61, s60, 100352
    s_add_u32 s44, s8, s61
    s_addc_u32 s45, s9, 0
    s_mov_b32 s42, 401408
    s_mov_b32 s43, 0x20000
    s_mov_b32 s46, 100352
    s_mov_b32 s47, 0x20000
    s_mul_i32 s64, s58, 9363
    s_lshr_b32 s64, s64, 16
    s_mul_i32 s59, s64, 7
    s_sub_u32 s59, s58, s59
    s_mov_b32 s58, s64
    v_lshrrev_b32_e64 v62, 3, v0
    v_and_b32 v63, 7, v0
    v_lshlrev_b32 v64, 1, v55
    v_xor_b32 v63, v63, v64
    v_lshlrev_b32 v63, 4, v63
    v_mul_u32_u24 v62, 896, v62
    s_lshl_b32 s64, s59, 7
    v_add3_u32 v2, v62, v63, s64
    v_add_u32 v3, 6144, v2
    v_add_u32 v4, 12288, v2
    v_add_u32 v5, 18432, v2
    v_cmp_gt_u32 vcc, 32, v0
    v_bfe_u32 v62, v0, 2, 3
    v_lshrrev_b32_e64 v63, 5, v0
    v_cndmask_b32 v21, v49, v5, vcc
    v_and_b32 v64, 3, v0
    v_bfe_u32 v65, v0, 3, 2
    v_lshlrev_b32_e64 v62, 7, v62
    v_lshl_add_u32 v62, v63, 10, v62
    v_lshl_add_u32 v62, v64, 3, v62
    v_lshl_add_u32 v62, v65, 5, v62
    v_add_u32 v6, s65, v62
    v_add_u32 v10, s66, v62
    v_xor_b32 v7, 32, v6
    v_xor_b32 v11, 32, v10
    v_xor_b32 v8, 64, v6
    v_xor_b32 v12, 64, v10
    v_xor_b32 v9, 96, v6
    v_xor_b32 v13, 96, v10
    v_add_u32 v14, 0x10000, v10
    v_add_u32 v15, 0x10000, v11
    v_add_u32 v16, 0x10000, v12
    v_add_u32 v17, 0x10000, v13
    s_mov_b64 s[0:1], s[16:17]
    s_mov_b64 s[18:19], s[8:9]
    s_and_b32 s64, s2, 7
    s_mul_i32 s64, s64, 7
    s_lshr_b32 s64, s64, 2
    s_lshl_b32 s4, s64, 10
    s_add_u32 s5, s4, 1024
    s_cmp_eq_u32 s5, 14336
    s_cselect_b32 s5, 0, s5
    s_add_u32 s6, s5, 1024
    s_cmp_eq_u32 s6, 14336
    s_cselect_b32 s6, 0, s6
    s_add_u32 s7, s6, 1024
    s_cmp_eq_u32 s7, 14336
    s_cselect_b32 s7, 0, s7
    s_add_u32 s8, s7, 1024
    s_cmp_eq_u32 s8, 14336
    s_cselect_b32 s8, 0, s8
    s_add_u32 s9, s8, 1024
    s_cmp_eq_u32 s9, 14336
    s_cselect_b32 s9, 0, s9
    s_add_u32 s10, s9, 1024
    s_cmp_eq_u32 s10, 14336
    s_cselect_b32 s10, 0, s10
    s_add_u32 s11, s10, 1024
    s_cmp_eq_u32 s11, 14336
    s_cselect_b32 s11, 0, s11
    s_add_u32 s12, s11, 1024
    s_cmp_eq_u32 s12, 14336
    s_cselect_b32 s12, 0, s12
    s_add_u32 s13, s12, 1024
    s_cmp_eq_u32 s13, 14336
    s_cselect_b32 s13, 0, s13
    s_add_u32 s14, s13, 1024
    s_cmp_eq_u32 s14, 14336
    s_cselect_b32 s14, 0, s14
    s_add_u32 s15, s14, 1024
    s_cmp_eq_u32 s15, 14336
    s_cselect_b32 s15, 0, s15
    s_add_u32 s16, s15, 1024
    s_cmp_eq_u32 s16, 14336
    s_cselect_b32 s16, 0, s16
    s_add_u32 s17, s16, 1024
    s_cmp_eq_u32 s17, 14336
    s_cselect_b32 s17, 0, s17
    v_lshlrev_b32_e64 v18, 4, v0
    v_mov_b32 v20, 1
    s_mov_b32 s73, 1
    v_and_b32 v19, 7, v0
    v_bfe_u32 v62, v0, 3, 1
    v_lshlrev_b32_e64 v19, 2, v19
    v_lshl_add_u32 v19, v62, 10, v19
    v_add_u32 v19, 160512, v19
    s_lshl2_add_u32 s64, s57, s60
    s_mul_i32 s3, s64, 4682
    s_lshr_b32 s3, s3, 16
    s_lshl2_add_u32 s3, s56, s3
    s_lshl_b32 s3, s3, 7
    s_add_u32 s3, s3, 9633792
    s_add_u32 s82, s22, s3
    s_addc_u32 s83, s23, 0
    s_lshl_b32 s64, s64, 10
    s_mul_i32 s70, s56, 737280
    s_add_u32 s70, s70, s64
    s_lshr_b32 s64, s58, 1
    s_lshl2_add_u32 s76, s64, s60
    s_lshl_b32 s76, s76, 7
    s_add_u32 s76, s76, 9633792
    s_add_u32 s76, s22, s76
    s_addc_u32 s77, s23, 0
    s_mul_i32 s64, s64, 158
    s_add_u32 s78, s64, 143
    s_min_u32 s78, s78, 2033
    s_mul_i32 s78, s78, 580
    s_lshr_b32 s78, s78, 16
    s_max_u32 s64, s64, 14
    s_sub_u32 s64, s64, 14
    s_mul_i32 s64, s64, 580
    s_lshr_b32 s64, s64, 16
    s_sub_u32 s78, s78, s64
    s_lshl2_add_u32 s78, s78, 4
    s_mul_i32 s68, s58, 368640
    s_mul_i32 s64, s60, 14336
    s_add_u32 s68, s68, s64
    s_mul_i32 s64, s60, 10240
    s_sub_u32 s69, 57344, s64
    v_and_b32_e64 v48, 1, v0
    v_cmp_eq_u32 s[80:81], 1, v48
    v_lshlrev_b32_e64 v48, 5, v48
    v_lshl_add_u32 v48, v46, 2, v48
    v_bfe_u32 v47, v0, 4, 1
    v_lshlrev_b32 v47, 6, v47
    v_sub_u32 v48, v48, v47
    s_lshl3_add_u32 s61, s60, 163776
    v_cmp_eq_u32 vcc, 0, v0
    v_add_u32 v48, s61, v48
    v_mov_b32 v46, 0
    v_cndmask_b32 v1, v49, v46, vcc
    s_waitcnt vmcnt(9)
    v_lshlrev_b32 v52, 16, v38
    v_and_b32 v53, 0xffff0000, v38
    v_pk_add_f32 v[46:47], v[52:53], 0
    v_pk_mul_f32 v[50:51], v[52:53], v[52:53]
    v_lshlrev_b32_e64 v52, 16, v39
    v_and_b32 v53, 0xffff0000, v39
    v_pk_add_f32 v[46:47], v[46:47], v[52:53]
    v_pk_fma_f32 v[50:51], v[52:53], v[52:53], v[50:51]
    v_lshlrev_b32_e64 v52, 16, v40
    v_and_b32 v53, 0xffff0000, v40
    v_pk_add_f32 v[46:47], v[46:47], v[52:53]
    v_pk_fma_f32 v[50:51], v[52:53], v[52:53], v[50:51]
    v_lshlrev_b32_e64 v52, 16, v41
    v_and_b32 v53, 0xffff0000, v41
    v_pk_add_f32 v[46:47], v[46:47], v[52:53]
    v_pk_fma_f32 v[50:51], v[52:53], v[52:53], v[50:51]
    v_lshlrev_b32_e64 v52, 16, v42
    v_and_b32 v53, 0xffff0000, v42
    v_pk_add_f32 v[46:47], v[46:47], v[52:53]
    v_pk_fma_f32 v[50:51], v[52:53], v[52:53], v[50:51]
    v_lshlrev_b32_e64 v52, 16, v43
    v_and_b32 v53, 0xffff0000, v43
    v_pk_add_f32 v[46:47], v[46:47], v[52:53]
    v_pk_fma_f32 v[50:51], v[52:53], v[52:53], v[50:51]
    v_lshlrev_b32_e64 v52, 16, v44
    v_and_b32 v53, 0xffff0000, v44
    v_pk_add_f32 v[46:47], v[46:47], v[52:53]
    v_pk_fma_f32 v[50:51], v[52:53], v[52:53], v[50:51]
    v_lshlrev_b32_e64 v52, 16, v45
    v_and_b32 v53, 0xffff0000, v45
    v_pk_add_f32 v[46:47], v[46:47], v[52:53]
    v_pk_fma_f32 v[50:51], v[52:53], v[52:53], v[50:51]
    v_add_f32_e64 v51, v50, v51
    v_add_f32 v50, v46, v47
    s_nop 0
    v_add_f32_dpp v51, v51, v51 quad_perm:[1,0,3,2] row_mask:0xf bank_mask:0xf
    v_add_f32_dpp v50, v50, v50 quad_perm:[1,0,3,2] row_mask:0xf bank_mask:0xf
    s_nop 0
    v_add_f32_dpp v51, v51, v51 quad_perm:[2,3,0,1] row_mask:0xf bank_mask:0xf
    v_add_f32_dpp v50, v50, v50 quad_perm:[2,3,0,1] row_mask:0xf bank_mask:0xf
    s_nop 0
    v_add_f32_dpp v51, v51, v51 row_half_mirror row_mask:0xf bank_mask:0xf
    v_add_f32_dpp v50, v50, v50 row_half_mirror row_mask:0xf bank_mask:0xf
    s_nop 0
    v_add_f32_dpp v51, v51, v51 row_mirror row_mask:0xf bank_mask:0xf
    v_add_f32_dpp v50, v50, v50 row_mirror row_mask:0xf bank_mask:0xf
    s_nop 0
    v_add_f32_dpp v51, v51, v51 row_bcast:15 row_mask:0xa bank_mask:0xf
    v_add_f32_dpp v50, v50, v50 row_bcast:15 row_mask:0xa bank_mask:0xf
    v_mul_f32 v50, 0x3b124925, v50
    v_mul_f32 v51, 0x3b124925, v51
    v_fma_f32 v51, -v50, v50, v51
    v_max_f32_e64 v51, 0, v51
    v_cvt_pk_bf16_f32 v50, -v50, v51
    v_and_b32 v51, 0xffff0000, v50
    v_lshlrev_b32_e64 v50, 16, v50
    v_add_f32 v51, 0x3727c5ac, v51
    v_cvt_pk_bf16_f32 v51, v51, v51
    v_and_b32 v51, 0xffff0000, v51
    v_sqrt_f32 v51, v51
    s_nop 0
    v_cvt_pk_bf16_f32 v51, v51, v51
    v_and_b32 v51, 0xffff0000, v51
    v_rcp_f32 v51, v51
    s_nop 0
    v_cndmask_b32 v50, v50, v51, s[80:81]
    v_or_b32_e64 v50, 1, v50
    ds_write_b32 v48, v50
    s_add_u32 m0, s66, 16384
    s_add_u32 s67, s75, 114688
    buffer_load_dwordx4 v27, s[28:31], s67 offen offset:0 lds
    buffer_load_dwordx4 v27, s[32:35], s67 offen offset:1024 lds
    s_add_u32 s67, s75, 169984
    buffer_load_dwordx4 v27, s[28:31], s67 offen offset:2048 lds
    buffer_load_dwordx4 v27, s[32:35], s67 offen offset:3072 lds
    s_add_u32 s74, s74, 128
    s_cmp_eq_u32 s74, 896
    s_cselect_b32 s74, 0, s74
    s_add_u32 m0, s65, 20736
    s_nop 0
    buffer_load_dwordx4 v22, s[24:27], s74 offen offset:0 lds
    buffer_load_dwordx4 v23, s[24:27], s74 offen offset:1024 lds
    buffer_load_dwordx4 v24, s[24:27], s74 offen offset:2048 lds
    buffer_load_dwordx4 v25, s[24:27], s74 offen offset:3072 lds
    s_waitcnt vmcnt(8) lgkmcnt(0)
    s_barrier
    ds_read_b64_tr_b16 a[208:209], v32 offset:0
    ds_read_b64_tr_b16 a[210:211], v32 offset:4096
    ds_read_b64_tr_b16 a[212:213], v33 offset:0
    ds_read_b64_tr_b16 a[214:215], v33 offset:4096
    ds_read_b64_tr_b16 a[216:217], v32 offset:1024
    ds_read_b64_tr_b16 a[218:219], v32 offset:5120
    ds_read_b64_tr_b16 a[220:221], v33 offset:1024
    ds_read_b64_tr_b16 a[222:223], v33 offset:5120
    ds_read_b128 a[176:179], v28 offset:0
    ds_read_b128 a[184:187], v28 offset:1024
    ds_read_b128 a[192:195], v28 offset:2048
    s_waitcnt lgkmcnt(2)
    v_mfma_f32_16x16x32_bf16 v[96:99], a[208:211], a[176:179], 0
    s_add_u32 m0, s65, 24832
    ds_read_b128 a[200:203], v28 offset:3072
    v_mfma_f32_16x16x32_bf16 v[100:103], a[212:215], a[176:179], 0
    buffer_load_dwordx4 v26, s[24:27], s74 offen offset:0 lds
    v_mfma_f32_16x16x32_bf16 v[104:107], a[216:219], a[176:179], 0
    s_add_u32 m0, s66, 32768
    s_add_u32 s75, s75, 229376
    v_mfma_f32_16x16x32_bf16 v[108:111], a[220:223], a[176:179], 0
    v_and_b32_e64 v42, 3, v0
    s_waitcnt lgkmcnt(2)
    v_mfma_f32_16x16x32_bf16 v[140:143], a[220:223], a[184:187], 0
    s_cmp_eq_u32 s75, 1605632
    s_cselect_b32 s75, 0, s75
    v_mfma_f32_16x16x32_bf16 v[136:139], a[216:219], a[184:187], 0
    s_add_u32 s67, s75, 0
    ds_read_b128 a[176:179], v28 offset:4096
    v_mfma_f32_16x16x32_bf16 v[132:135], a[212:215], a[184:187], 0
    buffer_load_dwordx4 v27, s[28:31], s67 offen offset:0 lds
    v_mfma_f32_16x16x32_bf16 v[128:131], a[208:211], a[184:187], 0
    v_lshlrev_b32 v42, 4, v42
    s_waitcnt lgkmcnt(2)
    v_mfma_f32_16x16x32_bf16 v[160:163], a[208:211], a[192:195], 0
    buffer_load_dwordx4 v27, s[32:35], s67 offen offset:1024 lds
    v_mfma_f32_16x16x32_bf16 v[164:167], a[212:215], a[192:195], 0
    s_add_u32 s67, s75, 55296
    ds_read_b128 a[184:187], v30 offset:14336
    v_mfma_f32_16x16x32_bf16 v[168:171], a[216:219], a[192:195], 0
    v_add_u32 v42, 163712, v42
    ds_read_b128 v[38:41], v42
    v_mfma_f32_16x16x32_bf16 v[172:175], a[220:223], a[192:195], 0
    s_lshl_b32 s61, s71, 6
    s_waitcnt lgkmcnt(3)
    v_mfma_f32_16x16x32_bf16 v[204:207], a[220:223], a[200:203], 0
    ds_read_b128 a[192:195], v28 offset:10240
    s_add_u32 s61, s61, 9511040
    v_mfma_f32_16x16x32_bf16 v[200:203], a[216:219], a[200:203], 0
    buffer_load_dwordx4 v27, s[28:31], s67 offen offset:2048 lds
    v_mfma_f32_16x16x32_bf16 v[196:199], a[212:215], a[200:203], 0
    s_cmp_eq_u32 s60, 0
    s_cselect_b32 s61, s61, 2147483632
    v_mfma_f32_16x16x32_bf16 v[192:195], a[208:211], a[200:203], 0
    v_add_u32_e64 v42, s61, v42
    s_waitcnt lgkmcnt(3)
    v_mfma_f32_16x16x32_bf16 v[224:227], a[208:211], a[176:179], 0
    ds_read_b128 a[200:203], v28 offset:11264
    v_cmp_gt_u32_e64 vcc, 4, v0
    v_mfma_f32_16x16x32_bf16 v[228:231], a[212:215], a[176:179], 0
    buffer_load_dwordx4 v27, s[32:35], s67 offen offset:3072 lds
    v_mfma_f32_16x16x32_bf16 v[232:235], a[216:219], a[176:179], 0
    s_add_u32 m0, s66, 49152
    s_add_u32 s67, s75, 114688
    v_mfma_f32_16x16x32_bf16 v[236:239], a[220:223], a[176:179], 0
    v_cndmask_b32 v42, v1, v42, vcc
    s_waitcnt lgkmcnt(3)
    v_mfma_f32_16x16x32_bf16 v[252:255], a[220:223], a[184:187], 0
    s_waitcnt vmcnt(9)
    s_barrier
    v_mfma_f32_16x16x32_bf16 v[248:251], a[216:219], a[184:187], 0
    buffer_load_dwordx4 v27, s[28:31], s67 offen offset:0 lds
    v_mfma_f32_16x16x32_bf16 v[244:247], a[212:215], a[184:187], 0
    ds_read_b128 a[176:179], v28 offset:12288
    v_mfma_f32_16x16x32_bf16 v[240:243], a[208:211], a[184:187], 0
    ds_read_b64_tr_b16 a[224:225], v32 offset:16384
    s_waitcnt lgkmcnt(3)
    v_mfma_f32_16x16x32_bf16 v[112:115], a[208:211], a[192:195], 0
    buffer_load_dwordx4 v27, s[32:35], s67 offen offset:1024 lds
    v_mfma_f32_16x16x32_bf16 v[116:119], a[212:215], a[192:195], 0
    ds_read_b64_tr_b16 a[226:227], v32 offset:20480
    s_add_u32 s67, s75, 169984
    v_mfma_f32_16x16x32_bf16 v[120:123], a[216:219], a[192:195], 0
    ds_read_b64_tr_b16 a[228:229], v33 offset:16384
    v_mfma_f32_16x16x32_bf16 v[124:127], a[220:223], a[192:195], 0
    ds_read_b64_tr_b16 a[230:231], v33 offset:20480
    s_waitcnt lgkmcnt(5)
    v_mfma_f32_16x16x32_bf16 v[156:159], a[220:223], a[200:203], 0
    ds_read_b64_tr_b16 a[232:233], v32 offset:17408
    v_mfma_f32_16x16x32_bf16 v[152:155], a[216:219], a[200:203], 0
    ds_read_b64_tr_b16 a[234:235], v32 offset:21504
    v_mfma_f32_16x16x32_bf16 v[148:151], a[212:215], a[200:203], 0
    ds_read_b64_tr_b16 a[236:237], v33 offset:17408
    v_mfma_f32_16x16x32_bf16 v[144:147], a[208:211], a[200:203], 0
    ds_read_b64_tr_b16 a[238:239], v33 offset:21504
    s_waitcnt lgkmcnt(8)
    v_mfma_f32_16x16x32_bf16 v[176:179], a[208:211], a[176:179], 0
    ds_read_b128 a[184:187], v28 offset:13312
    v_mfma_f32_16x16x32_bf16 v[180:183], a[212:215], a[176:179], 0
    ds_read_b128 a[192:195], v29 offset:0
    v_mfma_f32_16x16x32_bf16 v[184:187], a[216:219], a[176:179], 0
    ds_read_b128 a[200:203], v29 offset:1024
    v_mfma_f32_16x16x32_bf16 v[188:191], a[220:223], a[176:179], 0
    s_waitcnt lgkmcnt(2)
    v_mfma_f32_16x16x32_bf16 v[220:223], a[220:223], a[184:187], 0
    ds_read_b128 a[176:179], v29 offset:2048
    v_mfma_f32_16x16x32_bf16 v[216:219], a[216:219], a[184:187], 0
    buffer_load_dwordx4 v27, s[28:31], s67 offen offset:2048 lds
    v_mfma_f32_16x16x32_bf16 v[212:215], a[212:215], a[184:187], 0
    buffer_load_dwordx4 v27, s[32:35], s67 offen offset:3072 lds
    v_mfma_f32_16x16x32_bf16 v[208:211], a[208:211], a[184:187], 0
    s_add_u32 s74, s74, 128
    s_waitcnt lgkmcnt(2)
    v_mfma_f32_16x16x32_bf16 v[96:99], a[224:227], a[192:195], v[96:99]
    s_cmp_eq_u32 s74, 896
    s_cselect_b32 s74, 0, s74
    v_mfma_f32_16x16x32_bf16 v[100:103], a[228:231], a[192:195], v[100:103]
    s_add_u32 m0, s65, 41472
    ds_read_b128 a[184:187], v29 offset:3072
    v_mfma_f32_16x16x32_bf16 v[104:107], a[232:235], a[192:195], v[104:107]
    buffer_load_dwordx4 v22, s[24:27], s74 offen offset:0 lds
    v_mfma_f32_16x16x32_bf16 v[108:111], a[236:239], a[192:195], v[108:111]
    s_waitcnt lgkmcnt(2)
    s_nop 0
    v_mfma_f32_16x16x32_bf16 v[140:143], a[236:239], a[200:203], v[140:143]
    ds_read_b128 a[192:195], v29 offset:4096
    v_mfma_f32_16x16x32_bf16 v[136:139], a[232:235], a[200:203], v[136:139]
    buffer_load_dwordx4 v23, s[24:27], s74 offen offset:1024 lds
    v_mfma_f32_16x16x32_bf16 v[132:135], a[228:231], a[200:203], v[132:135]
    buffer_load_dword v43, off, s[52:55], 0 offset:0 sc1
    v_mfma_f32_16x16x32_bf16 v[128:131], a[224:227], a[200:203], v[128:131]
    s_waitcnt lgkmcnt(2)
    s_nop 0
    v_mfma_f32_16x16x32_bf16 v[160:163], a[224:227], a[176:179], v[160:163]
    ds_read_b128 a[200:203], v31 offset:14336
    v_mfma_f32_16x16x32_bf16 v[164:167], a[228:231], a[176:179], v[164:167]
    buffer_load_dwordx4 v24, s[24:27], s74 offen offset:2048 lds
    v_mfma_f32_16x16x32_bf16 v[168:171], a[232:235], a[176:179], v[168:171]
    v_mfma_f32_16x16x32_bf16 v[172:175], a[236:239], a[176:179], v[172:175]
    s_waitcnt lgkmcnt(2)
    s_nop 0
    v_mfma_f32_16x16x32_bf16 v[204:207], a[236:239], a[184:187], v[204:207]
    ds_read_b128 a[176:179], v29 offset:10240
    v_mfma_f32_16x16x32_bf16 v[200:203], a[232:235], a[184:187], v[200:203]
    buffer_load_dwordx4 v25, s[24:27], s74 offen offset:3072 lds
    v_mfma_f32_16x16x32_bf16 v[196:199], a[228:231], a[184:187], v[196:199]
    s_add_u32 m0, s65, 45568
    v_mfma_f32_16x16x32_bf16 v[192:195], a[224:227], a[184:187], v[192:195]
    s_waitcnt lgkmcnt(2)
    s_nop 0
    v_mfma_f32_16x16x32_bf16 v[224:227], a[224:227], a[192:195], v[224:227]
    ds_read_b128 a[184:187], v29 offset:11264
    v_mfma_f32_16x16x32_bf16 v[228:231], a[228:231], a[192:195], v[228:231]
    buffer_load_dwordx4 v26, s[24:27], s74 offen offset:0 lds
    v_mfma_f32_16x16x32_bf16 v[232:235], a[232:235], a[192:195], v[232:235]
    s_add_u32 m0, s66, 0
    s_add_u32 s75, s75, 229376
    v_mfma_f32_16x16x32_bf16 v[236:239], a[236:239], a[192:195], v[236:239]
    s_waitcnt lgkmcnt(2)
    v_mfma_f32_16x16x32_bf16 v[252:255], a[236:239], a[200:203], v[252:255]
    s_waitcnt vmcnt(10)
    s_barrier
    v_mfma_f32_16x16x32_bf16 v[248:251], a[232:235], a[200:203], v[248:251]
    s_cmp_eq_u32 s75, 1605632
    s_cselect_b32 s75, 0, s75
    v_mfma_f32_16x16x32_bf16 v[244:247], a[228:231], a[200:203], v[244:247]
    s_add_u32 s67, s75, 0
    ds_read_b128 a[192:195], v29 offset:12288
    v_mfma_f32_16x16x32_bf16 v[240:243], a[224:227], a[200:203], v[240:243]
    ds_read_b64_tr_b16 a[240:241], v32 offset:32768
    s_waitcnt lgkmcnt(3)
    v_mfma_f32_16x16x32_bf16 v[112:115], a[224:227], a[176:179], v[112:115]
    buffer_load_dwordx4 v27, s[28:31], s67 offen offset:0 lds
    v_mfma_f32_16x16x32_bf16 v[116:119], a[228:231], a[176:179], v[116:119]
    ds_read_b64_tr_b16 a[242:243], v32 offset:36864
    v_mfma_f32_16x16x32_bf16 v[120:123], a[232:235], a[176:179], v[120:123]
    ds_read_b64_tr_b16 a[244:245], v33 offset:32768
    v_mfma_f32_16x16x32_bf16 v[124:127], a[236:239], a[176:179], v[124:127]
    ds_read_b64_tr_b16 a[246:247], v33 offset:36864
    s_waitcnt lgkmcnt(5)
    v_mfma_f32_16x16x32_bf16 v[156:159], a[236:239], a[184:187], v[156:159]
    ds_read_b64_tr_b16 a[248:249], v32 offset:33792
    v_mfma_f32_16x16x32_bf16 v[152:155], a[232:235], a[184:187], v[152:155]
    ds_read_b64_tr_b16 a[250:251], v32 offset:37888
    v_mfma_f32_16x16x32_bf16 v[148:151], a[228:231], a[184:187], v[148:151]
    ds_read_b64_tr_b16 a[252:253], v33 offset:33792
    v_mfma_f32_16x16x32_bf16 v[144:147], a[224:227], a[184:187], v[144:147]
    ds_read_b64_tr_b16 a[254:255], v33 offset:37888
    s_waitcnt lgkmcnt(8)
    v_mfma_f32_16x16x32_bf16 v[176:179], a[224:227], a[192:195], v[176:179]
    ds_read_b128 a[200:203], v29 offset:13312
    v_mfma_f32_16x16x32_bf16 v[180:183], a[228:231], a[192:195], v[180:183]
    ds_read_b128 a[176:179], v28 offset:20736
    v_mfma_f32_16x16x32_bf16 v[184:187], a[232:235], a[192:195], v[184:187]
    ds_read_b128 a[184:187], v28 offset:21760
    v_mfma_f32_16x16x32_bf16 v[188:191], a[236:239], a[192:195], v[188:191]
    s_waitcnt lgkmcnt(2)
    v_mfma_f32_16x16x32_bf16 v[220:223], a[236:239], a[200:203], v[220:223]
    ds_read_b128 a[192:195], v28 offset:22784
    v_mfma_f32_16x16x32_bf16 v[216:219], a[232:235], a[200:203], v[216:219]
    buffer_load_dwordx4 v27, s[32:35], s67 offen offset:1024 lds
    v_mfma_f32_16x16x32_bf16 v[212:215], a[228:231], a[200:203], v[212:215]
    s_add_u32 s67, s75, 55296
    v_mfma_f32_16x16x32_bf16 v[208:211], a[224:227], a[200:203], v[208:211]
    s_waitcnt lgkmcnt(2)
    s_nop 0
    v_mfma_f32_16x16x32_bf16 v[96:99], a[240:243], a[176:179], v[96:99]
    buffer_load_dwordx4 v27, s[28:31], s67 offen offset:2048 lds
    v_mfma_f32_16x16x32_bf16 v[100:103], a[244:247], a[176:179], v[100:103]
    ds_read_b128 a[200:203], v28 offset:23808
    v_mfma_f32_16x16x32_bf16 v[104:107], a[248:251], a[176:179], v[104:107]
    buffer_load_dwordx4 v27, s[32:35], s67 offen offset:3072 lds
    v_mfma_f32_16x16x32_bf16 v[108:111], a[252:255], a[176:179], v[108:111]
    s_add_u32 m0, s66, 16384
    s_waitcnt lgkmcnt(2)
    v_mfma_f32_16x16x32_bf16 v[140:143], a[252:255], a[184:187], v[140:143]
    s_add_u32 s67, s75, 114688
    ds_read_b128 a[176:179], v28 offset:24832
    v_mfma_f32_16x16x32_bf16 v[136:139], a[248:251], a[184:187], v[136:139]
    v_mfma_f32_16x16x32_bf16 v[132:135], a[244:247], a[184:187], v[132:135]
    v_mfma_f32_16x16x32_bf16 v[128:131], a[240:243], a[184:187], v[128:131]
    s_waitcnt lgkmcnt(2)
    v_mfma_f32_16x16x32_bf16 v[160:163], a[240:243], a[192:195], v[160:163]
    buffer_load_dwordx4 v27, s[28:31], s67 offen offset:0 lds
    v_mfma_f32_16x16x32_bf16 v[164:167], a[244:247], a[192:195], v[164:167]
    ds_read_b128 a[184:187], v30 offset:35072
    v_mfma_f32_16x16x32_bf16 v[168:171], a[248:251], a[192:195], v[168:171]
    v_mfma_f32_16x16x32_bf16 v[172:175], a[252:255], a[192:195], v[172:175]
    s_waitcnt lgkmcnt(2)
    s_nop 0
    v_mfma_f32_16x16x32_bf16 v[204:207], a[252:255], a[200:203], v[204:207]
    ds_read_b128 a[192:195], v28 offset:30976
    v_mfma_f32_16x16x32_bf16 v[200:203], a[248:251], a[200:203], v[200:203]
    buffer_load_dwordx4 v27, s[32:35], s67 offen offset:1024 lds
    v_mfma_f32_16x16x32_bf16 v[196:199], a[244:247], a[200:203], v[196:199]
    s_add_u32 s67, s75, 169984
    v_mfma_f32_16x16x32_bf16 v[192:195], a[240:243], a[200:203], v[192:195]
    s_waitcnt lgkmcnt(2)
    s_nop 0
    v_mfma_f32_16x16x32_bf16 v[224:227], a[240:243], a[176:179], v[224:227]
    ds_read_b128 a[200:203], v28 offset:32000
    v_mfma_f32_16x16x32_bf16 v[228:231], a[244:247], a[176:179], v[228:231]
    buffer_load_dwordx4 v27, s[28:31], s67 offen offset:2048 lds
    v_mfma_f32_16x16x32_bf16 v[232:235], a[248:251], a[176:179], v[232:235]
    v_mfma_f32_16x16x32_bf16 v[236:239], a[252:255], a[176:179], v[236:239]
    s_waitcnt lgkmcnt(2)
    v_mfma_f32_16x16x32_bf16 v[252:255], a[252:255], a[184:187], v[252:255]
    s_waitcnt vmcnt(13)
    s_barrier
    v_mfma_f32_16x16x32_bf16 v[248:251], a[248:251], a[184:187], v[248:251]
    ds_read_b128 a[176:179], v28 offset:33024
    v_mfma_f32_16x16x32_bf16 v[244:247], a[244:247], a[184:187], v[244:247]
    ds_read_b64_tr_b16 a[208:209], v32 offset:49152
    v_mfma_f32_16x16x32_bf16 v[240:243], a[240:243], a[184:187], v[240:243]
    ds_read_b64_tr_b16 a[210:211], v32 offset:53248
    s_waitcnt lgkmcnt(4)
    v_mfma_f32_16x16x32_bf16 v[112:115], a[240:243], a[192:195], v[112:115]
    buffer_load_dwordx4 v27, s[32:35], s67 offen offset:3072 lds
    v_mfma_f32_16x16x32_bf16 v[116:119], a[244:247], a[192:195], v[116:119]
    s_add_u32 s74, s74, 128
    ds_read_b64_tr_b16 a[212:213], v33 offset:49152
    v_mfma_f32_16x16x32_bf16 v[120:123], a[248:251], a[192:195], v[120:123]
    s_cmp_eq_u32 s74, 896
    s_cselect_b32 s74, 0, s74
    v_mfma_f32_16x16x32_bf16 v[124:127], a[252:255], a[192:195], v[124:127]
    ds_read_b64_tr_b16 a[214:215], v33 offset:53248
    s_waitcnt lgkmcnt(5)
    v_mfma_f32_16x16x32_bf16 v[156:159], a[252:255], a[200:203], v[156:159]
    ds_read_b64_tr_b16 a[216:217], v32 offset:50176
    s_add_u32 m0, s65, 0
    v_mfma_f32_16x16x32_bf16 v[152:155], a[248:251], a[200:203], v[152:155]
    ds_read_b64_tr_b16 a[218:219], v32 offset:54272
    v_mfma_f32_16x16x32_bf16 v[148:151], a[244:247], a[200:203], v[148:151]
    ds_read_b64_tr_b16 a[220:221], v33 offset:50176
    v_mfma_f32_16x16x32_bf16 v[144:147], a[240:243], a[200:203], v[144:147]
    ds_read_b64_tr_b16 a[222:223], v33 offset:54272
    s_waitcnt lgkmcnt(8)
    v_mfma_f32_16x16x32_bf16 v[176:179], a[240:243], a[176:179], v[176:179]
    ds_read_b128 a[184:187], v28 offset:34048
    v_mfma_f32_16x16x32_bf16 v[180:183], a[244:247], a[176:179], v[180:183]
    ds_read_b128 a[192:195], v29 offset:20736
    v_mfma_f32_16x16x32_bf16 v[184:187], a[248:251], a[176:179], v[184:187]
    ds_read_b128 a[200:203], v29 offset:21760
    v_mfma_f32_16x16x32_bf16 v[188:191], a[252:255], a[176:179], v[188:191]
    s_waitcnt lgkmcnt(2)
    s_nop 0
    v_mfma_f32_16x16x32_bf16 v[220:223], a[252:255], a[184:187], v[220:223]
    ds_read_b128 a[176:179], v29 offset:22784
    v_mfma_f32_16x16x32_bf16 v[216:219], a[248:251], a[184:187], v[216:219]
    buffer_load_dwordx4 v22, s[24:27], s74 offen offset:0 lds
    v_mfma_f32_16x16x32_bf16 v[212:215], a[244:247], a[184:187], v[212:215]
    buffer_load_dwordx4 v23, s[24:27], s74 offen offset:1024 lds
    v_mfma_f32_16x16x32_bf16 v[208:211], a[240:243], a[184:187], v[208:211]
    s_waitcnt lgkmcnt(2)
    v_mfma_f32_16x16x32_bf16 v[96:99], a[208:211], a[192:195], v[96:99]
    ds_read_b128 a[184:187], v29 offset:23808
    v_mfma_f32_16x16x32_bf16 v[100:103], a[212:215], a[192:195], v[100:103]
    s_waitcnt vmcnt(13)
    v_cmp_eq_u32_e64 vcc, 0, v43
    s_nop 4
    s_cbranch_vccnz Lf_cert
Lf_cert_r:
    v_mfma_f32_16x16x32_bf16 v[104:107], a[216:219], a[192:195], v[104:107]
    buffer_load_dwordx4 v24, s[24:27], s74 offen offset:2048 lds
    v_mfma_f32_16x16x32_bf16 v[108:111], a[220:223], a[192:195], v[108:111]
    s_waitcnt lgkmcnt(2)
    s_nop 0
    v_mfma_f32_16x16x32_bf16 v[140:143], a[220:223], a[200:203], v[140:143]
    ds_read_b128 a[192:195], v29 offset:24832
    v_mfma_f32_16x16x32_bf16 v[136:139], a[216:219], a[200:203], v[136:139]
    buffer_store_dwordx4 v[38:41], v42, s[36:39], 0 offen sc1
    v_mfma_f32_16x16x32_bf16 v[132:135], a[212:215], a[200:203], v[132:135]
    s_mul_i32 s61, s56, 79
    v_add_u32_e64 v44, s61, v0
    v_mfma_f32_16x16x32_bf16 v[128:131], a[208:211], a[200:203], v[128:131]
    v_min_u32 v45, 15, v0
    s_waitcnt lgkmcnt(2)
    v_mfma_f32_16x16x32_bf16 v[160:163], a[208:211], a[176:179], v[160:163]
    buffer_load_dwordx4 v25, s[24:27], s74 offen offset:3072 lds
    v_mfma_f32_16x16x32_bf16 v[164:167], a[212:215], a[176:179], v[164:167]
    s_add_u32 m0, s65, 4096
    ds_read_b128 a[200:203], v31 offset:35072
    v_mfma_f32_16x16x32_bf16 v[168:171], a[216:219], a[176:179], v[168:171]
    v_add3_u32 v45, v45, s61, 64
    v_min_u32 v44, 1023, v44
    v_mfma_f32_16x16x32_bf16 v[172:175], a[220:223], a[176:179], v[172:175]
    v_and_b32 v46, 7, v44
    s_waitcnt lgkmcnt(2)
    v_mfma_f32_16x16x32_bf16 v[204:207], a[220:223], a[184:187], v[204:207]
    ds_read_b128 a[176:179], v29 offset:30976
    v_lshrrev_b32_e64 v44, 3, v44
    v_mfma_f32_16x16x32_bf16 v[200:203], a[216:219], a[184:187], v[200:203]
    buffer_load_dwordx4 v26, s[24:27], s74 offen offset:0 lds
    v_mfma_f32_16x16x32_bf16 v[196:199], a[212:215], a[184:187], v[196:199]
    s_add_u32 m0, s66, 32768
    s_add_u32 s75, s75, 229376
    v_mfma_f32_16x16x32_bf16 v[192:195], a[208:211], a[184:187], v[192:195]
    v_lshlrev_b32 v44, 7, v44
    s_waitcnt lgkmcnt(2)
    v_mfma_f32_16x16x32_bf16 v[224:227], a[208:211], a[192:195], v[224:227]
    ds_read_b128 a[184:187], v29 offset:32000
    v_lshl_add_u32 v44, v46, 2, v44
    v_mfma_f32_16x16x32_bf16 v[228:231], a[212:215], a[192:195], v[228:231]
    s_cmp_eq_u32 s75, 1605632
    s_cselect_b32 s75, 0, s75
    v_mfma_f32_16x16x32_bf16 v[232:235], a[216:219], a[192:195], v[232:235]
    s_add_u32 s67, s75, 0
    v_min_u32 v45, 1023, v45
    v_mfma_f32_16x16x32_bf16 v[236:239], a[220:223], a[192:195], v[236:239]
    v_and_b32 v46, 7, v45
    s_waitcnt lgkmcnt(2)
    v_mfma_f32_16x16x32_bf16 v[252:255], a[220:223], a[200:203], v[252:255]
    s_waitcnt vmcnt(10)
    s_barrier
    v_mfma_f32_16x16x32_bf16 v[248:251], a[216:219], a[200:203], v[248:251]
    buffer_load_dwordx4 v27, s[28:31], s67 offen offset:0 lds
    v_mfma_f32_16x16x32_bf16 v[244:247], a[212:215], a[200:203], v[244:247]
    ds_read_b128 a[192:195], v29 offset:33024
    v_lshrrev_b32_e64 v45, 3, v45
    v_mfma_f32_16x16x32_bf16 v[240:243], a[208:211], a[200:203], v[240:243]
    ds_read_b64_tr_b16 a[224:225], v32 offset:0
    s_waitcnt lgkmcnt(3)
    v_mfma_f32_16x16x32_bf16 v[112:115], a[208:211], a[176:179], v[112:115]
    buffer_load_dwordx4 v27, s[32:35], s67 offen offset:1024 lds
    v_mfma_f32_16x16x32_bf16 v[116:119], a[212:215], a[176:179], v[116:119]
    ds_read_b64_tr_b16 a[226:227], v32 offset:4096
    s_add_u32 s67, s75, 55296
    v_mfma_f32_16x16x32_bf16 v[120:123], a[216:219], a[176:179], v[120:123]
    ds_read_b64_tr_b16 a[228:229], v33 offset:0
    v_lshlrev_b32 v45, 7, v45
    v_mfma_f32_16x16x32_bf16 v[124:127], a[220:223], a[176:179], v[124:127]
    ds_read_b64_tr_b16 a[230:231], v33 offset:4096
    s_waitcnt lgkmcnt(5)
    v_mfma_f32_16x16x32_bf16 v[156:159], a[220:223], a[184:187], v[156:159]
    ds_read_b64_tr_b16 a[232:233], v32 offset:1024
    v_lshl_add_u32 v45, v46, 2, v45
    v_mfma_f32_16x16x32_bf16 v[152:155], a[216:219], a[184:187], v[152:155]
    ds_read_b64_tr_b16 a[234:235], v32 offset:5120
    s_and_b32 s61, s60, 1
    v_mfma_f32_16x16x32_bf16 v[148:151], a[212:215], a[184:187], v[148:151]
    ds_read_b64_tr_b16 a[236:237], v33 offset:1024
    s_lshr_b32 s63, s60, 1
    v_mfma_f32_16x16x32_bf16 v[144:147], a[208:211], a[184:187], v[144:147]
    ds_read_b64_tr_b16 a[238:239], v33 offset:5120
    s_waitcnt lgkmcnt(8)
    v_mfma_f32_16x16x32_bf16 v[176:179], a[208:211], a[192:195], v[176:179]
    ds_read_b128 a[200:203], v29 offset:34048
    s_lshl1_add_u32 s61, s61, s63
    v_mfma_f32_16x16x32_bf16 v[180:183], a[212:215], a[192:195], v[180:183]
    ds_read_b128 a[176:179], v28 offset:41472
    s_lshl_b32 s62, s61, 5
    v_mfma_f32_16x16x32_bf16 v[184:187], a[216:219], a[192:195], v[184:187]
    ds_read_b128 a[184:187], v28 offset:42496
    s_add_u32 s62, s62, 9674752
    v_mfma_f32_16x16x32_bf16 v[188:191], a[220:223], a[192:195], v[188:191]
    s_lshl_b32 s61, s61, 9
    s_waitcnt lgkmcnt(2)
    v_mfma_f32_16x16x32_bf16 v[220:223], a[220:223], a[200:203], v[220:223]
    ds_read_b128 a[192:195], v28 offset:43520
    s_add_u32 s61, s61, 160512
    v_mfma_f32_16x16x32_bf16 v[216:219], a[216:219], a[200:203], v[216:219]
    buffer_load_dwordx4 v27, s[28:31], s67 offen offset:2048 lds
    v_mfma_f32_16x16x32_bf16 v[212:215], a[212:215], a[200:203], v[212:215]
    buffer_load_dwordx4 v27, s[32:35], s67 offen offset:3072 lds
    v_mfma_f32_16x16x32_bf16 v[208:211], a[208:211], a[200:203], v[208:211]
    s_add_u32 m0, s66, 49152
    s_waitcnt lgkmcnt(2)
    v_mfma_f32_16x16x32_bf16 v[96:99], a[224:227], a[176:179], v[96:99]
    s_add_u32 s67, s75, 114688
    ds_read_b128 a[200:203], v28 offset:44544
    v_mfma_f32_16x16x32_bf16 v[100:103], a[228:231], a[176:179], v[100:103]
    v_lshl_add_u32 v46, v0, 2, s61
    v_mfma_f32_16x16x32_bf16 v[104:107], a[232:235], a[176:179], v[104:107]
    buffer_load_dwordx4 v27, s[28:31], s67 offen offset:0 lds
    v_mfma_f32_16x16x32_bf16 v[108:111], a[236:239], a[176:179], v[108:111]
    s_waitcnt lgkmcnt(2)
    v_mfma_f32_16x16x32_bf16 v[140:143], a[236:239], a[184:187], v[140:143]
    ds_read_b128 a[176:179], v28 offset:45568
    v_mfma_f32_16x16x32_bf16 v[136:139], a[232:235], a[184:187], v[136:139]
    v_mfma_f32_16x16x32_bf16 v[132:135], a[228:231], a[184:187], v[132:135]
    v_mfma_f32_16x16x32_bf16 v[128:131], a[224:227], a[184:187], v[128:131]
    s_waitcnt lgkmcnt(2)
    s_nop 0
    v_mfma_f32_16x16x32_bf16 v[160:163], a[224:227], a[192:195], v[160:163]
    buffer_load_dwordx4 v27, s[32:35], s67 offen offset:1024 lds
    v_mfma_f32_16x16x32_bf16 v[164:167], a[228:231], a[192:195], v[164:167]
    s_add_u32 s67, s75, 169984
    ds_read_b128 a[184:187], v30 offset:55808
    v_mfma_f32_16x16x32_bf16 v[168:171], a[232:235], a[192:195], v[168:171]
    v_mfma_f32_16x16x32_bf16 v[172:175], a[236:239], a[192:195], v[172:175]
    s_waitcnt lgkmcnt(2)
    s_nop 0
    v_mfma_f32_16x16x32_bf16 v[204:207], a[236:239], a[200:203], v[204:207]
    ds_read_b128 a[192:195], v28 offset:51712
    v_mfma_f32_16x16x32_bf16 v[200:203], a[232:235], a[200:203], v[200:203]
    buffer_load_dwordx4 v27, s[28:31], s67 offen offset:2048 lds
    v_mfma_f32_16x16x32_bf16 v[196:199], a[228:231], a[200:203], v[196:199]
    v_mfma_f32_16x16x32_bf16 v[192:195], a[224:227], a[200:203], v[192:195]
    s_waitcnt lgkmcnt(2)
    s_nop 0
    v_mfma_f32_16x16x32_bf16 v[224:227], a[224:227], a[176:179], v[224:227]
    ds_read_b128 a[200:203], v28 offset:52736
    v_mfma_f32_16x16x32_bf16 v[228:231], a[228:231], a[176:179], v[228:231]
    buffer_load_dwordx4 v27, s[32:35], s67 offen offset:3072 lds
    v_mfma_f32_16x16x32_bf16 v[232:235], a[232:235], a[176:179], v[232:235]
    s_add_u32 s74, s74, 128
    v_mfma_f32_16x16x32_bf16 v[236:239], a[236:239], a[176:179], v[236:239]
    s_waitcnt lgkmcnt(2)
    v_mfma_f32_16x16x32_bf16 v[252:255], a[236:239], a[184:187], v[252:255]
    s_waitcnt vmcnt(14)
    s_barrier
    v_mfma_f32_16x16x32_bf16 v[248:251], a[232:235], a[184:187], v[248:251]
    s_cmp_eq_u32 s74, 896
    s_cselect_b32 s74, 0, s74
    v_mfma_f32_16x16x32_bf16 v[244:247], a[228:231], a[184:187], v[244:247]
    s_add_u32 m0, s65, 20736
    ds_read_b128 a[176:179], v28 offset:53760
    v_mfma_f32_16x16x32_bf16 v[240:243], a[224:227], a[184:187], v[240:243]
    ds_read_b64_tr_b16 a[240:241], v32 offset:16384
    s_waitcnt lgkmcnt(3)
    v_mfma_f32_16x16x32_bf16 v[112:115], a[224:227], a[192:195], v[112:115]
    buffer_load_dwordx4 v22, s[24:27], s74 offen offset:0 lds
    v_mfma_f32_16x16x32_bf16 v[116:119], a[228:231], a[192:195], v[116:119]
    ds_read_b64_tr_b16 a[242:243], v32 offset:20480
    v_mfma_f32_16x16x32_bf16 v[120:123], a[232:235], a[192:195], v[120:123]
    ds_read_b64_tr_b16 a[244:245], v33 offset:16384
    v_mfma_f32_16x16x32_bf16 v[124:127], a[236:239], a[192:195], v[124:127]
    ds_read_b64_tr_b16 a[246:247], v33 offset:20480
    s_waitcnt lgkmcnt(5)
    v_mfma_f32_16x16x32_bf16 v[156:159], a[236:239], a[200:203], v[156:159]
    ds_read_b64_tr_b16 a[248:249], v32 offset:17408
    v_mfma_f32_16x16x32_bf16 v[152:155], a[232:235], a[200:203], v[152:155]
    ds_read_b64_tr_b16 a[250:251], v32 offset:21504
    v_mfma_f32_16x16x32_bf16 v[148:151], a[228:231], a[200:203], v[148:151]
    ds_read_b64_tr_b16 a[252:253], v33 offset:17408
    v_mfma_f32_16x16x32_bf16 v[144:147], a[224:227], a[200:203], v[144:147]
    ds_read_b64_tr_b16 a[254:255], v33 offset:21504
    s_waitcnt lgkmcnt(8)
    v_mfma_f32_16x16x32_bf16 v[176:179], a[224:227], a[176:179], v[176:179]
    ds_read_b128 a[184:187], v28 offset:54784
    v_mfma_f32_16x16x32_bf16 v[180:183], a[228:231], a[176:179], v[180:183]
    ds_read_b128 a[192:195], v29 offset:41472
    v_mfma_f32_16x16x32_bf16 v[184:187], a[232:235], a[176:179], v[184:187]
    ds_read_b128 a[200:203], v29 offset:42496
    v_mfma_f32_16x16x32_bf16 v[188:191], a[236:239], a[176:179], v[188:191]
    s_waitcnt lgkmcnt(2)
    v_mfma_f32_16x16x32_bf16 v[220:223], a[236:239], a[184:187], v[220:223]
    ds_read_b128 a[176:179], v29 offset:43520
    v_mfma_f32_16x16x32_bf16 v[216:219], a[232:235], a[184:187], v[216:219]
    buffer_load_dwordx4 v23, s[24:27], s74 offen offset:1024 lds
    v_mfma_f32_16x16x32_bf16 v[212:215], a[228:231], a[184:187], v[212:215]
    buffer_load_dwordx4 v24, s[24:27], s74 offen offset:2048 lds
    v_mfma_f32_16x16x32_bf16 v[208:211], a[224:227], a[184:187], v[208:211]
    s_waitcnt lgkmcnt(2)
    s_nop 0
    v_mfma_f32_16x16x32_bf16 v[96:99], a[240:243], a[192:195], v[96:99]
    ds_read_b128 a[184:187], v29 offset:44544
    v_mfma_f32_16x16x32_bf16 v[100:103], a[244:247], a[192:195], v[100:103]
    v_mfma_f32_16x16x32_bf16 v[104:107], a[248:251], a[192:195], v[104:107]
    buffer_load_dwordx4 v25, s[24:27], s74 offen offset:3072 lds
    v_mfma_f32_16x16x32_bf16 v[108:111], a[252:255], a[192:195], v[108:111]
    s_add_u32 m0, s65, 24832
    s_waitcnt lgkmcnt(2)
    v_mfma_f32_16x16x32_bf16 v[140:143], a[252:255], a[200:203], v[140:143]
    ds_read_b128 a[192:195], v29 offset:45568
    v_mfma_f32_16x16x32_bf16 v[136:139], a[248:251], a[200:203], v[136:139]
    v_mfma_f32_16x16x32_bf16 v[132:135], a[244:247], a[200:203], v[132:135]
    v_mfma_f32_16x16x32_bf16 v[128:131], a[240:243], a[200:203], v[128:131]
    s_waitcnt lgkmcnt(2)
    v_mfma_f32_16x16x32_bf16 v[160:163], a[240:243], a[176:179], v[160:163]
    buffer_load_dwordx4 v26, s[24:27], s74 offen offset:0 lds
    v_mfma_f32_16x16x32_bf16 v[164:167], a[244:247], a[176:179], v[164:167]
    s_add_u32 m0, s66, 0
    s_add_u32 s75, s75, 229376
    v_mfma_f32_16x16x32_bf16 v[168:171], a[248:251], a[176:179], v[168:171]
    s_cmp_eq_u32 s75, 1605632
    s_cselect_b32 s75, 0, s75
    v_mfma_f32_16x16x32_bf16 v[172:175], a[252:255], a[176:179], v[172:175]
    s_add_u32 s67, s75, 0
    s_waitcnt lgkmcnt(1)
    v_mfma_f32_16x16x32_bf16 v[204:207], a[252:255], a[184:187], v[204:207]
    ds_read_b128 a[200:203], v31 offset:55808
    v_mfma_f32_16x16x32_bf16 v[200:203], a[248:251], a[184:187], v[200:203]
    ds_read_b128 a[176:179], v29 offset:51712
    v_mfma_f32_16x16x32_bf16 v[196:199], a[244:247], a[184:187], v[196:199]
    buffer_load_dwordx4 v27, s[28:31], s67 offen offset:0 lds
    v_mfma_f32_16x16x32_bf16 v[192:195], a[240:243], a[184:187], v[192:195]
    s_waitcnt lgkmcnt(2)
    s_nop 0
    v_mfma_f32_16x16x32_bf16 v[224:227], a[240:243], a[192:195], v[224:227]
    ds_read_b128 a[184:187], v29 offset:52736
    v_mfma_f32_16x16x32_bf16 v[228:231], a[244:247], a[192:195], v[228:231]
    v_mfma_f32_16x16x32_bf16 v[232:235], a[248:251], a[192:195], v[232:235]
    buffer_load_dwordx4 v27, s[32:35], s67 offen offset:1024 lds
    v_mfma_f32_16x16x32_bf16 v[236:239], a[252:255], a[192:195], v[236:239]
    s_add_u32 s67, s75, 55296
    s_waitcnt lgkmcnt(2)
    v_mfma_f32_16x16x32_bf16 v[252:255], a[252:255], a[200:203], v[252:255]
    s_waitcnt vmcnt(11)
    s_barrier
    v_mfma_f32_16x16x32_bf16 v[248:251], a[248:251], a[200:203], v[248:251]
    ds_read_b128 a[192:195], v29 offset:53760
    v_mfma_f32_16x16x32_bf16 v[244:247], a[244:247], a[200:203], v[244:247]
    ds_read_b64_tr_b16 a[208:209], v32 offset:32768
    v_mfma_f32_16x16x32_bf16 v[240:243], a[240:243], a[200:203], v[240:243]
    ds_read_b64_tr_b16 a[210:211], v32 offset:36864
    s_waitcnt lgkmcnt(4)
    v_mfma_f32_16x16x32_bf16 v[112:115], a[240:243], a[176:179], v[112:115]
    buffer_load_dwordx4 v27, s[28:31], s67 offen offset:2048 lds
    v_mfma_f32_16x16x32_bf16 v[116:119], a[244:247], a[176:179], v[116:119]
    ds_read_b64_tr_b16 a[212:213], v33 offset:32768
    v_mfma_f32_16x16x32_bf16 v[120:123], a[248:251], a[176:179], v[120:123]
    ds_read_b64_tr_b16 a[214:215], v33 offset:36864
    v_mfma_f32_16x16x32_bf16 v[124:127], a[252:255], a[176:179], v[124:127]
    ds_read_b64_tr_b16 a[216:217], v32 offset:33792
    s_waitcnt lgkmcnt(6)
    v_mfma_f32_16x16x32_bf16 v[156:159], a[252:255], a[184:187], v[156:159]
    ds_read_b64_tr_b16 a[218:219], v32 offset:37888
    v_mfma_f32_16x16x32_bf16 v[152:155], a[248:251], a[184:187], v[152:155]
    ds_read_b64_tr_b16 a[220:221], v33 offset:33792
    v_mfma_f32_16x16x32_bf16 v[148:151], a[244:247], a[184:187], v[148:151]
    ds_read_b64_tr_b16 a[222:223], v33 offset:37888
    v_mfma_f32_16x16x32_bf16 v[144:147], a[240:243], a[184:187], v[144:147]
    ds_read_b128 a[200:203], v29 offset:54784
    s_waitcnt lgkmcnt(9)
    v_mfma_f32_16x16x32_bf16 v[176:179], a[240:243], a[192:195], v[176:179]
    ds_read_b128 a[176:179], v28 offset:0
    v_mfma_f32_16x16x32_bf16 v[180:183], a[244:247], a[192:195], v[180:183]
    ds_read_b128 a[184:187], v28 offset:1024
    v_mfma_f32_16x16x32_bf16 v[184:187], a[248:251], a[192:195], v[184:187]
    buffer_load_dwordx4 v27, s[32:35], s67 offen offset:3072 lds
    v_mfma_f32_16x16x32_bf16 v[188:191], a[252:255], a[192:195], v[188:191]
    s_add_u32 m0, s66, 16384
    s_waitcnt lgkmcnt(2)
    v_mfma_f32_16x16x32_bf16 v[220:223], a[252:255], a[200:203], v[220:223]
    ds_read_b128 a[192:195], v28 offset:2048
    s_add_u32 s67, s75, 114688
    v_mfma_f32_16x16x32_bf16 v[216:219], a[248:251], a[200:203], v[216:219]
    buffer_load_dwordx4 v27, s[28:31], s67 offen offset:0 lds
    v_mfma_f32_16x16x32_bf16 v[212:215], a[244:247], a[200:203], v[212:215]
    v_mfma_f32_16x16x32_bf16 v[208:211], a[240:243], a[200:203], v[208:211]
    s_waitcnt lgkmcnt(2)
    v_mfma_f32_16x16x32_bf16 v[96:99], a[208:211], a[176:179], v[96:99]
    buffer_load_dwordx4 v27, s[32:35], s67 offen offset:1024 lds
    v_mfma_f32_16x16x32_bf16 v[100:103], a[212:215], a[176:179], v[100:103]
    s_add_u32 s67, s75, 169984
    ds_read_b128 a[200:203], v28 offset:3072
    v_mfma_f32_16x16x32_bf16 v[104:107], a[216:219], a[176:179], v[104:107]
    v_mfma_f32_16x16x32_bf16 v[108:111], a[220:223], a[176:179], v[108:111]
    s_waitcnt lgkmcnt(2)
    v_mfma_f32_16x16x32_bf16 v[140:143], a[220:223], a[184:187], v[140:143]
    s_waitcnt vmcnt(11)
    s_barrier
    v_mfma_f32_16x16x32_bf16 v[136:139], a[216:219], a[184:187], v[136:139]
    ds_read_b128 a[176:179], v28 offset:4096
    v_mfma_f32_16x16x32_bf16 v[132:135], a[212:215], a[184:187], v[132:135]
    ds_read_b64_tr_b16 a[224:225], v32 offset:49152
    v_mfma_f32_16x16x32_bf16 v[128:131], a[208:211], a[184:187], v[128:131]
    ds_read_b64_tr_b16 a[226:227], v32 offset:53248
    s_waitcnt lgkmcnt(4)
    v_mfma_f32_16x16x32_bf16 v[160:163], a[208:211], a[192:195], v[160:163]
    ds_read_b64_tr_b16 a[228:229], v33 offset:49152
    v_mfma_f32_16x16x32_bf16 v[164:167], a[212:215], a[192:195], v[164:167]
    ds_read_b64_tr_b16 a[230:231], v33 offset:53248
    v_mfma_f32_16x16x32_bf16 v[168:171], a[216:219], a[192:195], v[168:171]
    ds_read_b64_tr_b16 a[232:233], v32 offset:50176
    v_mfma_f32_16x16x32_bf16 v[172:175], a[220:223], a[192:195], v[172:175]
    ds_read_b64_tr_b16 a[234:235], v32 offset:54272
    s_waitcnt lgkmcnt(7)
    v_mfma_f32_16x16x32_bf16 v[204:207], a[220:223], a[200:203], v[204:207]
    ds_read_b64_tr_b16 a[236:237], v33 offset:50176
    v_mfma_f32_16x16x32_bf16 v[200:203], a[216:219], a[200:203], v[200:203]
    ds_read_b64_tr_b16 a[238:239], v33 offset:54272
    v_mfma_f32_16x16x32_bf16 v[196:199], a[212:215], a[200:203], v[196:199]
    ds_read_b128 a[184:187], v30 offset:14336
    v_mfma_f32_16x16x32_bf16 v[192:195], a[208:211], a[200:203], v[192:195]
    ds_read_b128 a[188:191], v31 offset:14336
    s_waitcnt lgkmcnt(10)
    v_mfma_f32_16x16x32_bf16 v[224:227], a[208:211], a[176:179], v[224:227]
    ds_read_b128 a[192:195], v28 offset:10240
    v_mfma_f32_16x16x32_bf16 v[228:231], a[212:215], a[176:179], v[228:231]
    ds_read_b128 a[196:199], v29 offset:10240
    v_mfma_f32_16x16x32_bf16 v[232:235], a[216:219], a[176:179], v[232:235]
    ds_read_b128 a[200:203], v28 offset:11264
    v_mfma_f32_16x16x32_bf16 v[236:239], a[220:223], a[176:179], v[236:239]
    ds_read_b128 a[204:207], v29 offset:11264
    s_waitcnt lgkmcnt(4)
    v_mfma_f32_16x16x32_bf16 v[240:243], a[208:211], a[184:187], v[240:243]
    buffer_load_dwordx4 v27, s[28:31], s67 offen offset:2048 lds
    v_mfma_f32_16x16x32_bf16 v[240:243], a[224:227], a[188:191], v[240:243]
    buffer_load_dwordx4 v27, s[32:35], s67 offen offset:3072 lds
    v_mfma_f32_16x16x32_bf16 v[244:247], a[228:231], a[188:191], v[244:247]
    s_add_u32 s74, s74, 128
    ds_read_b128 a[176:179], v28 offset:12288
    v_mfma_f32_16x16x32_bf16 v[244:247], a[212:215], a[184:187], v[244:247]
    s_cmp_eq_u32 s74, 896
    s_cselect_b32 s74, 0, s74
    v_mfma_f32_16x16x32_bf16 v[248:251], a[216:219], a[184:187], v[248:251]
    s_add_u32 m0, s65, 41472
    ds_read_b128 a[180:183], v29 offset:12288
    v_mfma_f32_16x16x32_bf16 v[248:251], a[232:235], a[188:191], v[248:251]
    buffer_load_dwordx4 v22, s[24:27], s74 offen offset:0 lds
    v_mfma_f32_16x16x32_bf16 v[252:255], a[236:239], a[188:191], v[252:255]
    buffer_load_dword v47, v44, s[36:39], s62 offen sc1
    v_mfma_f32_16x16x32_bf16 v[252:255], a[220:223], a[184:187], v[252:255]
    s_waitcnt lgkmcnt(4)
    s_nop 0
    v_mfma_f32_16x16x32_bf16 v[112:115], a[208:211], a[192:195], v[112:115]
    ds_read_b128 a[184:187], v28 offset:13312
    v_mfma_f32_16x16x32_bf16 v[112:115], a[224:227], a[196:199], v[112:115]
    ds_read_b128 a[188:191], v29 offset:13312
    v_mfma_f32_16x16x32_bf16 v[116:119], a[228:231], a[196:199], v[116:119]
    buffer_load_dwordx4 v23, s[24:27], s74 offen offset:1024 lds
    v_mfma_f32_16x16x32_bf16 v[116:119], a[212:215], a[192:195], v[116:119]
    buffer_load_dword v48, v45, s[36:39], s62 offen sc1
    v_mfma_f32_16x16x32_bf16 v[120:123], a[216:219], a[192:195], v[120:123]
    buffer_load_dword v43, off, s[52:55], 0 offset:128 sc1
    v_mfma_f32_16x16x32_bf16 v[120:123], a[232:235], a[196:199], v[120:123]
    v_mfma_f32_16x16x32_bf16 v[124:127], a[236:239], a[196:199], v[124:127]
    v_mfma_f32_16x16x32_bf16 v[124:127], a[220:223], a[192:195], v[124:127]
    s_waitcnt lgkmcnt(4)
    v_mfma_f32_16x16x32_bf16 v[144:147], a[208:211], a[200:203], v[144:147]
    s_waitcnt vmcnt(9)
    s_barrier
    v_mfma_f32_16x16x32_bf16 v[144:147], a[224:227], a[204:207], v[144:147]
    buffer_load_dwordx4 v24, s[24:27], s74 offen offset:2048 lds
    v_mfma_f32_16x16x32_bf16 v[148:151], a[228:231], a[204:207], v[148:151]
    ds_read_b128 a[192:195], v29 offset:0
    v_mfma_f32_16x16x32_bf16 v[148:151], a[212:215], a[200:203], v[148:151]
    ds_read_b128 a[196:199], v28 offset:20736
    v_mfma_f32_16x16x32_bf16 v[152:155], a[216:219], a[200:203], v[152:155]
    ds_read_b64_tr_b16 a[240:241], v32 offset:0
    v_mfma_f32_16x16x32_bf16 v[152:155], a[232:235], a[204:207], v[152:155]
    buffer_load_dwordx4 v25, s[24:27], s74 offen offset:3072 lds
    v_mfma_f32_16x16x32_bf16 v[156:159], a[236:239], a[204:207], v[156:159]
    s_add_u32 m0, s65, 45568
    ds_read_b64_tr_b16 a[242:243], v32 offset:4096
    v_mfma_f32_16x16x32_bf16 v[156:159], a[220:223], a[200:203], v[156:159]
    ds_read_b64_tr_b16 a[244:245], v33 offset:0
    s_waitcnt lgkmcnt(7)
    v_mfma_f32_16x16x32_bf16 v[176:179], a[208:211], a[176:179], v[176:179]
    ds_read_b64_tr_b16 a[246:247], v33 offset:4096
    v_mfma_f32_16x16x32_bf16 v[176:179], a[224:227], a[180:183], v[176:179]
    ds_read_b64_tr_b16 a[248:249], v32 offset:1024
    v_mfma_f32_16x16x32_bf16 v[180:183], a[228:231], a[180:183], v[180:183]
    buffer_load_dwordx4 v26, s[24:27], s74 offen offset:0 lds
    v_mfma_f32_16x16x32_bf16 v[180:183], a[212:215], a[176:179], v[180:183]
    s_add_u32 m0, s66, 32768
    s_add_u32 s75, s75, 229376
    v_mfma_f32_16x16x32_bf16 v[184:187], a[216:219], a[176:179], v[184:187]
    s_cmp_eq_u32 s75, 1605632
    s_cselect_b32 s75, 0, s75
    v_mfma_f32_16x16x32_bf16 v[184:187], a[232:235], a[180:183], v[184:187]
    ds_read_b64_tr_b16 a[250:251], v32 offset:5120
    s_add_u32 s67, s75, 0
    v_mfma_f32_16x16x32_bf16 v[188:191], a[236:239], a[180:183], v[188:191]
    ds_read_b64_tr_b16 a[252:253], v33 offset:1024
    v_mfma_f32_16x16x32_bf16 v[188:191], a[220:223], a[176:179], v[188:191]
    ds_read_b64_tr_b16 a[254:255], v33 offset:5120
    s_waitcnt lgkmcnt(10)
    v_mfma_f32_16x16x32_bf16 v[208:211], a[208:211], a[184:187], v[208:211]
    ds_read_b128 a[200:203], v29 offset:1024
    v_mfma_f32_16x16x32_bf16 v[208:211], a[224:227], a[188:191], v[208:211]
    ds_read_b128 a[204:207], v28 offset:21760
    v_mfma_f32_16x16x32_bf16 v[212:215], a[228:231], a[188:191], v[212:215]
    ds_read_b128 a[176:179], v29 offset:2048
    v_mfma_f32_16x16x32_bf16 v[212:215], a[212:215], a[184:187], v[212:215]
    ds_read_b128 a[180:183], v28 offset:22784
    v_mfma_f32_16x16x32_bf16 v[216:219], a[216:219], a[184:187], v[216:219]
    buffer_load_dwordx4 v27, s[28:31], s67 offen offset:0 lds
    v_mfma_f32_16x16x32_bf16 v[216:219], a[232:235], a[188:191], v[216:219]
    buffer_load_dwordx4 v27, s[32:35], s67 offen offset:1024 lds
    v_mfma_f32_16x16x32_bf16 v[220:223], a[236:239], a[188:191], v[220:223]
    s_add_u32 s67, s75, 55296
    v_mfma_f32_16x16x32_bf16 v[220:223], a[220:223], a[184:187], v[220:223]
    s_waitcnt lgkmcnt(4)
    v_mfma_f32_16x16x32_bf16 v[96:99], a[224:227], a[192:195], v[96:99]
    ds_read_b128 a[184:187], v29 offset:3072
    v_mfma_f32_16x16x32_bf16 v[96:99], a[240:243], a[196:199], v[96:99]
    ds_read_b128 a[188:191], v28 offset:23808
    v_mfma_f32_16x16x32_bf16 v[100:103], a[244:247], a[196:199], v[100:103]
    buffer_load_dwordx4 v27, s[28:31], s67 offen offset:2048 lds
    v_mfma_f32_16x16x32_bf16 v[100:103], a[228:231], a[192:195], v[100:103]
    v_mfma_f32_16x16x32_bf16 v[104:107], a[232:235], a[192:195], v[104:107]
    v_mfma_f32_16x16x32_bf16 v[104:107], a[248:251], a[196:199], v[104:107]
    v_mfma_f32_16x16x32_bf16 v[108:111], a[252:255], a[196:199], v[108:111]
    v_mfma_f32_16x16x32_bf16 v[108:111], a[236:239], a[192:195], v[108:111]
    s_waitcnt lgkmcnt(4)
    s_nop 0
    v_mfma_f32_16x16x32_bf16 v[128:131], a[224:227], a[200:203], v[128:131]
    buffer_load_dwordx4 v27, s[32:35], s67 offen offset:3072 lds
    v_mfma_f32_16x16x32_bf16 v[128:131], a[240:243], a[204:207], v[128:131]
    s_add_u32 m0, s66, 49152
    s_add_u32 s67, s75, 114688
    v_mfma_f32_16x16x32_bf16 v[132:135], a[244:247], a[204:207], v[132:135]
    ds_read_b128 a[192:195], v29 offset:4096
    v_mfma_f32_16x16x32_bf16 v[132:135], a[228:231], a[200:203], v[132:135]
    ds_read_b128 a[196:199], v28 offset:24832
    v_mfma_f32_16x16x32_bf16 v[136:139], a[232:235], a[200:203], v[136:139]
    buffer_load_dwordx4 v27, s[28:31], s67 offen offset:0 lds
    v_mfma_f32_16x16x32_bf16 v[136:139], a[248:251], a[204:207], v[136:139]
    v_mfma_f32_16x16x32_bf16 v[140:143], a[252:255], a[204:207], v[140:143]
    v_mfma_f32_16x16x32_bf16 v[140:143], a[236:239], a[200:203], v[140:143]
    s_waitcnt lgkmcnt(4)
    v_mfma_f32_16x16x32_bf16 v[160:163], a[224:227], a[176:179], v[160:163]
    s_waitcnt vmcnt(13)
    s_barrier
    v_mfma_f32_16x16x32_bf16 v[160:163], a[240:243], a[180:183], v[160:163]
    ds_read_b128 a[200:203], v30 offset:35072
    v_mfma_f32_16x16x32_bf16 v[164:167], a[244:247], a[180:183], v[164:167]
    buffer_load_dwordx4 v27, s[32:35], s67 offen offset:1024 lds
    v_mfma_f32_16x16x32_bf16 v[164:167], a[228:231], a[176:179], v[164:167]
    s_add_u32 s67, s75, 169984
    ds_read_b128 a[204:207], v31 offset:35072
    v_mfma_f32_16x16x32_bf16 v[168:171], a[232:235], a[176:179], v[168:171]
    ds_read_b64_tr_b16 a[208:209], v32 offset:16384
    v_mfma_f32_16x16x32_bf16 v[168:171], a[248:251], a[180:183], v[168:171]
    ds_read_b64_tr_b16 a[210:211], v32 offset:20480
    v_mfma_f32_16x16x32_bf16 v[172:175], a[252:255], a[180:183], v[172:175]
    ds_read_b64_tr_b16 a[212:213], v33 offset:16384
    v_mfma_f32_16x16x32_bf16 v[172:175], a[236:239], a[176:179], v[172:175]
    ds_read_b64_tr_b16 a[214:215], v33 offset:20480
    s_waitcnt lgkmcnt(8)
    v_mfma_f32_16x16x32_bf16 v[192:195], a[224:227], a[184:187], v[192:195]
    buffer_load_dwordx4 v27, s[28:31], s67 offen offset:2048 lds
    v_mfma_f32_16x16x32_bf16 v[192:195], a[240:243], a[188:191], v[192:195]
    ds_read_b64_tr_b16 a[216:217], v32 offset:17408
    v_mfma_f32_16x16x32_bf16 v[196:199], a[244:247], a[188:191], v[196:199]
    ds_read_b64_tr_b16 a[218:219], v32 offset:21504
    v_mfma_f32_16x16x32_bf16 v[196:199], a[228:231], a[184:187], v[196:199]
    ds_read_b64_tr_b16 a[220:221], v33 offset:17408
    v_mfma_f32_16x16x32_bf16 v[200:203], a[232:235], a[184:187], v[200:203]
    buffer_load_dwordx4 v27, s[32:35], s67 offen offset:3072 lds
    v_mfma_f32_16x16x32_bf16 v[200:203], a[248:251], a[188:191], v[200:203]
    s_add_u32 m0, s66, 0
    s_add_u32 s75, s75, 229376
    v_mfma_f32_16x16x32_bf16 v[204:207], a[252:255], a[188:191], v[204:207]
    s_cmp_eq_u32 s75, 1605632
    s_cselect_b32 s75, 0, s75
    v_mfma_f32_16x16x32_bf16 v[204:207], a[236:239], a[184:187], v[204:207]
    ds_read_b64_tr_b16 a[222:223], v33 offset:21504
    s_waitcnt lgkmcnt(10)
    v_mfma_f32_16x16x32_bf16 v[224:227], a[224:227], a[192:195], v[224:227]
    ds_read_b128 a[176:179], v28 offset:30976
    s_add_u32 s67, s75, 0
    v_mfma_f32_16x16x32_bf16 v[224:227], a[240:243], a[196:199], v[224:227]
    ds_read_b128 a[180:183], v29 offset:30976
    v_mfma_f32_16x16x32_bf16 v[228:231], a[244:247], a[196:199], v[228:231]
    ds_read_b128 a[184:187], v28 offset:32000
    v_mfma_f32_16x16x32_bf16 v[228:231], a[228:231], a[192:195], v[228:231]
    ds_read_b128 a[188:191], v29 offset:32000
    v_mfma_f32_16x16x32_bf16 v[232:235], a[232:235], a[192:195], v[232:235]
    buffer_load_dwordx4 v27, s[28:31], s67 offen offset:0 lds
    v_mfma_f32_16x16x32_bf16 v[232:235], a[248:251], a[196:199], v[232:235]
    v_mfma_f32_16x16x32_bf16 v[236:239], a[252:255], a[196:199], v[236:239]
    buffer_load_dwordx4 v27, s[32:35], s67 offen offset:1024 lds
    v_mfma_f32_16x16x32_bf16 v[236:239], a[236:239], a[192:195], v[236:239]
    s_add_u32 s67, s75, 55296
    s_waitcnt lgkmcnt(4)
    v_mfma_f32_16x16x32_bf16 v[240:243], a[240:243], a[200:203], v[240:243]
    ds_read_b128 a[192:195], v28 offset:33024
    v_mfma_f32_16x16x32_bf16 v[240:243], a[208:211], a[204:207], v[240:243]
    ds_read_b128 a[196:199], v29 offset:33024
    v_mfma_f32_16x16x32_bf16 v[244:247], a[212:215], a[204:207], v[244:247]
    s_waitcnt vmcnt(13)
    v_min3_u32 v43, v47, v48, v43
    v_cmp_eq_u32_e64 vcc, 0, v43
    s_nop 4
    s_cbranch_vccnz Lf_par
Lf_par_r:
    v_mfma_f32_16x16x32_bf16 v[244:247], a[244:247], a[200:203], v[244:247]
    buffer_load_dwordx4 v27, s[28:31], s67 offen offset:2048 lds
    v_mfma_f32_16x16x32_bf16 v[248:251], a[248:251], a[200:203], v[248:251]
    ds_write_b32 v46, v47 offset:0
    v_mfma_f32_16x16x32_bf16 v[248:251], a[216:219], a[204:207], v[248:251]
    ds_write_b32 v46, v48 offset:256
    v_mfma_f32_16x16x32_bf16 v[252:255], a[220:223], a[204:207], v[252:255]
    v_mfma_f32_16x16x32_bf16 v[252:255], a[252:255], a[200:203], v[252:255]
    s_waitcnt lgkmcnt(6)
    s_nop 0
    v_mfma_f32_16x16x32_bf16 v[112:115], a[240:243], a[176:179], v[112:115]
    buffer_load_dwordx4 v27, s[32:35], s67 offen offset:3072 lds
    v_mfma_f32_16x16x32_bf16 v[112:115], a[208:211], a[180:183], v[112:115]
    s_add_u32 m0, s66, 65536
    s_mul_i32 s67, s4, 28
    v_mfma_f32_16x16x32_bf16 v[116:119], a[212:215], a[180:183], v[116:119]
    ds_read_b128 a[200:203], v28 offset:34048
    v_mfma_f32_16x16x32_bf16 v[116:119], a[244:247], a[176:179], v[116:119]
    ds_read_b128 a[204:207], v29 offset:34048
    v_mfma_f32_16x16x32_bf16 v[120:123], a[248:251], a[176:179], v[120:123]
    v_mfma_f32_16x16x32_bf16 v[120:123], a[216:219], a[180:183], v[120:123]
    buffer_load_dwordx4 v2, s[40:43], s67 offen offset:0 lds
    v_mfma_f32_16x16x32_bf16 v[124:127], a[220:223], a[180:183], v[124:127]
    v_mfma_f32_16x16x32_bf16 v[124:127], a[252:255], a[176:179], v[124:127]
    s_waitcnt lgkmcnt(2)
    v_mfma_f32_16x16x32_bf16 v[144:147], a[240:243], a[184:187], v[144:147]
    s_waitcnt vmcnt(9)
    s_barrier
    v_mfma_f32_16x16x32_bf16 v[144:147], a[208:211], a[188:191], v[144:147]
    ds_read_b128 a[176:179], v29 offset:20736
    v_mfma_f32_16x16x32_bf16 v[148:151], a[212:215], a[188:191], v[148:151]
    ds_read_b128 a[180:183], v28 offset:41472
    v_mfma_f32_16x16x32_bf16 v[148:151], a[244:247], a[184:187], v[148:151]
    buffer_load_dwordx4 v3, s[40:43], s67 offen offset:1024 lds
    v_mfma_f32_16x16x32_bf16 v[152:155], a[248:251], a[184:187], v[152:155]
    ds_read_b64_tr_b16 a[224:225], v32 offset:32768
    v_mfma_f32_16x16x32_bf16 v[152:155], a[216:219], a[188:191], v[152:155]
    ds_read_b64_tr_b16 a[226:227], v32 offset:36864
    v_mfma_f32_16x16x32_bf16 v[156:159], a[220:223], a[188:191], v[156:159]
    ds_read_b64_tr_b16 a[228:229], v33 offset:32768
    v_mfma_f32_16x16x32_bf16 v[156:159], a[252:255], a[184:187], v[156:159]
    ds_read_b64_tr_b16 a[230:231], v33 offset:36864
    v_mfma_f32_16x16x32_bf16 v[176:179], a[240:243], a[192:195], v[176:179]
    buffer_load_dwordx4 v4, s[40:43], s67 offen offset:2048 lds
    v_mfma_f32_16x16x32_bf16 v[176:179], a[208:211], a[196:199], v[176:179]
    ds_read_b64_tr_b16 a[232:233], v32 offset:33792
    v_mfma_f32_16x16x32_bf16 v[180:183], a[212:215], a[196:199], v[180:183]
    ds_read_b64_tr_b16 a[234:235], v32 offset:37888
    v_mfma_f32_16x16x32_bf16 v[180:183], a[244:247], a[192:195], v[180:183]
    ds_read_b64_tr_b16 a[236:237], v33 offset:33792
    v_mfma_f32_16x16x32_bf16 v[184:187], a[248:251], a[192:195], v[184:187]
    ds_read_b64_tr_b16 a[238:239], v33 offset:37888
    v_mfma_f32_16x16x32_bf16 v[184:187], a[216:219], a[196:199], v[184:187]
    buffer_load_dwordx4 v5, s[40:43], s67 offen offset:3072 lds
    v_mfma_f32_16x16x32_bf16 v[188:191], a[220:223], a[196:199], v[188:191]
    s_add_u32 s74, s74, 128
    ds_read_b128 a[184:187], v29 offset:21760
    v_mfma_f32_16x16x32_bf16 v[188:191], a[252:255], a[192:195], v[188:191]
    ds_read_b128 a[188:191], v28 offset:42496
    s_waitcnt lgkmcnt(12)
    v_mfma_f32_16x16x32_bf16 v[208:211], a[240:243], a[200:203], v[208:211]
    ds_read_b128 a[192:195], v29 offset:22784
    v_mfma_f32_16x16x32_bf16 v[208:211], a[208:211], a[204:207], v[208:211]
    ds_read_b128 a[196:199], v28 offset:43520
    v_mfma_f32_16x16x32_bf16 v[212:215], a[212:215], a[204:207], v[212:215]
    s_cmp_eq_u32 s74, 896
    s_cselect_b32 s74, 0, s74
    v_mfma_f32_16x16x32_bf16 v[212:215], a[244:247], a[200:203], v[212:215]
    s_add_u32 m0, s65, 0
    ds_read2_b32 v[60:61], v19 offset0:8 offset1:136
    v_mfma_f32_16x16x32_bf16 v[216:219], a[248:251], a[200:203], v[216:219]
    buffer_load_dwordx4 v22, s[24:27], s74 offen offset:0 lds
    v_mfma_f32_16x16x32_bf16 v[216:219], a[216:219], a[204:207], v[216:219]
    ds_read2_b32 v[56:57], v19 offset0:0 offset1:128
    v_mfma_f32_16x16x32_bf16 v[220:223], a[220:223], a[204:207], v[220:223]
    ds_read2_b32 v[68:69], v19 offset0:24 offset1:152
    v_mfma_f32_16x16x32_bf16 v[220:223], a[252:255], a[200:203], v[220:223]
    ds_read2_b32 v[64:65], v19 offset0:16 offset1:144
    s_waitcnt lgkmcnt(8)
    v_mfma_f32_16x16x32_bf16 v[96:99], a[208:211], a[176:179], v[96:99]
    buffer_load_dwordx4 v23, s[24:27], s74 offen offset:1024 lds
    v_mfma_f32_16x16x32_bf16 v[96:99], a[224:227], a[180:183], v[96:99]
    ds_read_b128 a[200:203], v29 offset:23808
    v_mfma_f32_16x16x32_bf16 v[100:103], a[228:231], a[180:183], v[100:103]
    ds_read_b128 a[204:207], v28 offset:44544
    v_mfma_f32_16x16x32_bf16 v[100:103], a[212:215], a[176:179], v[100:103]
    buffer_load_dwordx4 v24, s[24:27], s74 offen offset:2048 lds
    v_mfma_f32_16x16x32_bf16 v[104:107], a[216:219], a[176:179], v[104:107]
    ds_read2_b32 v[76:77], v19 offset0:40 offset1:168
    v_mfma_f32_16x16x32_bf16 v[104:107], a[232:235], a[180:183], v[104:107]
    ds_read2_b32 v[72:73], v19 offset0:32 offset1:160
    v_mfma_f32_16x16x32_bf16 v[108:111], a[236:239], a[180:183], v[108:111]
    ds_read2_b32 v[84:85], v19 offset0:56 offset1:184
    v_mfma_f32_16x16x32_bf16 v[108:111], a[220:223], a[176:179], v[108:111]
    ds_read2_b32 v[80:81], v19 offset0:48 offset1:176
    s_waitcnt lgkmcnt(12)
    v_mfma_f32_16x16x32_bf16 v[128:131], a[208:211], a[184:187], v[128:131]
    buffer_load_dwordx4 v25, s[24:27], s74 offen offset:3072 lds
    v_mfma_f32_16x16x32_bf16 v[128:131], a[224:227], a[188:191], v[128:131]
    s_add_u32 m0, s65, 4096
    ds_read_b128 a[176:179], v29 offset:24832
    v_mfma_f32_16x16x32_bf16 v[132:135], a[228:231], a[188:191], v[132:135]
    ds_read_b128 a[180:183], v28 offset:45568
    v_mfma_f32_16x16x32_bf16 v[132:135], a[212:215], a[184:187], v[132:135]
    ds_read2_b32 v[92:93], v19 offset0:72 offset1:200
    v_mfma_f32_16x16x32_bf16 v[136:139], a[216:219], a[184:187], v[136:139]
    buffer_load_dwordx4 v26, s[24:27], s74 offen offset:0 lds
    v_mfma_f32_16x16x32_bf16 v[136:139], a[232:235], a[188:191], v[136:139]
    s_add_u32 m0, s66, 16384
    s_add_u32 s67, s75, 114688
    v_mfma_f32_16x16x32_bf16 v[140:143], a[236:239], a[188:191], v[140:143]
    ds_read2_b32 v[88:89], v19 offset0:64 offset1:192
    v_mfma_f32_16x16x32_bf16 v[140:143], a[220:223], a[184:187], v[140:143]
    s_waitcnt lgkmcnt(14)
    v_mfma_f32_16x16x32_bf16 v[160:163], a[208:211], a[192:195], v[160:163]
    s_waitcnt vmcnt(13)
    s_barrier
    v_mfma_f32_16x16x32_bf16 v[160:163], a[224:227], a[196:199], v[160:163]
    ds_read_b128 a[184:187], v30 offset:55808
    v_mfma_f32_16x16x32_bf16 v[164:167], a[228:231], a[196:199], v[164:167]
    buffer_load_dwordx4 v27, s[28:31], s67 offen offset:0 lds
    v_mfma_f32_16x16x32_bf16 v[164:167], a[212:215], a[192:195], v[164:167]
    ds_read_b128 a[188:191], v31 offset:55808
    v_mfma_f32_16x16x32_bf16 v[168:171], a[216:219], a[192:195], v[168:171]
    ds_read_b64_tr_b16 a[240:241], v32 offset:49152
    s_waitcnt lgkmcnt(3)
    v_mfma_f32_16x16x32_bf16 v[168:171], a[232:235], a[196:199], v[168:171]
    ds_read_b64_tr_b16 a[242:243], v32 offset:53248
    v_mul_f32 v62, 0xbfb8aa3b, v61
    v_mfma_f32_16x16x32_bf16 v[172:175], a[236:239], a[196:199], v[172:175]
    buffer_load_dwordx4 v27, s[32:35], s67 offen offset:1024 lds
    v_mfma_f32_16x16x32_bf16 v[172:175], a[220:223], a[192:195], v[172:175]
    s_add_u32 s67, s75, 169984
    v_mfma_f32_16x16x32_bf16 v[192:195], a[208:211], a[200:203], v[192:195]
    ds_read_b64_tr_b16 a[244:245], v33 offset:49152
    v_mul_f32 v61, v61, v61
    v_mfma_f32_16x16x32_bf16 v[192:195], a[224:227], a[204:207], v[192:195]
    ds_read_b64_tr_b16 a[246:247], v33 offset:53248
    v_mfma_f32_16x16x32_bf16 v[196:199], a[228:231], a[204:207], v[196:199]
    ds_read_b64_tr_b16 a[248:249], v32 offset:50176
    v_mfma_f32_16x16x32_bf16 v[196:199], a[212:215], a[200:203], v[196:199]
    buffer_load_dwordx4 v27, s[28:31], s67 offen offset:2048 lds
    v_mfma_f32_16x16x32_bf16 v[200:203], a[216:219], a[200:203], v[200:203]
    ds_read_b64_tr_b16 a[250:251], v32 offset:54272
    v_mfma_f32_16x16x32_bf16 v[200:203], a[232:235], a[204:207], v[200:203]
    ds_read_b64_tr_b16 a[252:253], v33 offset:50176
    v_mfma_f32_16x16x32_bf16 v[204:207], a[236:239], a[204:207], v[204:207]
    ds_read_b64_tr_b16 a[254:255], v33 offset:54272
    v_mfma_f32_16x16x32_bf16 v[204:207], a[220:223], a[200:203], v[204:207]
    ds_read_b128 a[192:195], v28 offset:51712
    v_mfma_f32_16x16x32_bf16 v[224:227], a[208:211], a[176:179], v[224:227]
    ds_read_b128 a[196:199], v29 offset:51712
    v_mfma_f32_16x16x32_bf16 v[224:227], a[224:227], a[180:183], v[224:227]
    ds_read_b128 a[200:203], v28 offset:52736
    v_mfma_f32_16x16x32_bf16 v[228:231], a[228:231], a[180:183], v[228:231]
    ds_read_b128 a[204:207], v29 offset:52736
    v_mfma_f32_16x16x32_bf16 v[228:231], a[212:215], a[176:179], v[228:231]
    buffer_load_dwordx4 v27, s[32:35], s67 offen offset:3072 lds
    v_mfma_f32_16x16x32_bf16 v[232:235], a[216:219], a[176:179], v[232:235]
    s_add_u32 m0, s66, 81920
    s_mul_i32 s67, s5, 28
    v_mfma_f32_16x16x32_bf16 v[232:235], a[232:235], a[180:183], v[232:235]
    buffer_load_dwordx4 v2, s[40:43], s67 offen offset:0 lds
    v_mfma_f32_16x16x32_bf16 v[236:239], a[236:239], a[180:183], v[236:239]
    v_rcp_f32 v61, v61
    v_mfma_f32_16x16x32_bf16 v[236:239], a[220:223], a[176:179], v[236:239]
    v_mul_f32 v58, 0xbfb8aa3b, v57
    s_waitcnt lgkmcnt(4)
    v_mfma_f32_16x16x32_bf16 v[240:243], a[224:227], a[184:187], v[240:243]
    ds_read_b128 a[176:179], v28 offset:53760
    v_mul_f32 v57, v57, v57
    v_mfma_f32_16x16x32_bf16 v[240:243], a[240:243], a[188:191], v[240:243]
    buffer_load_dwordx4 v3, s[40:43], s67 offen offset:1024 lds
    v_mfma_f32_16x16x32_bf16 v[244:247], a[244:247], a[188:191], v[244:247]
    ds_read_b128 a[180:183], v29 offset:53760
    v_mfma_f32_16x16x32_bf16 v[244:247], a[228:231], a[184:187], v[244:247]
    v_rcp_f32_e64 v57, v57
    v_mfma_f32_16x16x32_bf16 v[248:251], a[232:235], a[184:187], v[248:251]
    v_mul_f32 v70, 0xbfb8aa3b, v69
    v_mul_f32_e64 v69, v69, v69
    v_mfma_f32_16x16x32_bf16 v[248:251], a[248:251], a[188:191], v[248:251]
    buffer_load_dwordx4 v4, s[40:43], s67 offen offset:2048 lds
    v_mfma_f32_16x16x32_bf16 v[252:255], a[252:255], a[188:191], v[252:255]
    v_rcp_f32_e64 v69, v69
    v_mfma_f32_16x16x32_bf16 v[252:255], a[236:239], a[184:187], v[252:255]
    v_mul_f32 v66, 0xbfb8aa3b, v65
    s_waitcnt lgkmcnt(4)
    v_mfma_f32_16x16x32_bf16 v[112:115], a[224:227], a[192:195], v[112:115]
    ds_read_b128 a[184:187], v28 offset:54784
    v_mul_f32 v65, v65, v65
    v_mfma_f32_16x16x32_bf16 v[112:115], a[240:243], a[196:199], v[112:115]
    ds_read_b128 a[188:191], v29 offset:54784
    s_waitcnt vmcnt(12)
    v_mfma_f32_16x16x32_bf16 v[116:119], a[244:247], a[196:199], v[116:119]
    buffer_load_dwordx4 v5, s[40:43], s67 offen offset:3072 lds
    v_mfma_f32_16x16x32_bf16 v[116:119], a[228:231], a[192:195], v[116:119]
    s_add_u32 m0, s66, 32768
    s_mul_i32 s67, s6, 28
    v_mfma_f32_16x16x32_bf16 v[120:123], a[232:235], a[192:195], v[120:123]
    v_rcp_f32_e64 v65, v65
    v_mfma_f32_16x16x32_bf16 v[120:123], a[248:251], a[196:199], v[120:123]
    v_mul_f32 v78, 0xbfb8aa3b, v77
    v_mul_f32_e64 v77, v77, v77
    v_mfma_f32_16x16x32_bf16 v[124:127], a[252:255], a[196:199], v[124:127]
    buffer_load_dwordx4 v2, s[40:43], s67 offen offset:0 lds
    v_mfma_f32_16x16x32_bf16 v[124:127], a[236:239], a[192:195], v[124:127]
    ds_read_b64_tr_b16 a[0:1], v14 offset:0
    s_waitcnt lgkmcnt(5)
    v_mfma_f32_16x16x32_bf16 v[144:147], a[224:227], a[200:203], v[144:147]
    s_waitcnt vmcnt(9)
    s_barrier
    v_mfma_f32_16x16x32_bf16 v[144:147], a[240:243], a[204:207], v[144:147]
    ds_read_b128 a[192:195], v29 offset:41472
    v_mfma_f32_16x16x32_bf16 v[148:151], a[244:247], a[204:207], v[148:151]
    ds_read_b128 a[196:199], v28 offset:0
    v_mfma_f32_16x16x32_bf16 v[148:151], a[228:231], a[200:203], v[148:151]
    ds_read_b64_tr_b16 a[208:209], v32 offset:0
    v_mfma_f32_16x16x32_bf16 v[152:155], a[232:235], a[200:203], v[152:155]
    buffer_load_dwordx4 v3, s[40:43], s67 offen offset:1024 lds
    v_mfma_f32_16x16x32_bf16 v[152:155], a[248:251], a[204:207], v[152:155]
    ds_read_b64_tr_b16 a[210:211], v32 offset:4096
    v_mfma_f32_16x16x32_bf16 v[156:159], a[252:255], a[204:207], v[156:159]
    ds_read_b64_tr_b16 a[212:213], v33 offset:0
    v_mfma_f32_16x16x32_bf16 v[156:159], a[236:239], a[200:203], v[156:159]
    ds_read_b64_tr_b16 a[214:215], v33 offset:4096
    s_waitcnt lgkmcnt(9)
    v_mfma_f32_16x16x32_bf16 v[176:179], a[224:227], a[176:179], v[176:179]
    buffer_load_dwordx4 v4, s[40:43], s67 offen offset:2048 lds
    v_mfma_f32_16x16x32_bf16 v[176:179], a[240:243], a[180:183], v[176:179]
    ds_read_b64_tr_b16 a[216:217], v32 offset:1024
    v_mfma_f32_16x16x32_bf16 v[180:183], a[244:247], a[180:183], v[180:183]
    ds_read_b64_tr_b16 a[218:219], v32 offset:5120
    v_mfma_f32_16x16x32_bf16 v[180:183], a[228:231], a[176:179], v[180:183]
    ds_read_b64_tr_b16 a[220:221], v33 offset:1024
    v_mfma_f32_16x16x32_bf16 v[184:187], a[232:235], a[176:179], v[184:187]
    ds_read_b64_tr_b16 a[222:223], v33 offset:5120
    v_mfma_f32_16x16x32_bf16 v[184:187], a[248:251], a[180:183], v[184:187]
    buffer_load_dwordx4 v5, s[40:43], s67 offen offset:3072 lds
    v_mfma_f32_16x16x32_bf16 v[188:191], a[252:255], a[180:183], v[188:191]
    s_add_u32 m0, s66, 49152
    s_mul_i32 s67, s7, 28
    v_mfma_f32_16x16x32_bf16 v[188:191], a[236:239], a[176:179], v[188:191]
    ds_read_b128 a[200:203], v29 offset:42496
    s_waitcnt lgkmcnt(12)
    v_mfma_f32_16x16x32_bf16 v[208:211], a[224:227], a[184:187], v[208:211]
    ds_read_b128 a[204:207], v28 offset:1024
    v_mfma_f32_16x16x32_bf16 v[208:211], a[240:243], a[188:191], v[208:211]
    ds_read_b128 a[176:179], v29 offset:43520
    v_mfma_f32_16x16x32_bf16 v[212:215], a[244:247], a[188:191], v[212:215]
    ds_read_b128 a[180:183], v28 offset:2048
    v_mfma_f32_16x16x32_bf16 v[212:215], a[228:231], a[184:187], v[212:215]
    buffer_load_dwordx4 v2, s[40:43], s67 offen offset:0 lds
    v_mfma_f32_16x16x32_bf16 v[216:219], a[232:235], a[184:187], v[216:219]
    v_rcp_f32_e64 v77, v77
    v_mfma_f32_16x16x32_bf16 v[216:219], a[248:251], a[188:191], v[216:219]
    v_mul_f32 v74, 0xbfb8aa3b, v73
    v_mul_f32_e64 v73, v73, v73
    v_mfma_f32_16x16x32_bf16 v[220:223], a[252:255], a[188:191], v[220:223]
    buffer_load_dwordx4 v3, s[40:43], s67 offen offset:1024 lds
    v_mfma_f32_16x16x32_bf16 v[220:223], a[236:239], a[184:187], v[220:223]
    ds_read_b64_tr_b16 a[2:3], v14 offset:2048
    s_waitcnt lgkmcnt(5)
    v_mfma_f32_16x16x32_bf16 v[96:99], a[240:243], a[192:195], v[96:99]
    ds_read_b128 a[184:187], v29 offset:44544
    v_mfma_f32_16x16x32_bf16 v[96:99], a[208:211], a[196:199], v[96:99]
    ds_read_b128 a[188:191], v28 offset:3072
    v_mfma_f32_16x16x32_bf16 v[100:103], a[212:215], a[196:199], v[100:103]
    buffer_load_dwordx4 v4, s[40:43], s67 offen offset:2048 lds
    v_mfma_f32_16x16x32_bf16 v[100:103], a[244:247], a[192:195], v[100:103]
    v_rcp_f32 v73, v73
    v_mfma_f32_16x16x32_bf16 v[104:107], a[248:251], a[192:195], v[104:107]
    v_mul_f32 v86, 0xbfb8aa3b, v85
    v_mul_f32_e64 v85, v85, v85
    v_mfma_f32_16x16x32_bf16 v[104:107], a[216:219], a[196:199], v[104:107]
    v_rcp_f32_e64 v85, v85
    v_mfma_f32_16x16x32_bf16 v[108:111], a[220:223], a[196:199], v[108:111]
    v_mul_f32 v82, 0xbfb8aa3b, v81
    v_mul_f32_e64 v81, v81, v81
    v_mfma_f32_16x16x32_bf16 v[108:111], a[252:255], a[192:195], v[108:111]
    ds_read_b64_tr_b16 a[4:5], v15 offset:0
    s_waitcnt lgkmcnt(6)
    v_mfma_f32_16x16x32_bf16 v[128:131], a[240:243], a[200:203], v[128:131]
    buffer_load_dwordx4 v5, s[40:43], s67 offen offset:3072 lds
    v_mfma_f32_16x16x32_bf16 v[128:131], a[208:211], a[204:207], v[128:131]
    s_add_u32 m0, s65, 20736
    s_mul_i32 s67, s8, 28
    v_mfma_f32_16x16x32_bf16 v[132:135], a[212:215], a[204:207], v[132:135]
    ds_read_b128 a[192:195], v29 offset:45568
    v_mfma_f32_16x16x32_bf16 v[132:135], a[244:247], a[200:203], v[132:135]
    ds_read_b128 a[196:199], v28 offset:4096
    v_mfma_f32_16x16x32_bf16 v[136:139], a[248:251], a[200:203], v[136:139]
    buffer_load_dwordx4 v2, s[40:43], s67 offen offset:0 lds
    v_mfma_f32_16x16x32_bf16 v[136:139], a[216:219], a[204:207], v[136:139]
    v_rcp_f32_e64 v81, v81
    v_mfma_f32_16x16x32_bf16 v[140:143], a[220:223], a[204:207], v[140:143]
    v_mul_f32 v94, 0xbfb8aa3b, v93
    v_mul_f32_e64 v93, v93, v93
    v_mfma_f32_16x16x32_bf16 v[140:143], a[252:255], a[200:203], v[140:143]
    ds_read_b64_tr_b16 a[6:7], v15 offset:2048
    s_waitcnt lgkmcnt(7)
    v_mfma_f32_16x16x32_bf16 v[160:163], a[240:243], a[176:179], v[160:163]
    s_waitcnt vmcnt(13)
    s_barrier
    v_mfma_f32_16x16x32_bf16 v[160:163], a[208:211], a[180:183], v[160:163]
    buffer_load_dwordx4 v3, s[40:43], s67 offen offset:1024 lds
    v_mfma_f32_16x16x32_bf16 v[164:167], a[212:215], a[180:183], v[164:167]
    ds_read_b128 a[200:203], v30 offset:14336
    v_mfma_f32_16x16x32_bf16 v[164:167], a[244:247], a[176:179], v[164:167]
    ds_read_b128 a[204:207], v31 offset:14336
    v_mfma_f32_16x16x32_bf16 v[168:171], a[248:251], a[176:179], v[168:171]
    ds_read_b64_tr_b16 a[224:225], v32 offset:16384
    v_mfma_f32_16x16x32_bf16 v[168:171], a[216:219], a[180:183], v[168:171]
    ds_read_b64_tr_b16 a[226:227], v32 offset:20480
    v_mfma_f32_16x16x32_bf16 v[172:175], a[220:223], a[180:183], v[172:175]
    buffer_load_dwordx4 v4, s[40:43], s67 offen offset:2048 lds
    v_mfma_f32_16x16x32_bf16 v[172:175], a[252:255], a[176:179], v[172:175]
    ds_read_b64_tr_b16 a[228:229], v33 offset:16384
    s_waitcnt lgkmcnt(9)
    v_mfma_f32_16x16x32_bf16 v[192:195], a[240:243], a[184:187], v[192:195]
    ds_read_b64_tr_b16 a[230:231], v33 offset:20480
    v_mfma_f32_16x16x32_bf16 v[192:195], a[208:211], a[188:191], v[192:195]
    ds_read_b64_tr_b16 a[232:233], v32 offset:17408
    v_mfma_f32_16x16x32_bf16 v[196:199], a[212:215], a[188:191], v[196:199]
    buffer_load_dwordx4 v5, s[40:43], s67 offen offset:3072 lds
    v_mfma_f32_16x16x32_bf16 v[196:199], a[244:247], a[184:187], v[196:199]
    s_add_u32 m0, s66, 0
    s_mul_i32 s67, s9, 28
    v_mfma_f32_16x16x32_bf16 v[200:203], a[248:251], a[184:187], v[200:203]
    ds_read_b64_tr_b16 a[234:235], v32 offset:21504
    v_mfma_f32_16x16x32_bf16 v[200:203], a[216:219], a[188:191], v[200:203]
    ds_read_b64_tr_b16 a[236:237], v33 offset:17408
    v_mfma_f32_16x16x32_bf16 v[204:207], a[220:223], a[188:191], v[204:207]
    ds_read_b64_tr_b16 a[238:239], v33 offset:21504
    v_mfma_f32_16x16x32_bf16 v[204:207], a[252:255], a[184:187], v[204:207]
    ds_read_b128 a[176:179], v28 offset:10240
    s_waitcnt lgkmcnt(12)
    v_mfma_f32_16x16x32_bf16 v[224:227], a[240:243], a[192:195], v[224:227]
    ds_read_b128 a[180:183], v29 offset:10240
    v_mfma_f32_16x16x32_bf16 v[224:227], a[208:211], a[196:199], v[224:227]
    ds_read_b128 a[184:187], v28 offset:11264
    v_mfma_f32_16x16x32_bf16 v[228:231], a[212:215], a[196:199], v[228:231]
    ds_read_b128 a[188:191], v29 offset:11264
    v_mfma_f32_16x16x32_bf16 v[228:231], a[244:247], a[192:195], v[228:231]
    buffer_load_dwordx4 v2, s[40:43], s67 offen offset:0 lds
    v_mfma_f32_16x16x32_bf16 v[232:235], a[248:251], a[192:195], v[232:235]
    buffer_load_dwordx4 v3, s[40:43], s67 offen offset:1024 lds
    v_mfma_f32_16x16x32_bf16 v[232:235], a[216:219], a[196:199], v[232:235]
    v_rcp_f32 v93, v93
    v_mfma_f32_16x16x32_bf16 v[236:239], a[220:223], a[196:199], v[236:239]
    v_mul_f32 v90, 0xbfb8aa3b, v89
    v_mul_f32_e64 v89, v89, v89
    v_mfma_f32_16x16x32_bf16 v[236:239], a[252:255], a[192:195], v[236:239]
    ds_read_b64_tr_b16 a[8:9], v16 offset:0
    s_waitcnt lgkmcnt(5)
    v_mfma_f32_16x16x32_bf16 v[240:243], a[208:211], a[200:203], v[240:243]
    buffer_load_dwordx4 v4, s[40:43], s67 offen offset:2048 lds
    v_mfma_f32_16x16x32_bf16 v[240:243], a[224:227], a[204:207], v[240:243]
    ds_read_b128 a[192:195], v28 offset:12288
    v_mfma_f32_16x16x32_bf16 v[244:247], a[228:231], a[204:207], v[244:247]
    ds_read_b128 a[196:199], v29 offset:12288
    v_mfma_f32_16x16x32_bf16 v[244:247], a[212:215], a[200:203], v[244:247]
    v_rcp_f32 v89, v89
    v_mfma_f32_16x16x32_bf16 v[248:251], a[216:219], a[200:203], v[248:251]
    ds_read_b64_tr_b16 a[10:11], v16 offset:2048
    v_mfma_f32_16x16x32_bf16 v[248:251], a[232:235], a[204:207], v[248:251]
    buffer_load_dwordx4 v5, s[40:43], s67 offen offset:3072 lds
    v_mfma_f32_16x16x32_bf16 v[252:255], a[236:239], a[204:207], v[252:255]
    ds_read_b64_tr_b16 a[12:13], v17 offset:0
    v_mfma_f32_16x16x32_bf16 v[252:255], a[220:223], a[200:203], v[252:255]
    ds_read_b64_tr_b16 a[14:15], v17 offset:2048
    s_waitcnt lgkmcnt(8)
    v_mfma_f32_16x16x32_bf16 v[112:115], a[208:211], a[176:179], v[112:115]
    ds_read_b128 a[200:203], v28 offset:13312
    s_waitcnt vmcnt(16)
    v_mfma_f32_16x16x32_bf16 v[112:115], a[224:227], a[180:183], v[112:115]
    ds_read_b128 a[204:207], v29 offset:13312
    v_mfma_f32_16x16x32_bf16 v[116:119], a[228:231], a[180:183], v[116:119]
    ds_read_b64_tr_b16 a[16:17], v14 offset:16384
    v_mfma_f32_16x16x32_bf16 v[116:119], a[212:215], a[176:179], v[116:119]
    ds_read_b64_tr_b16 a[18:19], v14 offset:18432
    v_mfma_f32_16x16x32_bf16 v[120:123], a[216:219], a[176:179], v[120:123]
    s_add_u32 m0, s66, 65536
    s_mul_i32 s67, s10, 28
    v_mfma_f32_16x16x32_bf16 v[120:123], a[232:235], a[180:183], v[120:123]
    s_waitcnt lgkmcnt(4)
    v_mov_b32_dpp v38, v240 row_newbcast:15 row_mask:0xf bank_mask:0xf
    v_mfma_f32_16x16x32_bf16 v[124:127], a[236:239], a[180:183], v[124:127]
    buffer_load_dwordx4 v2, s[40:43], s67 offen offset:0 lds
    v_mfma_f32_16x16x32_bf16 v[124:127], a[220:223], a[176:179], v[124:127]
    v_mov_b32_dpp v39, v241 row_newbcast:15 row_mask:0xf bank_mask:0xf
    v_mfma_f32_16x16x32_bf16 v[144:147], a[208:211], a[184:187], v[144:147]
    s_barrier
    s_nop 0
    v_mfma_f32_16x16x32_bf16 v[144:147], a[224:227], a[188:191], v[144:147]
    buffer_load_dwordx4 v3, s[40:43], s67 offen offset:1024 lds
    v_mfma_f32_16x16x32_bf16 v[148:151], a[228:231], a[188:191], v[148:151]
    ds_read_b128 a[176:179], v29 offset:0
    v_mov_b32_dpp v40, v242 row_newbcast:15 row_mask:0xf bank_mask:0xf
    v_mfma_f32_16x16x32_bf16 v[148:151], a[212:215], a[184:187], v[148:151]
    v_mov_b32_dpp v41, v243 row_newbcast:15 row_mask:0xf bank_mask:0xf
    v_mov_b32_dpp v42, v244 row_newbcast:15 row_mask:0xf bank_mask:0xf
    v_mfma_f32_16x16x32_bf16 v[152:155], a[216:219], a[184:187], v[152:155]
    buffer_load_dwordx4 v4, s[40:43], s67 offen offset:2048 lds
    v_mfma_f32_16x16x32_bf16 v[152:155], a[232:235], a[188:191], v[152:155]
    v_mov_b32_dpp v43, v245 row_newbcast:15 row_mask:0xf bank_mask:0xf
    v_mov_b32_dpp v44, v246 row_newbcast:15 row_mask:0xf bank_mask:0xf
    v_mfma_f32_16x16x32_bf16 v[156:159], a[236:239], a[188:191], v[156:159]
    v_mov_b32_dpp v45, v247 row_newbcast:15 row_mask:0xf bank_mask:0xf
    v_mov_b32_dpp v46, v248 row_newbcast:15 row_mask:0xf bank_mask:0xf
    v_mfma_f32_16x16x32_bf16 v[156:159], a[220:223], a[184:187], v[156:159]
    v_mov_b32_dpp v47, v249 row_newbcast:15 row_mask:0xf bank_mask:0xf
    v_mfma_f32_16x16x32_bf16 v[176:179], a[208:211], a[192:195], v[176:179]
    ds_read_b128 a[184:187], v29 offset:1024
    v_mov_b32_dpp v48, v250 row_newbcast:15 row_mask:0xf bank_mask:0xf
    v_mfma_f32_16x16x32_bf16 v[176:179], a[224:227], a[196:199], v[176:179]
    buffer_load_dwordx4 v5, s[40:43], s67 offen offset:3072 lds
    v_mfma_f32_16x16x32_bf16 v[180:183], a[228:231], a[196:199], v[180:183]
    s_add_u32 m0, s66, 16384
    s_mul_i32 s67, s11, 28
    v_mfma_f32_16x16x32_bf16 v[180:183], a[212:215], a[192:195], v[180:183]
    v_mov_b32_dpp v49, v251 row_newbcast:15 row_mask:0xf bank_mask:0xf
    v_mov_b32_dpp v50, v252 row_newbcast:15 row_mask:0xf bank_mask:0xf
    v_mfma_f32_16x16x32_bf16 v[184:187], a[216:219], a[192:195], v[184:187]
    v_mov_b32_dpp v51, v253 row_newbcast:15 row_mask:0xf bank_mask:0xf
    v_mov_b32_dpp v52, v254 row_newbcast:15 row_mask:0xf bank_mask:0xf
    v_mfma_f32_16x16x32_bf16 v[184:187], a[232:235], a[196:199], v[184:187]
    buffer_load_dwordx4 v2, s[40:43], s67 offen offset:0 lds
    v_mfma_f32_16x16x32_bf16 v[188:191], a[236:239], a[196:199], v[188:191]
    v_mov_b32_dpp v53, v255 row_newbcast:15 row_mask:0xf bank_mask:0xf
    ds_read_b64_tr_b16 a[20:21], v15 offset:16384
    v_mfma_f32_16x16x32_bf16 v[188:191], a[220:223], a[192:195], v[188:191]
    ds_read_b64_tr_b16 a[22:23], v15 offset:18432
    s_waitcnt lgkmcnt(6)
    v_mfma_f32_16x16x32_bf16 v[208:211], a[208:211], a[200:203], v[208:211]
    ds_read_b128 a[192:195], v29 offset:2048
    v_mfma_f32_16x16x32_bf16 v[208:211], a[224:227], a[204:207], v[208:211]
    ds_read_b64_tr_b16 a[24:25], v16 offset:16384
    v_mfma_f32_16x16x32_bf16 v[212:215], a[228:231], a[204:207], v[212:215]
    buffer_load_dwordx4 v3, s[40:43], s67 offen offset:1024 lds
    v_mfma_f32_16x16x32_bf16 v[212:215], a[212:215], a[200:203], v[212:215]
    ds_read_b64_tr_b16 a[26:27], v16 offset:18432
    v_mfma_f32_16x16x32_bf16 v[216:219], a[216:219], a[200:203], v[216:219]
    ds_read_b64_tr_b16 a[28:29], v17 offset:16384
    v_mfma_f32_16x16x32_bf16 v[216:219], a[232:235], a[204:207], v[216:219]
    ds_read_b64_tr_b16 a[30:31], v17 offset:18432
    s_waitcnt vmcnt(18)
    v_mfma_f32_16x16x32_bf16 v[220:223], a[236:239], a[204:207], v[220:223]
    buffer_load_dwordx4 v4, s[40:43], s67 offen offset:2048 lds
    v_mfma_f32_16x16x32_bf16 v[220:223], a[220:223], a[200:203], v[220:223]
    ds_read_b64_tr_b16 a[32:33], v10 offset:32768
    s_waitcnt lgkmcnt(9)
    v_mfma_f32_16x16x32_bf16 v[96:99], a[224:227], a[176:179], v[96:99]
    ds_read_b128 a[200:203], v29 offset:3072
    v_mfma_f32_16x16x32_bf16 v[100:103], a[228:231], a[176:179], v[100:103]
    ds_read_b64_tr_b16 a[34:35], v10 offset:34816
    v_mfma_f32_16x16x32_bf16 v[104:107], a[232:235], a[176:179], v[104:107]
    ds_read_b64_tr_b16 a[36:37], v11 offset:32768
    v_mfma_f32_16x16x32_bf16 v[108:111], a[236:239], a[176:179], v[108:111]
    ds_read_b64_tr_b16 a[38:39], v11 offset:34816
    s_waitcnt lgkmcnt(12)
    v_mfma_f32_16x16x32_bf16 v[140:143], a[236:239], a[184:187], v[140:143]
    buffer_load_dwordx4 v5, s[40:43], s67 offen offset:3072 lds
    v_mfma_f32_16x16x32_bf16 v[136:139], a[232:235], a[184:187], v[136:139]
    s_add_u32 m0, s66, 81920
    s_mul_i32 s67, s12, 28
    v_mfma_f32_16x16x32_bf16 v[132:135], a[228:231], a[184:187], v[132:135]
    s_waitcnt lgkmcnt(5)
    ds_read_b128 a[176:179], v29 offset:4096
    v_mfma_f32_16x16x32_bf16 v[128:131], a[224:227], a[184:187], v[128:131]
    ds_read_b64_tr_b16 a[40:41], v12 offset:32768
    v_mfma_f32_16x16x32_bf16 v[160:163], a[224:227], a[192:195], v[160:163]
    buffer_load_dwordx4 v2, s[40:43], s67 offen offset:0 lds
    v_mfma_f32_16x16x32_bf16 v[164:167], a[228:231], a[192:195], v[164:167]
    ds_read_b64_tr_b16 a[42:43], v12 offset:34816
    v_mfma_f32_16x16x32_bf16 v[168:171], a[232:235], a[192:195], v[168:171]
    ds_read_b64_tr_b16 a[44:45], v13 offset:32768
    v_mfma_f32_16x16x32_bf16 v[172:175], a[236:239], a[192:195], v[172:175]
    ds_read_b64_tr_b16 a[46:47], v13 offset:34816
    s_waitcnt lgkmcnt(8)
    v_mfma_f32_16x16x32_bf16 v[204:207], a[236:239], a[200:203], v[204:207]
    buffer_load_dwordx4 v3, s[40:43], s67 offen offset:1024 lds
    v_mfma_f32_16x16x32_bf16 v[200:203], a[232:235], a[200:203], v[200:203]
    s_waitcnt vmcnt(18)
    ds_read_b64_tr_b16 a[48:49], v10 offset:49152
    v_mfma_f32_16x16x32_bf16 v[196:199], a[228:231], a[200:203], v[196:199]
    ds_read_b64_tr_b16 a[50:51], v10 offset:51200
    v_mfma_f32_16x16x32_bf16 v[192:195], a[224:227], a[200:203], v[192:195]
    ds_read_b64_tr_b16 a[52:53], v11 offset:49152
    s_waitcnt lgkmcnt(7)
    v_mfma_f32_16x16x32_bf16 v[224:227], a[224:227], a[176:179], v[224:227]
    s_barrier
    s_nop 0
    v_mfma_f32_16x16x32_bf16 v[228:231], a[228:231], a[176:179], v[228:231]
    buffer_load_dwordx4 v4, s[40:43], s67 offen offset:2048 lds
    v_mfma_f32_16x16x32_bf16 v[232:235], a[232:235], a[176:179], v[232:235]
    ds_read_b64_tr_b16 a[54:55], v11 offset:51200
    v_mfma_f32_16x16x32_bf16 v[236:239], a[236:239], a[176:179], v[236:239]
    ds_read_b64_tr_b16 a[56:57], v12 offset:49152
    v_pk_fma_f32 v[112:113], v[38:39], v[60:61], v[112:113] op_sel_hi:[1,0,1]
    v_pk_fma_f32 v[114:115], v[40:41], v[60:61], v[114:115] op_sel_hi:[1,0,1]
    v_pk_fma_f32 v[116:117], v[42:43], v[60:61], v[116:117] op_sel_hi:[1,0,1]
    v_pk_fma_f32 v[118:119], v[44:45], v[60:61], v[118:119] op_sel_hi:[1,0,1]
    v_pk_fma_f32 v[120:121], v[46:47], v[60:61], v[120:121] op_sel_hi:[1,0,1]
    v_pk_fma_f32 v[122:123], v[48:49], v[60:61], v[122:123] op_sel_hi:[1,0,1]
    v_pk_fma_f32 v[124:125], v[50:51], v[60:61], v[124:125] op_sel_hi:[1,0,1]
    v_pk_fma_f32 v[126:127], v[52:53], v[60:61], v[126:127] op_sel_hi:[1,0,1]
    v_pk_mul_f32 v[22:23], v[112:113], v[62:63] op_sel_hi:[1,0]
    v_pk_mul_f32 v[24:25], v[114:115], v[62:63] op_sel_hi:[1,0]
    v_pk_mul_f32 v[26:27], v[116:117], v[62:63] op_sel_hi:[1,0]
    v_pk_mul_f32 v[28:29], v[118:119], v[62:63] op_sel_hi:[1,0]
    v_exp_f32_e64 v22, v22
    ds_read_b64_tr_b16 a[58:59], v12 offset:51200
    v_exp_f32_e64 v23, v23
    ds_read_b64_tr_b16 a[60:61], v13 offset:49152
    v_exp_f32_e64 v24, v24
    buffer_load_dwordx4 v5, s[40:43], s67 offen offset:3072 lds
    v_exp_f32_e64 v25, v25
    s_add_u32 m0, s66, 32768
    s_mul_i32 s67, s13, 28
    v_exp_f32_e64 v26, v26
    s_waitcnt lgkmcnt(7)
    ds_read_b64_tr_b16 a[62:63], v13 offset:51200
    v_exp_f32 v27, v27
    s_waitcnt vmcnt(16)
    ds_read_b64_tr_b16 a[64:65], v6 offset:20736
    v_exp_f32_e64 v28, v28
    buffer_load_dwordx4 v2, s[40:43], s67 offen offset:0 lds
    v_exp_f32_e64 v29, v29
    ds_read_b64_tr_b16 a[66:67], v6 offset:22784
    v_pk_mul_f32 v[112:113], v[112:113], v[120:121]
    v_pk_mul_f32 v[114:115], v[114:115], v[122:123]
    v_pk_mul_f32 v[116:117], v[116:117], v[124:125]
    v_pk_mul_f32 v[118:119], v[118:119], v[126:127]
    v_pk_fma_f32 v[22:23], v[22:23], v[60:61], v[60:61] op_sel:[0,1,1] op_sel_hi:[1,1,1]
    v_pk_fma_f32 v[24:25], v[24:25], v[60:61], v[60:61] op_sel:[0,1,1] op_sel_hi:[1,1,1]
    v_pk_fma_f32 v[26:27], v[26:27], v[60:61], v[60:61] op_sel:[0,1,1] op_sel_hi:[1,1,1]
    v_pk_fma_f32 v[28:29], v[28:29], v[60:61], v[60:61] op_sel:[0,1,1] op_sel_hi:[1,1,1]
    v_rcp_f32_e64 v22, v22
    ds_read_b64_tr_b16 a[68:69], v7 offset:20736
    v_rcp_f32_e64 v23, v23
    ds_read_b64_tr_b16 a[70:71], v7 offset:22784
    v_rcp_f32_e64 v24, v24
    buffer_load_dwordx4 v3, s[40:43], s67 offen offset:1024 lds
    v_rcp_f32_e64 v25, v25
    ds_read_b64_tr_b16 a[72:73], v8 offset:20736
    v_rcp_f32_e64 v26, v26
    ds_read_b64_tr_b16 a[74:75], v8 offset:22784
    v_rcp_f32_e64 v27, v27
    ds_read_b64_tr_b16 a[76:77], v9 offset:20736
    v_rcp_f32_e64 v28, v28
    buffer_load_dwordx4 v4, s[40:43], s67 offen offset:2048 lds
    v_rcp_f32_e64 v29, v29
    ds_read_b64_tr_b16 a[78:79], v9 offset:22784
    s_waitcnt vmcnt(15)
    s_nop 0
    v_pk_mul_f32 v[112:113], v[112:113], v[22:23]
    v_pk_mul_f32 v[114:115], v[114:115], v[24:25]
    v_pk_mul_f32 v[116:117], v[116:117], v[26:27]
    v_pk_mul_f32 v[118:119], v[118:119], v[28:29]
    s_add_u32 s63, s70, 368640
    v_cvt_pk_bf16_f32 v34, v112, v113
    v_cvt_pk_bf16_f32 v35, v114, v115
    v_cvt_pk_bf16_f32 v36, v116, v117
    v_cvt_pk_bf16_f32 v37, v118, v119
    buffer_store_dwordx4 v[34:37], v18, s[36:39], s63 offen sc1
    v_pk_fma_f32 v[96:97], v[38:39], v[56:57], v[96:97] op_sel_hi:[1,0,1]
    v_pk_fma_f32 v[98:99], v[40:41], v[56:57], v[98:99] op_sel_hi:[1,0,1]
    v_pk_fma_f32 v[100:101], v[42:43], v[56:57], v[100:101] op_sel_hi:[1,0,1]
    v_pk_fma_f32 v[102:103], v[44:45], v[56:57], v[102:103] op_sel_hi:[1,0,1]
    v_pk_fma_f32 v[104:105], v[46:47], v[56:57], v[104:105] op_sel_hi:[1,0,1]
    v_pk_fma_f32 v[106:107], v[48:49], v[56:57], v[106:107] op_sel_hi:[1,0,1]
    v_pk_fma_f32 v[108:109], v[50:51], v[56:57], v[108:109] op_sel_hi:[1,0,1]
    v_pk_fma_f32 v[110:111], v[52:53], v[56:57], v[110:111] op_sel_hi:[1,0,1]
    v_pk_mul_f32 v[22:23], v[96:97], v[58:59] op_sel_hi:[1,0]
    v_pk_mul_f32 v[24:25], v[98:99], v[58:59] op_sel_hi:[1,0]
    v_pk_mul_f32 v[26:27], v[100:101], v[58:59] op_sel_hi:[1,0]
    v_pk_mul_f32 v[28:29], v[102:103], v[58:59] op_sel_hi:[1,0]
    v_exp_f32_e64 v22, v22
    ds_read_b64_tr_b16 a[80:81], v10 offset:0
    v_exp_f32_e64 v23, v23
    ds_read_b64_tr_b16 a[82:83], v10 offset:2048
    v_exp_f32_e64 v24, v24
    buffer_load_dwordx4 v5, s[40:43], s67 offen offset:3072 lds
    v_exp_f32_e64 v25, v25
    s_add_u32 m0, s66, 49152
    s_mul_i32 s67, s14, 28
    v_exp_f32_e64 v26, v26
    s_waitcnt lgkmcnt(10)
    ds_read_b64_tr_b16 a[84:85], v11 offset:0
    v_exp_f32_e64 v27, v27
    ds_read_b64_tr_b16 a[86:87], v11 offset:2048
    v_exp_f32_e64 v28, v28
    buffer_load_dwordx4 v2, s[40:43], s67 offen offset:0 lds
    v_exp_f32_e64 v29, v29
    ds_read_b64_tr_b16 a[88:89], v12 offset:0
    v_pk_mul_f32 v[96:97], v[96:97], v[104:105]
    v_pk_mul_f32 v[98:99], v[98:99], v[106:107]
    v_pk_mul_f32 v[100:101], v[100:101], v[108:109]
    v_pk_mul_f32 v[102:103], v[102:103], v[110:111]
    v_pk_fma_f32 v[22:23], v[22:23], v[56:57], v[56:57] op_sel:[0,1,1] op_sel_hi:[1,1,1]
    v_pk_fma_f32 v[24:25], v[24:25], v[56:57], v[56:57] op_sel:[0,1,1] op_sel_hi:[1,1,1]
    v_pk_fma_f32 v[26:27], v[26:27], v[56:57], v[56:57] op_sel:[0,1,1] op_sel_hi:[1,1,1]
    v_pk_fma_f32 v[28:29], v[28:29], v[56:57], v[56:57] op_sel:[0,1,1] op_sel_hi:[1,1,1]
    v_rcp_f32_e64 v22, v22
    ds_read_b64_tr_b16 a[90:91], v12 offset:2048
    v_rcp_f32_e64 v23, v23
    ds_read_b64_tr_b16 a[92:93], v13 offset:0
    v_rcp_f32_e64 v24, v24
    buffer_load_dwordx4 v3, s[40:43], s67 offen offset:1024 lds
    v_rcp_f32_e64 v25, v25
    ds_read_b64_tr_b16 a[94:95], v13 offset:2048
    s_waitcnt vmcnt(15)
    v_rcp_f32 v26, v26
    ds_read_b64_tr_b16 a[96:97], v14 offset:0
    v_rcp_f32_e64 v27, v27
    ds_read_b64_tr_b16 a[98:99], v14 offset:2048
    v_rcp_f32_e64 v28, v28
    buffer_load_dwordx4 v4, s[40:43], s67 offen offset:2048 lds
    v_rcp_f32_e64 v29, v29
    ds_read_b64_tr_b16 a[100:101], v15 offset:0
    v_pk_mul_f32 v[96:97], v[96:97], v[22:23]
    v_pk_mul_f32 v[98:99], v[98:99], v[24:25]
    v_pk_mul_f32 v[100:101], v[100:101], v[26:27]
    v_pk_mul_f32 v[102:103], v[102:103], v[28:29]
    s_add_u32 s63, s70, 0
    s_nop 0
    v_cvt_pk_bf16_f32 v30, v96, v97
    v_cvt_pk_bf16_f32 v31, v98, v99
    v_cvt_pk_bf16_f32 v32, v100, v101
    v_cvt_pk_bf16_f32 v33, v102, v103
    buffer_store_dwordx4 v[30:33], v18, s[36:39], s63 offen sc1
    v_pk_fma_f32 v[144:145], v[38:39], v[68:69], v[144:145] op_sel_hi:[1,0,1]
    v_pk_fma_f32 v[146:147], v[40:41], v[68:69], v[146:147] op_sel_hi:[1,0,1]
    v_pk_fma_f32 v[148:149], v[42:43], v[68:69], v[148:149] op_sel_hi:[1,0,1]
    v_pk_fma_f32 v[150:151], v[44:45], v[68:69], v[150:151] op_sel_hi:[1,0,1]
    v_pk_fma_f32 v[152:153], v[46:47], v[68:69], v[152:153] op_sel_hi:[1,0,1]
    v_pk_fma_f32 v[154:155], v[48:49], v[68:69], v[154:155] op_sel_hi:[1,0,1]
    v_pk_fma_f32 v[156:157], v[50:51], v[68:69], v[156:157] op_sel_hi:[1,0,1]
    v_pk_fma_f32 v[158:159], v[52:53], v[68:69], v[158:159] op_sel_hi:[1,0,1]
    v_pk_mul_f32 v[22:23], v[144:145], v[70:71] op_sel_hi:[1,0]
    v_pk_mul_f32 v[24:25], v[146:147], v[70:71] op_sel_hi:[1,0]
    v_pk_mul_f32 v[26:27], v[148:149], v[70:71] op_sel_hi:[1,0]
    v_pk_mul_f32 v[28:29], v[150:151], v[70:71] op_sel_hi:[1,0]
    v_exp_f32_e64 v22, v22
    ds_read_b64_tr_b16 a[102:103], v15 offset:2048
    v_exp_f32_e64 v23, v23
    ds_read_b64_tr_b16 a[104:105], v16 offset:0
    v_exp_f32_e64 v24, v24
    buffer_load_dwordx4 v5, s[40:43], s67 offen offset:3072 lds
    v_exp_f32_e64 v25, v25
    s_add_u32 m0, s65, 20736
    s_mul_i32 s67, s15, 28
    v_exp_f32_e64 v26, v26
    s_waitcnt lgkmcnt(13)
    ds_read_b64_tr_b16 a[106:107], v16 offset:2048
    v_exp_f32_e64 v27, v27
    ds_read_b64_tr_b16 a[108:109], v17 offset:0
    v_exp_f32_e64 v28, v28
    buffer_load_dwordx4 v2, s[40:43], s67 offen offset:0 lds
    v_exp_f32_e64 v29, v29
    ds_read_b64_tr_b16 a[110:111], v17 offset:2048
    s_waitcnt vmcnt(15)
    s_nop 0
    v_pk_mul_f32 v[144:145], v[144:145], v[152:153]
    v_pk_mul_f32 v[146:147], v[146:147], v[154:155]
    v_pk_mul_f32 v[148:149], v[148:149], v[156:157]
    v_pk_mul_f32 v[150:151], v[150:151], v[158:159]
    v_pk_fma_f32 v[22:23], v[22:23], v[68:69], v[68:69] op_sel:[0,1,1] op_sel_hi:[1,1,1]
    v_pk_fma_f32 v[24:25], v[24:25], v[68:69], v[68:69] op_sel:[0,1,1] op_sel_hi:[1,1,1]
    v_pk_fma_f32 v[26:27], v[26:27], v[68:69], v[68:69] op_sel:[0,1,1] op_sel_hi:[1,1,1]
    v_pk_fma_f32 v[28:29], v[28:29], v[68:69], v[68:69] op_sel:[0,1,1] op_sel_hi:[1,1,1]
    v_rcp_f32_e64 v22, v22
    ds_read_b64_tr_b16 a[112:113], v10 offset:16384
    v_rcp_f32_e64 v23, v23
    ds_read_b64_tr_b16 a[114:115], v10 offset:18432
    v_rcp_f32_e64 v24, v24
    buffer_load_dwordx4 v3, s[40:43], s67 offen offset:1024 lds
    v_rcp_f32_e64 v25, v25
    ds_read_b64_tr_b16 a[116:117], v11 offset:16384
    v_rcp_f32_e64 v26, v26
    ds_read_b64_tr_b16 a[118:119], v11 offset:18432
    v_rcp_f32_e64 v27, v27
    ds_read_b64_tr_b16 a[120:121], v12 offset:16384
    v_rcp_f32_e64 v28, v28
    buffer_load_dwordx4 v4, s[40:43], s67 offen offset:2048 lds
    v_rcp_f32_e64 v29, v29
    ds_read_b64_tr_b16 a[122:123], v12 offset:18432
    v_pk_mul_f32 v[144:145], v[144:145], v[22:23]
    v_pk_mul_f32 v[146:147], v[146:147], v[24:25]
    v_pk_mul_f32 v[148:149], v[148:149], v[26:27]
    v_pk_mul_f32 v[150:151], v[150:151], v[28:29]
    s_add_u32 s63, s70, 442368
    v_cvt_pk_bf16_f32 v34, v144, v145
    v_cvt_pk_bf16_f32 v35, v146, v147
    v_cvt_pk_bf16_f32 v36, v148, v149
    v_cvt_pk_bf16_f32 v37, v150, v151
    buffer_store_dwordx4 v[34:37], v18, s[36:39], s63 offen sc1
    v_pk_fma_f32 v[128:129], v[38:39], v[64:65], v[128:129] op_sel_hi:[1,0,1]
    v_pk_fma_f32 v[130:131], v[40:41], v[64:65], v[130:131] op_sel_hi:[1,0,1]
    v_pk_fma_f32 v[132:133], v[42:43], v[64:65], v[132:133] op_sel_hi:[1,0,1]
    v_pk_fma_f32 v[134:135], v[44:45], v[64:65], v[134:135] op_sel_hi:[1,0,1]
    v_pk_fma_f32 v[136:137], v[46:47], v[64:65], v[136:137] op_sel_hi:[1,0,1]
    v_pk_fma_f32 v[138:139], v[48:49], v[64:65], v[138:139] op_sel_hi:[1,0,1]
    v_pk_fma_f32 v[140:141], v[50:51], v[64:65], v[140:141] op_sel_hi:[1,0,1]
    v_pk_fma_f32 v[142:143], v[52:53], v[64:65], v[142:143] op_sel_hi:[1,0,1]
    v_pk_mul_f32 v[22:23], v[128:129], v[66:67] op_sel_hi:[1,0]
    v_pk_mul_f32 v[24:25], v[130:131], v[66:67] op_sel_hi:[1,0]
    v_pk_mul_f32 v[26:27], v[132:133], v[66:67] op_sel_hi:[1,0]
    v_pk_mul_f32 v[28:29], v[134:135], v[66:67] op_sel_hi:[1,0]
    v_exp_f32_e64 v22, v22
    ds_read_b64_tr_b16 a[124:125], v13 offset:16384
    v_exp_f32_e64 v23, v23
    ds_read_b64_tr_b16 a[126:127], v13 offset:18432
    s_waitcnt vmcnt(14)
    v_exp_f32 v24, v24
    buffer_load_dwordx4 v5, s[40:43], s67 offen offset:3072 lds
    v_exp_f32_e64 v25, v25
    s_add_u32 m0, s66, 65536
    s_mul_i32 s67, s16, 28
    v_exp_f32_e64 v26, v26
    s_waitcnt lgkmcnt(8)
    ds_read_b64_tr_b16 a[128:129], v14 offset:16384
    v_exp_f32_e64 v27, v27
    ds_read_b64_tr_b16 a[130:131], v14 offset:18432
    v_exp_f32_e64 v28, v28
    buffer_load_dwordx4 v2, s[40:43], s67 offen offset:0 lds
    v_exp_f32_e64 v29, v29
    ds_read_b64_tr_b16 a[132:133], v15 offset:16384
    v_pk_mul_f32 v[128:129], v[128:129], v[136:137]
    v_pk_mul_f32 v[130:131], v[130:131], v[138:139]
    v_pk_mul_f32 v[132:133], v[132:133], v[140:141]
    v_pk_mul_f32 v[134:135], v[134:135], v[142:143]
    v_pk_fma_f32 v[22:23], v[22:23], v[64:65], v[64:65] op_sel:[0,1,1] op_sel_hi:[1,1,1]
    v_pk_fma_f32 v[24:25], v[24:25], v[64:65], v[64:65] op_sel:[0,1,1] op_sel_hi:[1,1,1]
    v_pk_fma_f32 v[26:27], v[26:27], v[64:65], v[64:65] op_sel:[0,1,1] op_sel_hi:[1,1,1]
    v_pk_fma_f32 v[28:29], v[28:29], v[64:65], v[64:65] op_sel:[0,1,1] op_sel_hi:[1,1,1]
    v_rcp_f32_e64 v22, v22
    ds_read_b64_tr_b16 a[134:135], v15 offset:18432
    v_rcp_f32_e64 v23, v23
    ds_read_b64_tr_b16 a[136:137], v16 offset:16384
    v_rcp_f32_e64 v24, v24
    buffer_load_dwordx4 v3, s[40:43], s67 offen offset:1024 lds
    v_rcp_f32_e64 v25, v25
    ds_read_b64_tr_b16 a[138:139], v16 offset:18432
    v_rcp_f32_e64 v26, v26
    ds_read_b64_tr_b16 a[140:141], v17 offset:16384
    v_rcp_f32_e64 v27, v27
    ds_read_b64_tr_b16 a[142:143], v17 offset:18432
    v_rcp_f32_e64 v28, v28
    buffer_load_dwordx4 v4, s[40:43], s67 offen offset:2048 lds
    v_rcp_f32_e64 v29, v29
    v_pk_mul_f32 v[128:129], v[128:129], v[22:23]
    v_pk_mul_f32 v[130:131], v[130:131], v[24:25]
    v_pk_mul_f32 v[132:133], v[132:133], v[26:27]
    v_pk_mul_f32 v[134:135], v[134:135], v[28:29]
    s_add_u32 s63, s70, 73728
    v_cvt_pk_bf16_f32 v30, v128, v129
    v_cvt_pk_bf16_f32 v31, v130, v131
    v_cvt_pk_bf16_f32 v32, v132, v133
    v_cvt_pk_bf16_f32 v33, v134, v135
    buffer_store_dwordx4 v[30:33], v18, s[36:39], s63 offen sc1
    v_pk_fma_f32 v[176:177], v[38:39], v[76:77], v[176:177] op_sel_hi:[1,0,1]
    v_pk_fma_f32 v[178:179], v[40:41], v[76:77], v[178:179] op_sel_hi:[1,0,1]
    v_pk_fma_f32 v[180:181], v[42:43], v[76:77], v[180:181] op_sel_hi:[1,0,1]
    v_pk_fma_f32 v[182:183], v[44:45], v[76:77], v[182:183] op_sel_hi:[1,0,1]
    v_pk_fma_f32 v[184:185], v[46:47], v[76:77], v[184:185] op_sel_hi:[1,0,1]
    v_pk_fma_f32 v[186:187], v[48:49], v[76:77], v[186:187] op_sel_hi:[1,0,1]
    v_pk_fma_f32 v[188:189], v[50:51], v[76:77], v[188:189] op_sel_hi:[1,0,1]
    v_pk_fma_f32 v[190:191], v[52:53], v[76:77], v[190:191] op_sel_hi:[1,0,1]
    v_pk_mul_f32 v[22:23], v[176:177], v[78:79] op_sel_hi:[1,0]
    v_pk_mul_f32 v[24:25], v[178:179], v[78:79] op_sel_hi:[1,0]
    v_pk_mul_f32 v[26:27], v[180:181], v[78:79] op_sel_hi:[1,0]
    v_pk_mul_f32 v[28:29], v[182:183], v[78:79] op_sel_hi:[1,0]
    v_exp_f32_e64 v22, v22
    v_exp_f32 v23, v23
    v_exp_f32 v24, v24
    buffer_load_dwordx4 v5, s[40:43], s67 offen offset:3072 lds
    v_exp_f32_e64 v25, v25
    s_add_u32 m0, s66, 81920
    s_mul_i32 s67, s17, 28
    v_exp_f32_e64 v26, v26
    s_waitcnt lgkmcnt(0)
    v_exp_f32 v27, v27
    v_exp_f32 v28, v28
    buffer_load_dwordx4 v2, s[40:43], s67 offen offset:0 lds
    v_exp_f32_e64 v29, v29
    v_pk_mul_f32 v[176:177], v[176:177], v[184:185]
    v_pk_mul_f32 v[178:179], v[178:179], v[186:187]
    v_pk_mul_f32 v[180:181], v[180:181], v[188:189]
    v_pk_mul_f32 v[182:183], v[182:183], v[190:191]
    v_pk_fma_f32 v[22:23], v[22:23], v[76:77], v[76:77] op_sel:[0,1,1] op_sel_hi:[1,1,1]
    v_pk_fma_f32 v[24:25], v[24:25], v[76:77], v[76:77] op_sel:[0,1,1] op_sel_hi:[1,1,1]
    v_pk_fma_f32 v[26:27], v[26:27], v[76:77], v[76:77] op_sel:[0,1,1] op_sel_hi:[1,1,1]
    v_pk_fma_f32 v[28:29], v[28:29], v[76:77], v[76:77] op_sel:[0,1,1] op_sel_hi:[1,1,1]
    v_rcp_f32_e64 v22, v22
    v_rcp_f32 v23, v23
    v_rcp_f32 v24, v24
    buffer_load_dwordx4 v3, s[40:43], s67 offen offset:1024 lds
    v_rcp_f32 v25, v25
    v_rcp_f32 v26, v26
    v_rcp_f32 v27, v27
    v_rcp_f32 v28, v28
    buffer_load_dwordx4 v4, s[40:43], s67 offen offset:2048 lds
    v_rcp_f32_e64 v29, v29
    v_pk_mul_f32 v[176:177], v[176:177], v[22:23]
    v_pk_mul_f32 v[178:179], v[178:179], v[24:25]
    v_pk_mul_f32 v[180:181], v[180:181], v[26:27]
    v_pk_mul_f32 v[182:183], v[182:183], v[28:29]
    s_add_u32 s63, s70, 516096
    v_cvt_pk_bf16_f32 v34, v176, v177
    v_cvt_pk_bf16_f32 v35, v178, v179
    v_cvt_pk_bf16_f32 v36, v180, v181
    v_cvt_pk_bf16_f32 v37, v182, v183
    buffer_store_dwordx4 v[34:37], v18, s[36:39], s63 offen sc1
    s_waitcnt vmcnt(15)
    s_add_u32 s64, s3, 0
    buffer_atomic_add v20, v1, s[36:39], s64 offen sc1
    v_pk_fma_f32 v[160:161], v[38:39], v[72:73], v[160:161] op_sel_hi:[1,0,1]
    v_pk_fma_f32 v[162:163], v[40:41], v[72:73], v[162:163] op_sel_hi:[1,0,1]
    v_pk_fma_f32 v[164:165], v[42:43], v[72:73], v[164:165] op_sel_hi:[1,0,1]
    v_pk_fma_f32 v[166:167], v[44:45], v[72:73], v[166:167] op_sel_hi:[1,0,1]
    v_pk_fma_f32 v[168:169], v[46:47], v[72:73], v[168:169] op_sel_hi:[1,0,1]
    v_pk_fma_f32 v[170:171], v[48:49], v[72:73], v[170:171] op_sel_hi:[1,0,1]
    v_pk_fma_f32 v[172:173], v[50:51], v[72:73], v[172:173] op_sel_hi:[1,0,1]
    v_pk_fma_f32 v[174:175], v[52:53], v[72:73], v[174:175] op_sel_hi:[1,0,1]
    v_pk_mul_f32 v[22:23], v[160:161], v[74:75] op_sel_hi:[1,0]
    v_pk_mul_f32 v[24:25], v[162:163], v[74:75] op_sel_hi:[1,0]
    v_pk_mul_f32 v[26:27], v[164:165], v[74:75] op_sel_hi:[1,0]
    v_pk_mul_f32 v[28:29], v[166:167], v[74:75] op_sel_hi:[1,0]
    v_exp_f32_e64 v22, v22
    v_exp_f32 v23, v23
    v_exp_f32 v24, v24
    buffer_load_dwordx4 v5, s[40:43], s67 offen offset:3072 lds
    v_exp_f32 v25, v25
    s_add_u32 m0, s66, 0
    s_mov_b32 s67, 0
    v_exp_f32 v26, v26
    v_exp_f32 v27, v27
    v_exp_f32 v28, v28
    buffer_load_dwordx4 v2, s[44:47], s67 offen offset:0 lds
    v_exp_f32_e64 v29, v29
    v_pk_mul_f32 v[160:161], v[160:161], v[168:169]
    v_pk_mul_f32 v[162:163], v[162:163], v[170:171]
    v_pk_mul_f32 v[164:165], v[164:165], v[172:173]
    v_pk_mul_f32 v[166:167], v[166:167], v[174:175]
    v_pk_fma_f32 v[22:23], v[22:23], v[72:73], v[72:73] op_sel:[0,1,1] op_sel_hi:[1,1,1]
    v_pk_fma_f32 v[24:25], v[24:25], v[72:73], v[72:73] op_sel:[0,1,1] op_sel_hi:[1,1,1]
    v_pk_fma_f32 v[26:27], v[26:27], v[72:73], v[72:73] op_sel:[0,1,1] op_sel_hi:[1,1,1]
    v_pk_fma_f32 v[28:29], v[28:29], v[72:73], v[72:73] op_sel:[0,1,1] op_sel_hi:[1,1,1]
    v_rcp_f32_e64 v22, v22
    v_rcp_f32 v23, v23
    v_rcp_f32 v24, v24
    buffer_load_dwordx4 v3, s[44:47], s67 offen offset:1024 lds
    v_rcp_f32 v25, v25
    v_rcp_f32 v26, v26
    v_rcp_f32 v27, v27
    v_rcp_f32 v28, v28
    buffer_load_dwordx4 v4, s[44:47], s67 offen offset:2048 lds
    v_rcp_f32_e64 v29, v29
    v_pk_mul_f32 v[160:161], v[160:161], v[22:23]
    v_pk_mul_f32 v[162:163], v[162:163], v[24:25]
    v_pk_mul_f32 v[164:165], v[164:165], v[26:27]
    v_pk_mul_f32 v[166:167], v[166:167], v[28:29]
    s_add_u32 s63, s70, 147456
    v_cvt_pk_bf16_f32 v30, v160, v161
    v_cvt_pk_bf16_f32 v31, v162, v163
    v_cvt_pk_bf16_f32 v32, v164, v165
    v_cvt_pk_bf16_f32 v33, v166, v167
    buffer_store_dwordx4 v[30:33], v18, s[36:39], s63 offen sc1
    v_pk_fma_f32 v[208:209], v[38:39], v[84:85], v[208:209] op_sel_hi:[1,0,1]
    v_pk_fma_f32 v[210:211], v[40:41], v[84:85], v[210:211] op_sel_hi:[1,0,1]
    v_pk_fma_f32 v[212:213], v[42:43], v[84:85], v[212:213] op_sel_hi:[1,0,1]
    v_pk_fma_f32 v[214:215], v[44:45], v[84:85], v[214:215] op_sel_hi:[1,0,1]
    v_pk_fma_f32 v[216:217], v[46:47], v[84:85], v[216:217] op_sel_hi:[1,0,1]
    v_pk_fma_f32 v[218:219], v[48:49], v[84:85], v[218:219] op_sel_hi:[1,0,1]
    v_pk_fma_f32 v[220:221], v[50:51], v[84:85], v[220:221] op_sel_hi:[1,0,1]
    v_pk_fma_f32 v[222:223], v[52:53], v[84:85], v[222:223] op_sel_hi:[1,0,1]
    v_pk_mul_f32 v[22:23], v[208:209], v[86:87] op_sel_hi:[1,0]
    v_pk_mul_f32 v[24:25], v[210:211], v[86:87] op_sel_hi:[1,0]
    v_pk_mul_f32 v[26:27], v[212:213], v[86:87] op_sel_hi:[1,0]
    v_pk_mul_f32 v[28:29], v[214:215], v[86:87] op_sel_hi:[1,0]
    v_exp_f32_e64 v22, v22
    v_exp_f32 v23, v23
    v_exp_f32 v24, v24
    buffer_load_dwordx4 v21, s[44:47], s67 offen offset:3072 lds
    v_exp_f32_e64 v25, v25
    s_add_u32 m0, s66, 16384
    s_mov_b32 s67, 25088
    v_exp_f32_e64 v26, v26
    v_exp_f32 v27, v27
    v_exp_f32 v28, v28
    buffer_load_dwordx4 v2, s[44:47], s67 offen offset:0 lds
    v_exp_f32_e64 v29, v29
    v_pk_mul_f32 v[208:209], v[208:209], v[216:217]
    v_pk_mul_f32 v[210:211], v[210:211], v[218:219]
    v_pk_mul_f32 v[212:213], v[212:213], v[220:221]
    v_pk_mul_f32 v[214:215], v[214:215], v[222:223]
    v_pk_fma_f32 v[22:23], v[22:23], v[84:85], v[84:85] op_sel:[0,1,1] op_sel_hi:[1,1,1]
    v_pk_fma_f32 v[24:25], v[24:25], v[84:85], v[84:85] op_sel:[0,1,1] op_sel_hi:[1,1,1]
    v_pk_fma_f32 v[26:27], v[26:27], v[84:85], v[84:85] op_sel:[0,1,1] op_sel_hi:[1,1,1]
    v_pk_fma_f32 v[28:29], v[28:29], v[84:85], v[84:85] op_sel:[0,1,1] op_sel_hi:[1,1,1]
    v_rcp_f32_e64 v22, v22
    v_rcp_f32 v23, v23
    v_rcp_f32 v24, v24
    buffer_load_dwordx4 v3, s[44:47], s67 offen offset:1024 lds
    v_rcp_f32 v25, v25
    v_rcp_f32 v26, v26
    v_rcp_f32 v27, v27
    v_rcp_f32 v28, v28
    buffer_load_dwordx4 v4, s[44:47], s67 offen offset:2048 lds
    v_rcp_f32_e64 v29, v29
    v_pk_mul_f32 v[208:209], v[208:209], v[22:23]
    v_pk_mul_f32 v[210:211], v[210:211], v[24:25]
    v_pk_mul_f32 v[212:213], v[212:213], v[26:27]
    v_pk_mul_f32 v[214:215], v[214:215], v[28:29]
    s_add_u32 s63, s70, 589824
    v_cvt_pk_bf16_f32 v34, v208, v209
    v_cvt_pk_bf16_f32 v35, v210, v211
    v_cvt_pk_bf16_f32 v36, v212, v213
    v_cvt_pk_bf16_f32 v37, v214, v215
    buffer_store_dwordx4 v[34:37], v18, s[36:39], s63 offen sc1
    s_waitcnt vmcnt(16)
    s_nop 0
    s_add_u32 s64, s3, 8192
    buffer_atomic_add v20, v1, s[36:39], s64 offen sc1
    v_pk_fma_f32 v[192:193], v[38:39], v[80:81], v[192:193] op_sel_hi:[1,0,1]
    v_pk_fma_f32 v[194:195], v[40:41], v[80:81], v[194:195] op_sel_hi:[1,0,1]
    v_pk_fma_f32 v[196:197], v[42:43], v[80:81], v[196:197] op_sel_hi:[1,0,1]
    v_pk_fma_f32 v[198:199], v[44:45], v[80:81], v[198:199] op_sel_hi:[1,0,1]
    v_pk_fma_f32 v[200:201], v[46:47], v[80:81], v[200:201] op_sel_hi:[1,0,1]
    v_pk_fma_f32 v[202:203], v[48:49], v[80:81], v[202:203] op_sel_hi:[1,0,1]
    v_pk_fma_f32 v[204:205], v[50:51], v[80:81], v[204:205] op_sel_hi:[1,0,1]
    v_pk_fma_f32 v[206:207], v[52:53], v[80:81], v[206:207] op_sel_hi:[1,0,1]
    v_pk_mul_f32 v[22:23], v[192:193], v[82:83] op_sel_hi:[1,0]
    v_pk_mul_f32 v[24:25], v[194:195], v[82:83] op_sel_hi:[1,0]
    v_pk_mul_f32 v[26:27], v[196:197], v[82:83] op_sel_hi:[1,0]
    v_pk_mul_f32 v[28:29], v[198:199], v[82:83] op_sel_hi:[1,0]
    v_exp_f32_e64 v22, v22
    v_exp_f32 v23, v23
    v_exp_f32 v24, v24
    buffer_load_dwordx4 v21, s[44:47], s67 offen offset:3072 lds
    v_exp_f32_e64 v25, v25
    s_add_u32 m0, s65, 41472
    s_mov_b32 s67, 50176
    v_exp_f32_e64 v26, v26
    v_exp_f32 v27, v27
    v_exp_f32 v28, v28
    buffer_load_dwordx4 v2, s[44:47], s67 offen offset:0 lds
    v_exp_f32_e64 v29, v29
    v_pk_mul_f32 v[192:193], v[192:193], v[200:201]
    v_pk_mul_f32 v[194:195], v[194:195], v[202:203]
    v_pk_mul_f32 v[196:197], v[196:197], v[204:205]
    v_pk_mul_f32 v[198:199], v[198:199], v[206:207]
    v_pk_fma_f32 v[22:23], v[22:23], v[80:81], v[80:81] op_sel:[0,1,1] op_sel_hi:[1,1,1]
    v_pk_fma_f32 v[24:25], v[24:25], v[80:81], v[80:81] op_sel:[0,1,1] op_sel_hi:[1,1,1]
    v_pk_fma_f32 v[26:27], v[26:27], v[80:81], v[80:81] op_sel:[0,1,1] op_sel_hi:[1,1,1]
    v_pk_fma_f32 v[28:29], v[28:29], v[80:81], v[80:81] op_sel:[0,1,1] op_sel_hi:[1,1,1]
    v_rcp_f32_e64 v22, v22
    v_rcp_f32 v23, v23
    v_rcp_f32 v24, v24
    buffer_load_dwordx4 v3, s[44:47], s67 offen offset:1024 lds
    v_rcp_f32 v25, v25
    v_rcp_f32 v26, v26
    v_rcp_f32 v27, v27
    v_rcp_f32 v28, v28
    buffer_load_dwordx4 v4, s[44:47], s67 offen offset:2048 lds
    v_rcp_f32_e64 v29, v29
    v_pk_mul_f32 v[192:193], v[192:193], v[22:23]
    v_pk_mul_f32 v[194:195], v[194:195], v[24:25]
    v_pk_mul_f32 v[196:197], v[196:197], v[26:27]
    v_pk_mul_f32 v[198:199], v[198:199], v[28:29]
    s_add_u32 s63, s70, 221184
    v_cvt_pk_bf16_f32 v30, v192, v193
    v_cvt_pk_bf16_f32 v31, v194, v195
    v_cvt_pk_bf16_f32 v32, v196, v197
    v_cvt_pk_bf16_f32 v33, v198, v199
    buffer_store_dwordx4 v[30:33], v18, s[36:39], s63 offen sc1
    v_pk_fma_f32 v[240:241], v[38:39], v[92:93], v[240:241] op_sel_hi:[1,0,1]
    v_pk_fma_f32 v[242:243], v[40:41], v[92:93], v[242:243] op_sel_hi:[1,0,1]
    v_pk_fma_f32 v[244:245], v[42:43], v[92:93], v[244:245] op_sel_hi:[1,0,1]
    v_pk_fma_f32 v[246:247], v[44:45], v[92:93], v[246:247] op_sel_hi:[1,0,1]
    v_pk_fma_f32 v[248:249], v[46:47], v[92:93], v[248:249] op_sel_hi:[1,0,1]
    v_pk_fma_f32 v[250:251], v[48:49], v[92:93], v[250:251] op_sel_hi:[1,0,1]
    v_pk_fma_f32 v[252:253], v[50:51], v[92:93], v[252:253] op_sel_hi:[1,0,1]
    v_pk_fma_f32 v[254:255], v[52:53], v[92:93], v[254:255] op_sel_hi:[1,0,1]
    v_pk_mul_f32 v[22:23], v[240:241], v[94:95] op_sel_hi:[1,0]
    v_pk_mul_f32 v[24:25], v[242:243], v[94:95] op_sel_hi:[1,0]
    v_pk_mul_f32 v[26:27], v[244:245], v[94:95] op_sel_hi:[1,0]
    v_pk_mul_f32 v[28:29], v[246:247], v[94:95] op_sel_hi:[1,0]
    v_exp_f32_e64 v22, v22
    v_exp_f32 v23, v23
    v_exp_f32 v24, v24
    buffer_load_dwordx4 v21, s[44:47], s67 offen offset:3072 lds
    v_exp_f32 v25, v25
    s_add_u32 m0, s65, 0
    s_mov_b32 s67, 75264
    v_exp_f32_e64 v26, v26
    v_exp_f32 v27, v27
    v_exp_f32 v28, v28
    buffer_load_dwordx4 v2, s[44:47], s67 offen offset:0 lds
    v_exp_f32_e64 v29, v29
    v_pk_mul_f32 v[240:241], v[240:241], v[248:249]
    v_pk_mul_f32 v[242:243], v[242:243], v[250:251]
    v_pk_mul_f32 v[244:245], v[244:245], v[252:253]
    v_pk_mul_f32 v[246:247], v[246:247], v[254:255]
    v_pk_fma_f32 v[22:23], v[22:23], v[92:93], v[92:93] op_sel:[0,1,1] op_sel_hi:[1,1,1]
    v_pk_fma_f32 v[24:25], v[24:25], v[92:93], v[92:93] op_sel:[0,1,1] op_sel_hi:[1,1,1]
    v_pk_fma_f32 v[26:27], v[26:27], v[92:93], v[92:93] op_sel:[0,1,1] op_sel_hi:[1,1,1]
    v_pk_fma_f32 v[28:29], v[28:29], v[92:93], v[92:93] op_sel:[0,1,1] op_sel_hi:[1,1,1]
    v_rcp_f32_e64 v22, v22
    v_rcp_f32 v23, v23
    v_rcp_f32 v24, v24
    buffer_load_dwordx4 v3, s[44:47], s67 offen offset:1024 lds
    v_rcp_f32 v25, v25
    v_rcp_f32 v26, v26
    v_rcp_f32 v27, v27
    v_rcp_f32 v28, v28
    buffer_load_dwordx4 v4, s[44:47], s67 offen offset:2048 lds
    v_rcp_f32_e64 v29, v29
    v_pk_mul_f32 v[240:241], v[240:241], v[22:23]
    v_pk_mul_f32 v[242:243], v[242:243], v[24:25]
    v_pk_mul_f32 v[244:245], v[244:245], v[26:27]
    v_pk_mul_f32 v[246:247], v[246:247], v[28:29]
    s_add_u32 s63, s70, 663552
    v_cvt_pk_bf16_f32 v34, v240, v241
    v_cvt_pk_bf16_f32 v35, v242, v243
    v_cvt_pk_bf16_f32 v36, v244, v245
    v_cvt_pk_bf16_f32 v37, v246, v247
    buffer_store_dwordx4 v[34:37], v18, s[36:39], s63 offen sc1
    s_waitcnt vmcnt(16)
    s_nop 0
    s_add_u32 s64, s3, 16384
    buffer_atomic_add v20, v1, s[36:39], s64 offen sc1
    s_load_dword s72, s[76:77], 0 glc
    v_pk_fma_f32 v[224:225], v[38:39], v[88:89], v[224:225] op_sel_hi:[1,0,1]
    v_pk_fma_f32 v[226:227], v[40:41], v[88:89], v[226:227] op_sel_hi:[1,0,1]
    v_pk_fma_f32 v[228:229], v[42:43], v[88:89], v[228:229] op_sel_hi:[1,0,1]
    v_pk_fma_f32 v[230:231], v[44:45], v[88:89], v[230:231] op_sel_hi:[1,0,1]
    v_pk_fma_f32 v[232:233], v[46:47], v[88:89], v[232:233] op_sel_hi:[1,0,1]
    v_pk_fma_f32 v[234:235], v[48:49], v[88:89], v[234:235] op_sel_hi:[1,0,1]
    v_pk_fma_f32 v[236:237], v[50:51], v[88:89], v[236:237] op_sel_hi:[1,0,1]
    v_pk_fma_f32 v[238:239], v[52:53], v[88:89], v[238:239] op_sel_hi:[1,0,1]
    v_pk_mul_f32 v[22:23], v[224:225], v[90:91] op_sel_hi:[1,0]
    v_pk_mul_f32 v[24:25], v[226:227], v[90:91] op_sel_hi:[1,0]
    v_pk_mul_f32 v[26:27], v[228:229], v[90:91] op_sel_hi:[1,0]
    v_pk_mul_f32 v[28:29], v[230:231], v[90:91] op_sel_hi:[1,0]
    v_exp_f32_e64 v22, v22
    v_exp_f32 v23, v23
    v_exp_f32 v24, v24
    buffer_load_dwordx4 v21, s[44:47], s67 offen offset:3072 lds
    v_exp_f32_e64 v25, v25
    v_exp_f32 v26, v26
    v_exp_f32 v27, v27
    v_exp_f32 v28, v28
    v_exp_f32 v29, v29
    v_pk_mul_f32 v[224:225], v[224:225], v[232:233]
    v_pk_mul_f32 v[226:227], v[226:227], v[234:235]
    v_pk_mul_f32 v[228:229], v[228:229], v[236:237]
    v_pk_mul_f32 v[230:231], v[230:231], v[238:239]
    v_pk_fma_f32 v[22:23], v[22:23], v[88:89], v[88:89] op_sel:[0,1,1] op_sel_hi:[1,1,1]
    v_pk_fma_f32 v[24:25], v[24:25], v[88:89], v[88:89] op_sel:[0,1,1] op_sel_hi:[1,1,1]
    v_pk_fma_f32 v[26:27], v[26:27], v[88:89], v[88:89] op_sel:[0,1,1] op_sel_hi:[1,1,1]
    v_pk_fma_f32 v[28:29], v[28:29], v[88:89], v[88:89] op_sel:[0,1,1] op_sel_hi:[1,1,1]
    v_rcp_f32 v22, v22
    v_rcp_f32 v23, v23
    v_rcp_f32 v24, v24
    v_rcp_f32 v25, v25
    v_rcp_f32 v26, v26
    v_rcp_f32 v27, v27
    v_rcp_f32 v28, v28
    v_rcp_f32 v29, v29
    v_pk_mul_f32 v[224:225], v[224:225], v[22:23]
    v_pk_mul_f32 v[226:227], v[226:227], v[24:25]
    v_pk_mul_f32 v[228:229], v[228:229], v[26:27]
    v_pk_mul_f32 v[230:231], v[230:231], v[28:29]
    s_add_u32 s63, s70, 294912
    v_cvt_pk_bf16_f32 v30, v224, v225
    v_cvt_pk_bf16_f32 v31, v226, v227
    v_cvt_pk_bf16_f32 v32, v228, v229
    v_cvt_pk_bf16_f32 v33, v230, v231
    buffer_store_dwordx4 v[30:33], v18, s[36:39], s63 offen sc1
    v_add_u32 v88, s68, v18
    s_waitcnt lgkmcnt(0)
    s_cmp_eq_u32 s72, 14
    s_cbranch_scc0 Lf_p0
Lf_p0_r:
    s_load_dword s79, s[76:77], 8192 glc
    buffer_load_dwordx4 v[96:99], v88, s[36:39], s4 offen sc1
    ds_read_b64_tr_b16 a[144:145], v10 offset:32768
    ds_read_b64_tr_b16 a[146:147], v10 offset:34816
    ds_read_b64_tr_b16 a[148:149], v11 offset:32768
    buffer_load_dwordx4 v[100:103], v88, s[36:39], s5 offen sc1
    ds_read_b64_tr_b16 a[150:151], v11 offset:34816
    ds_read_b64_tr_b16 a[152:153], v12 offset:32768
    ds_read_b64_tr_b16 a[154:155], v12 offset:34816
    ds_read_b64_tr_b16 a[156:157], v13 offset:32768
    buffer_load_dwordx4 v[104:107], v88, s[36:39], s6 offen sc1
    ds_read_b64_tr_b16 a[158:159], v13 offset:34816
    ds_read_b64_tr_b16 a[160:161], v10 offset:49152
    ds_read_b64_tr_b16 a[162:163], v10 offset:51200
    buffer_load_dwordx4 v[108:111], v88, s[36:39], s7 offen sc1
    ds_read_b64_tr_b16 a[164:165], v11 offset:49152
    ds_read_b64_tr_b16 a[166:167], v11 offset:51200
    ds_read_b64_tr_b16 a[168:169], v12 offset:49152
    ds_read_b64_tr_b16 a[170:171], v12 offset:51200
    buffer_load_dwordx4 v[112:115], v88, s[36:39], s8 offen sc1
    ds_read_b64_tr_b16 a[172:173], v13 offset:49152
    ds_read_b64_tr_b16 a[174:175], v13 offset:51200
    ds_read_b64_tr_b16 a[176:177], v6 offset:20736
    buffer_load_dwordx4 v[116:119], v88, s[36:39], s9 offen sc1
    ds_read_b64_tr_b16 a[178:179], v6 offset:22784
    ds_read_b64_tr_b16 a[180:181], v7 offset:20736
    ds_read_b64_tr_b16 a[182:183], v7 offset:22784
    ds_read_b64_tr_b16 a[184:185], v8 offset:20736
    buffer_load_dwordx4 v[120:123], v88, s[36:39], s10 offen sc1
    ds_read_b64_tr_b16 a[186:187], v8 offset:22784
    ds_read_b64_tr_b16 a[188:189], v9 offset:20736
    ds_read_b64_tr_b16 a[190:191], v9 offset:22784
    buffer_load_dwordx4 v[124:127], v88, s[36:39], s11 offen sc1
    ds_read_b64_tr_b16 a[192:193], v14 offset:0
    ds_read_b64_tr_b16 a[194:195], v14 offset:2048
    ds_read_b64_tr_b16 a[196:197], v15 offset:0
    ds_read_b64_tr_b16 a[198:199], v15 offset:2048
    buffer_load_dwordx4 v[128:131], v88, s[36:39], s12 offen sc1
    ds_read_b64_tr_b16 a[200:201], v16 offset:0
    ds_read_b64_tr_b16 a[202:203], v16 offset:2048
    ds_read_b64_tr_b16 a[204:205], v17 offset:0
    ds_read_b64_tr_b16 a[206:207], v17 offset:2048
    buffer_load_dwordx4 v[132:135], v88, s[36:39], s13 offen sc1
    ds_read_b64_tr_b16 a[208:209], v14 offset:16384
    ds_read_b64_tr_b16 a[210:211], v14 offset:18432
    ds_read_b64_tr_b16 a[212:213], v15 offset:16384
    ds_read_b64_tr_b16 a[214:215], v15 offset:18432
    ds_read_b64_tr_b16 a[216:217], v16 offset:16384
    ds_read_b64_tr_b16 a[218:219], v16 offset:18432
    ds_read_b64_tr_b16 a[220:221], v17 offset:16384
    ds_read_b64_tr_b16 a[222:223], v17 offset:18432
    v_add_u32 v89, 73728, v88
    s_waitcnt lgkmcnt(0)
    s_cmp_eq_u32 s79, 14
    s_cbranch_scc0 Lf_p1
Lf_p1_r:
    s_waitcnt vmcnt(10)
    s_atomic_add s73, s[82:83], 24576
    s_waitcnt vmcnt(8)
    v_mfma_f32_16x16x32_bf16 v[176:179], a[0:3], v[96:99], 0
    buffer_load_dwordx4 v[136:139], v88, s[36:39], s14 offen sc1
    v_mfma_f32_16x16x32_bf16 v[176:179], a[16:19], v[100:103], v[176:179]
    ds_read_b64_tr_b16 a[224:225], v10 offset:0
    v_mfma_f32_16x16x32_bf16 v[180:183], a[4:7], v[96:99], 0
    ds_read_b64_tr_b16 a[226:227], v10 offset:2048
    v_add_u32 v90, 147456, v88
    v_mfma_f32_16x16x32_bf16 v[180:183], a[20:23], v[100:103], v[180:183]
    ds_read_b64_tr_b16 a[228:229], v11 offset:0
    v_add_u32 v91, 221184, v88
    v_mfma_f32_16x16x32_bf16 v[184:187], a[8:11], v[96:99], 0
    buffer_load_dwordx4 v[140:143], v88, s[36:39], s15 offen sc1
    v_mfma_f32_16x16x32_bf16 v[184:187], a[24:27], v[100:103], v[184:187]
    ds_read_b64_tr_b16 a[230:231], v11 offset:2048
    v_add_u32 v92, 294912, v88
    v_mfma_f32_16x16x32_bf16 v[188:191], a[12:15], v[96:99], 0
    ds_read_b64_tr_b16 a[232:233], v12 offset:0
    s_lshr_b32 s61, s58, 1
    v_mfma_f32_16x16x32_bf16 v[188:191], a[28:31], v[100:103], v[188:191]
    ds_read_b64_tr_b16 a[234:235], v12 offset:2048
    s_waitcnt vmcnt(8)
    v_mfma_f32_16x16x32_bf16 v[176:179], a[32:35], v[104:107], v[176:179]
    buffer_load_dwordx4 v[96:99], v88, s[36:39], s16 offen sc1
    v_mfma_f32_16x16x32_bf16 v[176:179], a[48:51], v[108:111], v[176:179]
    ds_read_b64_tr_b16 a[236:237], v13 offset:0
    s_mul_i32 s61, s61, 158
    v_mfma_f32_16x16x32_bf16 v[180:183], a[52:55], v[108:111], v[180:183]
    ds_read_b64_tr_b16 a[238:239], v13 offset:2048
    v_mfma_f32_16x16x32_bf16 v[180:183], a[36:39], v[104:107], v[180:183]
    ds_read_b64_tr_b16 a[240:241], v10 offset:16384
    s_and_b32 s62, s58, 1
    v_mfma_f32_16x16x32_bf16 v[184:187], a[40:43], v[104:107], v[184:187]
    buffer_load_dwordx4 v[100:103], v88, s[36:39], s17 offen sc1
    v_mfma_f32_16x16x32_bf16 v[184:187], a[56:59], v[108:111], v[184:187]
    ds_read_b64_tr_b16 a[242:243], v10 offset:18432
    s_and_b32 s63, s60, 1
    v_mfma_f32_16x16x32_bf16 v[188:191], a[60:63], v[108:111], v[188:191]
    ds_read_b64_tr_b16 a[244:245], v11 offset:16384
    s_lshl1_add_u32 s62, s62, s63
    v_mfma_f32_16x16x32_bf16 v[188:191], a[44:47], v[104:107], v[188:191]
    ds_read_b64_tr_b16 a[246:247], v11 offset:18432
    s_waitcnt vmcnt(8)
    v_mfma_f32_16x16x32_bf16 v[176:179], a[64:67], v[112:115], v[176:179]
    buffer_load_dwordx4 v[104:107], v89, s[36:39], s4 offen sc1
    v_mfma_f32_16x16x32_bf16 v[176:179], a[80:83], v[116:119], v[176:179]
    ds_read_b64_tr_b16 a[248:249], v12 offset:16384
    s_lshr_b32 s64, s60, 1
    v_mfma_f32_16x16x32_bf16 v[180:183], a[84:87], v[116:119], v[180:183]
    ds_read_b64_tr_b16 a[250:251], v12 offset:18432
    s_lshl3_add_u32 s62, s62, s64
    v_mfma_f32_16x16x32_bf16 v[180:183], a[68:71], v[112:115], v[180:183]
    ds_read_b64_tr_b16 a[252:253], v13 offset:16384
    v_lshl_add_u32 v48, v55, 1, s62
    v_mfma_f32_16x16x32_bf16 v[184:187], a[72:75], v[112:115], v[184:187]
    buffer_load_dwordx4 v[108:111], v89, s[36:39], s5 offen sc1
    v_mfma_f32_16x16x32_bf16 v[184:187], a[88:91], v[116:119], v[184:187]
    ds_read_b64_tr_b16 a[254:255], v13 offset:18432
    v_mfma_f32_16x16x32_bf16 v[188:191], a[92:95], v[116:119], v[188:191]
    ds_read_b64_tr_b16 v[56:57], v6 offset:41472
    v_add_u32 v49, s61, v48
    v_mfma_f32_16x16x32_bf16 v[188:191], a[76:79], v[112:115], v[188:191]
    ds_read_b64_tr_b16 v[58:59], v6 offset:43520
    s_waitcnt vmcnt(8)
    v_mfma_f32_16x16x32_bf16 v[176:179], a[96:99], v[120:123], v[176:179]
    buffer_load_dwordx4 v[112:115], v89, s[36:39], s6 offen sc1
    v_mfma_f32_16x16x32_bf16 v[176:179], a[112:115], v[124:127], v[176:179]
    ds_read_b64_tr_b16 v[60:61], v7 offset:41472
    v_mul_u32_u24 v49, 896, v49
    v_mfma_f32_16x16x32_bf16 v[180:183], a[116:119], v[124:127], v[180:183]
    ds_read_b64_tr_b16 v[62:63], v7 offset:43520
    v_and_b32 v51, 15, v0
    v_mfma_f32_16x16x32_bf16 v[180:183], a[100:103], v[120:123], v[180:183]
    ds_read_b64_tr_b16 v[64:65], v8 offset:41472
    v_lshlrev_b32_e64 v50, 3, v51
    v_mfma_f32_16x16x32_bf16 v[184:187], a[104:107], v[120:123], v[184:187]
    buffer_load_dwordx4 v[116:119], v89, s[36:39], s7 offen sc1
    v_mfma_f32_16x16x32_bf16 v[184:187], a[120:123], v[124:127], v[184:187]
    ds_read_b64_tr_b16 v[66:67], v8 offset:43520
    s_lshl_b32 s61, s59, 7
    v_mfma_f32_16x16x32_bf16 v[188:191], a[124:127], v[124:127], v[188:191]
    ds_read_b64_tr_b16 v[68:69], v9 offset:41472
    v_add3_u32 v22, v49, v50, s61
    v_mfma_f32_16x16x32_bf16 v[188:191], a[108:111], v[120:123], v[188:191]
    ds_read_b64_tr_b16 v[70:71], v9 offset:43520
    s_waitcnt vmcnt(8)
    v_mfma_f32_16x16x32_bf16 v[176:179], a[128:131], v[128:131], v[176:179]
    buffer_load_dwordx4 v[120:123], v89, s[36:39], s8 offen sc1
    v_mfma_f32_16x16x32_bf16 v[176:179], a[144:147], v[132:135], v[176:179]
    ds_read_b64_tr_b16 v[72:73], v6 offset:0
    v_mfma_f32_16x16x32_bf16 v[180:183], a[148:151], v[132:135], v[180:183]
    ds_read_b64_tr_b16 v[74:75], v6 offset:2048
    v_add_u32 v23, 28672, v22
    v_mfma_f32_16x16x32_bf16 v[180:183], a[132:135], v[128:131], v[180:183]
    ds_read_b64_tr_b16 v[76:77], v7 offset:0
    v_add_u32 v24, 57344, v22
    v_mfma_f32_16x16x32_bf16 v[184:187], a[136:139], v[128:131], v[184:187]
    buffer_load_dwordx4 v[124:127], v89, s[36:39], s9 offen sc1
    v_mfma_f32_16x16x32_bf16 v[184:187], a[152:155], v[132:135], v[184:187]
    s_load_dword s72, s[76:77], 16384 glc
    ds_read_b64_tr_b16 v[78:79], v7 offset:2048
    v_mfma_f32_16x16x32_bf16 v[188:191], a[156:159], v[132:135], v[188:191]
    ds_read_b64_tr_b16 v[80:81], v8 offset:0
    v_add_u32 v25, 86016, v22
    v_mfma_f32_16x16x32_bf16 v[188:191], a[140:143], v[128:131], v[188:191]
    ds_read_b64_tr_b16 v[82:83], v8 offset:2048
    s_waitcnt vmcnt(8)
    v_mfma_f32_16x16x32_bf16 v[176:179], a[160:163], v[136:139], v[176:179]
    buffer_load_dwordx4 v[128:131], v89, s[36:39], s10 offen sc1
    v_mfma_f32_16x16x32_bf16 v[176:179], a[176:179], v[140:143], v[176:179]
    ds_read_b64_tr_b16 v[84:85], v9 offset:0
    v_add_u32 v26, 114688, v22
    v_mfma_f32_16x16x32_bf16 v[180:183], a[180:183], v[140:143], v[180:183]
    ds_read_b64_tr_b16 v[86:87], v9 offset:2048
    v_cmp_gt_u32 vcc, 30, v48
    v_mfma_f32_16x16x32_bf16 v[180:183], a[164:167], v[136:139], v[180:183]
    v_mov_b32 v49, 2147483632
    v_and_b32_e64 v50, 7, v0
    v_mfma_f32_16x16x32_bf16 v[184:187], a[168:171], v[136:139], v[184:187]
    buffer_load_dwordx4 v[132:135], v89, s[36:39], s11 offen sc1
    v_mfma_f32_16x16x32_bf16 v[184:187], a[184:187], v[140:143], v[184:187]
    v_cndmask_b32 v26, v49, v26, vcc
    v_xor_b32 v49, v55, v50
    v_mfma_f32_16x16x32_bf16 v[188:191], a[188:191], v[140:143], v[188:191]
    v_lshlrev_b32_e64 v49, 4, v49
    v_lshl_add_u32 v48, v51, 8, v49
    v_mfma_f32_16x16x32_bf16 v[188:191], a[172:175], v[136:139], v[188:191]
    s_lshl_b32 s61, s60, 12
    s_waitcnt vmcnt(8)
    v_mfma_f32_16x16x32_bf16 v[176:179], a[192:195], v[96:99], v[176:179]
    buffer_load_dwordx4 v[136:139], v89, s[36:39], s12 offen sc1
    v_mfma_f32_16x16x32_bf16 v[176:179], a[208:211], v[100:103], v[176:179]
    v_add_u32 v38, s61, v48
    v_xor_b32 v39, 64, v38
    v_mfma_f32_16x16x32_bf16 v[180:183], a[212:215], v[100:103], v[180:183]
    v_xor_b32 v40, 128, v38
    v_xor_b32 v41, 192, v38
    v_mfma_f32_16x16x32_bf16 v[180:183], a[196:199], v[96:99], v[180:183]
    v_add_u32 v42, 0x10000, v38
    v_add_u32 v43, 0x10000, v39
    v_mfma_f32_16x16x32_bf16 v[184:187], a[200:203], v[96:99], v[184:187]
    buffer_load_dwordx4 v[140:143], v89, s[36:39], s13 offen sc1
    v_mfma_f32_16x16x32_bf16 v[184:187], a[216:219], v[100:103], v[184:187]
    v_add_u32 v44, 0x10000, v40
    v_add_u32 v45, 0x10000, v41
    v_mfma_f32_16x16x32_bf16 v[188:191], a[220:223], v[100:103], v[188:191]
    s_lshl_b32 s61, s60, 2
    v_add_u32 v48, s61, v55
    v_mfma_f32_16x16x32_bf16 v[188:191], a[204:207], v[96:99], v[188:191]
    v_and_b32 v49, 7, v48
    s_waitcnt vmcnt(8)
    v_mfma_f32_16x16x32_bf16 v[192:195], a[0:3], v[104:107], 0
    buffer_load_dwordx4 v[96:99], v89, s[36:39], s14 offen sc1
    v_mfma_f32_16x16x32_bf16 v[192:195], a[16:19], v[108:111], v[192:195]
    v_xor_b32 v49, v49, v51
    v_lshlrev_b32 v49, 4, v49
    v_mfma_f32_16x16x32_bf16 v[196:199], a[4:7], v[104:107], 0
    v_lshl_add_u32 v46, v48, 8, v49
    v_add_u32 v47, 0x10000, v46
    v_mfma_f32_16x16x32_bf16 v[196:199], a[20:23], v[108:111], v[196:199]
    v_mfma_f32_16x16x32_bf16 v[200:203], a[8:11], v[104:107], 0
    buffer_load_dwordx4 v[100:103], v89, s[36:39], s15 offen sc1
    v_mfma_f32_16x16x32_bf16 v[200:203], a[24:27], v[108:111], v[200:203]
    v_mfma_f32_16x16x32_bf16 v[204:207], a[12:15], v[104:107], 0
    v_mfma_f32_16x16x32_bf16 v[204:207], a[28:31], v[108:111], v[204:207]
    s_waitcnt vmcnt(8)
    s_nop 0
    v_mfma_f32_16x16x32_bf16 v[192:195], a[32:35], v[112:115], v[192:195]
    buffer_load_dwordx4 v[104:107], v89, s[36:39], s16 offen sc1
    v_mfma_f32_16x16x32_bf16 v[192:195], a[48:51], v[116:119], v[192:195]
    v_mfma_f32_16x16x32_bf16 v[196:199], a[52:55], v[116:119], v[196:199]
    v_mfma_f32_16x16x32_bf16 v[196:199], a[36:39], v[112:115], v[196:199]
    v_mfma_f32_16x16x32_bf16 v[200:203], a[40:43], v[112:115], v[200:203]
    buffer_load_dwordx4 v[108:111], v89, s[36:39], s17 offen sc1
    v_mfma_f32_16x16x32_bf16 v[200:203], a[56:59], v[116:119], v[200:203]
    s_waitcnt lgkmcnt(0)
    v_mfma_f32_16x16x32_bf16 v[204:207], a[60:63], v[116:119], v[204:207]
    s_cmp_eq_u32 s72, 14
    s_cbranch_scc0 Lf_p2
Lf_p2_r:
    v_mfma_f32_16x16x32_bf16 v[204:207], a[44:47], v[112:115], v[204:207]
    s_waitcnt vmcnt(8)
    v_mfma_f32_16x16x32_bf16 v[192:195], a[64:67], v[120:123], v[192:195]
    buffer_load_dwordx4 v[112:115], v90, s[36:39], s4 offen sc1
    v_mfma_f32_16x16x32_bf16 v[192:195], a[80:83], v[124:127], v[192:195]
    v_mfma_f32_16x16x32_bf16 v[196:199], a[84:87], v[124:127], v[196:199]
    v_mfma_f32_16x16x32_bf16 v[196:199], a[68:71], v[120:123], v[196:199]
    v_mfma_f32_16x16x32_bf16 v[200:203], a[72:75], v[120:123], v[200:203]
    buffer_load_dwordx4 v[116:119], v90, s[36:39], s5 offen sc1
    v_mfma_f32_16x16x32_bf16 v[200:203], a[88:91], v[124:127], v[200:203]
    v_mfma_f32_16x16x32_bf16 v[204:207], a[92:95], v[124:127], v[204:207]
    v_mfma_f32_16x16x32_bf16 v[204:207], a[76:79], v[120:123], v[204:207]
    s_waitcnt vmcnt(8)
    s_nop 0
    v_mfma_f32_16x16x32_bf16 v[192:195], a[96:99], v[128:131], v[192:195]
    buffer_load_dwordx4 v[120:123], v90, s[36:39], s6 offen sc1
    v_mfma_f32_16x16x32_bf16 v[192:195], a[112:115], v[132:135], v[192:195]
    v_mfma_f32_16x16x32_bf16 v[196:199], a[116:119], v[132:135], v[196:199]
    v_mfma_f32_16x16x32_bf16 v[196:199], a[100:103], v[128:131], v[196:199]
    v_mfma_f32_16x16x32_bf16 v[200:203], a[104:107], v[128:131], v[200:203]
    buffer_load_dwordx4 v[124:127], v90, s[36:39], s7 offen sc1
    v_mfma_f32_16x16x32_bf16 v[200:203], a[120:123], v[132:135], v[200:203]
    v_mfma_f32_16x16x32_bf16 v[204:207], a[124:127], v[132:135], v[204:207]
    v_mfma_f32_16x16x32_bf16 v[204:207], a[108:111], v[128:131], v[204:207]
    s_waitcnt vmcnt(8)
    s_nop 0
    v_mfma_f32_16x16x32_bf16 v[192:195], a[128:131], v[136:139], v[192:195]
    buffer_load_dwordx4 v[128:131], v90, s[36:39], s8 offen sc1
    v_mfma_f32_16x16x32_bf16 v[192:195], a[144:147], v[140:143], v[192:195]
    v_mfma_f32_16x16x32_bf16 v[196:199], a[148:151], v[140:143], v[196:199]
    v_mfma_f32_16x16x32_bf16 v[196:199], a[132:135], v[136:139], v[196:199]
    v_mfma_f32_16x16x32_bf16 v[200:203], a[136:139], v[136:139], v[200:203]
    buffer_load_dwordx4 v[132:135], v90, s[36:39], s9 offen sc1
    v_mfma_f32_16x16x32_bf16 v[200:203], a[152:155], v[140:143], v[200:203]
    s_load_dword s79, s[76:77], 24576 glc
    v_mfma_f32_16x16x32_bf16 v[204:207], a[156:159], v[140:143], v[204:207]
    v_mfma_f32_16x16x32_bf16 v[204:207], a[140:143], v[136:139], v[204:207]
    s_waitcnt vmcnt(8)
    s_nop 0
    v_mfma_f32_16x16x32_bf16 v[192:195], a[160:163], v[96:99], v[192:195]
    buffer_load_dwordx4 v[136:139], v90, s[36:39], s10 offen sc1
    v_mfma_f32_16x16x32_bf16 v[192:195], a[176:179], v[100:103], v[192:195]
    buffer_load_dwordx2 v[28:29], v22, s[24:27], 0 offen
    v_mfma_f32_16x16x32_bf16 v[196:199], a[180:183], v[100:103], v[196:199]
    v_mfma_f32_16x16x32_bf16 v[196:199], a[164:167], v[96:99], v[196:199]
    v_mfma_f32_16x16x32_bf16 v[200:203], a[168:171], v[96:99], v[200:203]
    buffer_load_dwordx4 v[140:143], v90, s[36:39], s11 offen sc1
    v_mfma_f32_16x16x32_bf16 v[200:203], a[184:187], v[100:103], v[200:203]
    v_mfma_f32_16x16x32_bf16 v[204:207], a[188:191], v[100:103], v[204:207]
    v_mfma_f32_16x16x32_bf16 v[204:207], a[172:175], v[96:99], v[204:207]
    s_waitcnt vmcnt(9)
    s_nop 0
    v_mfma_f32_16x16x32_bf16 v[192:195], a[192:195], v[104:107], v[192:195]
    buffer_load_dwordx4 v[96:99], v90, s[36:39], s12 offen sc1
    v_mfma_f32_16x16x32_bf16 v[192:195], a[208:211], v[108:111], v[192:195]
    v_mfma_f32_16x16x32_bf16 v[196:199], a[212:215], v[108:111], v[196:199]
    v_mfma_f32_16x16x32_bf16 v[196:199], a[196:199], v[104:107], v[196:199]
    v_mfma_f32_16x16x32_bf16 v[200:203], a[200:203], v[104:107], v[200:203]
    buffer_load_dwordx4 v[100:103], v90, s[36:39], s13 offen sc1
    v_mfma_f32_16x16x32_bf16 v[200:203], a[216:219], v[108:111], v[200:203]
    buffer_load_dwordx2 v[30:31], v23, s[24:27], 0 offen
    v_mfma_f32_16x16x32_bf16 v[204:207], a[220:223], v[108:111], v[204:207]
    v_mfma_f32_16x16x32_bf16 v[204:207], a[204:207], v[104:107], v[204:207]
    s_waitcnt vmcnt(10)
    s_nop 0
    v_mfma_f32_16x16x32_bf16 v[208:211], a[0:3], v[112:115], 0
    buffer_load_dwordx4 v[104:107], v90, s[36:39], s14 offen sc1
    v_mfma_f32_16x16x32_bf16 v[208:211], a[16:19], v[116:119], v[208:211]
    v_mfma_f32_16x16x32_bf16 v[212:215], a[4:7], v[112:115], 0
    v_mfma_f32_16x16x32_bf16 v[212:215], a[20:23], v[116:119], v[212:215]
    v_mfma_f32_16x16x32_bf16 v[216:219], a[8:11], v[112:115], 0
    buffer_load_dwordx4 v[108:111], v90, s[36:39], s15 offen sc1
    v_mfma_f32_16x16x32_bf16 v[216:219], a[24:27], v[116:119], v[216:219]
    v_mfma_f32_16x16x32_bf16 v[220:223], a[12:15], v[112:115], 0
    v_mfma_f32_16x16x32_bf16 v[220:223], a[28:31], v[116:119], v[220:223]
    s_waitcnt vmcnt(10)
    s_nop 0
    v_mfma_f32_16x16x32_bf16 v[208:211], a[32:35], v[120:123], v[208:211]
    buffer_load_dwordx4 v[112:115], v90, s[36:39], s16 offen sc1
    v_mfma_f32_16x16x32_bf16 v[208:211], a[48:51], v[124:127], v[208:211]
    buffer_load_dwordx2 v[32:33], v24, s[24:27], 0 offen
    v_mfma_f32_16x16x32_bf16 v[212:215], a[52:55], v[124:127], v[212:215]
    v_mfma_f32_16x16x32_bf16 v[212:215], a[36:39], v[120:123], v[212:215]
    v_mfma_f32_16x16x32_bf16 v[216:219], a[40:43], v[120:123], v[216:219]
    buffer_load_dwordx4 v[116:119], v90, s[36:39], s17 offen sc1
    v_mfma_f32_16x16x32_bf16 v[216:219], a[56:59], v[124:127], v[216:219]
    s_waitcnt lgkmcnt(0)
    v_mfma_f32_16x16x32_bf16 v[220:223], a[60:63], v[124:127], v[220:223]
    s_cmp_eq_u32 s79, 14
    s_cbranch_scc0 Lf_p3
Lf_p3_r:
    v_mfma_f32_16x16x32_bf16 v[220:223], a[44:47], v[120:123], v[220:223]
    s_waitcnt vmcnt(11)
    v_mfma_f32_16x16x32_bf16 v[208:211], a[64:67], v[128:131], v[208:211]
    buffer_load_dwordx4 v[120:123], v91, s[36:39], s4 offen sc1
    v_mfma_f32_16x16x32_bf16 v[208:211], a[80:83], v[132:135], v[208:211]
    v_mfma_f32_16x16x32_bf16 v[212:215], a[84:87], v[132:135], v[212:215]
    v_mfma_f32_16x16x32_bf16 v[212:215], a[68:71], v[128:131], v[212:215]
    v_mfma_f32_16x16x32_bf16 v[216:219], a[72:75], v[128:131], v[216:219]
    buffer_load_dwordx4 v[124:127], v91, s[36:39], s5 offen sc1
    v_mfma_f32_16x16x32_bf16 v[216:219], a[88:91], v[132:135], v[216:219]
    buffer_load_dwordx2 v[34:35], v25, s[24:27], 0 offen
    v_mfma_f32_16x16x32_bf16 v[220:223], a[92:95], v[132:135], v[220:223]
    v_mfma_f32_16x16x32_bf16 v[220:223], a[76:79], v[128:131], v[220:223]
    s_waitcnt vmcnt(11)
    s_nop 0
    v_mfma_f32_16x16x32_bf16 v[208:211], a[96:99], v[136:139], v[208:211]
    buffer_load_dwordx4 v[128:131], v91, s[36:39], s6 offen sc1
    v_mfma_f32_16x16x32_bf16 v[208:211], a[112:115], v[140:143], v[208:211]
    v_mfma_f32_16x16x32_bf16 v[212:215], a[116:119], v[140:143], v[212:215]
    v_mfma_f32_16x16x32_bf16 v[212:215], a[100:103], v[136:139], v[212:215]
    v_mfma_f32_16x16x32_bf16 v[216:219], a[104:107], v[136:139], v[216:219]
    buffer_load_dwordx4 v[132:135], v91, s[36:39], s7 offen sc1
    v_mfma_f32_16x16x32_bf16 v[216:219], a[120:123], v[140:143], v[216:219]
    v_mfma_f32_16x16x32_bf16 v[220:223], a[124:127], v[140:143], v[220:223]
    v_mfma_f32_16x16x32_bf16 v[220:223], a[108:111], v[136:139], v[220:223]
    s_waitcnt vmcnt(11)
    s_nop 0
    v_mfma_f32_16x16x32_bf16 v[208:211], a[128:131], v[96:99], v[208:211]
    buffer_load_dwordx4 v[136:139], v91, s[36:39], s8 offen sc1
    v_mfma_f32_16x16x32_bf16 v[208:211], a[144:147], v[100:103], v[208:211]
    buffer_load_dwordx2 v[36:37], v26, s[24:27], 0 offen
    v_mfma_f32_16x16x32_bf16 v[212:215], a[148:151], v[100:103], v[212:215]
    v_mfma_f32_16x16x32_bf16 v[212:215], a[132:135], v[96:99], v[212:215]
    v_mfma_f32_16x16x32_bf16 v[216:219], a[136:139], v[96:99], v[216:219]
    buffer_load_dwordx4 v[140:143], v91, s[36:39], s9 offen sc1
    v_mfma_f32_16x16x32_bf16 v[216:219], a[152:155], v[100:103], v[216:219]
    v_mfma_f32_16x16x32_bf16 v[220:223], a[156:159], v[100:103], v[220:223]
    v_mfma_f32_16x16x32_bf16 v[220:223], a[140:143], v[96:99], v[220:223]
    s_waitcnt vmcnt(11)
    s_nop 0
    v_mfma_f32_16x16x32_bf16 v[208:211], a[160:163], v[104:107], v[208:211]
    buffer_load_dwordx4 v[96:99], v91, s[36:39], s10 offen sc1
    v_mfma_f32_16x16x32_bf16 v[208:211], a[176:179], v[108:111], v[208:211]
    v_mfma_f32_16x16x32_bf16 v[212:215], a[180:183], v[108:111], v[212:215]
    v_mfma_f32_16x16x32_bf16 v[212:215], a[164:167], v[104:107], v[212:215]
    v_mfma_f32_16x16x32_bf16 v[216:219], a[168:171], v[104:107], v[216:219]
    buffer_load_dwordx4 v[100:103], v91, s[36:39], s11 offen sc1
    v_mfma_f32_16x16x32_bf16 v[216:219], a[184:187], v[108:111], v[216:219]
    v_mfma_f32_16x16x32_bf16 v[220:223], a[188:191], v[108:111], v[220:223]
    v_mfma_f32_16x16x32_bf16 v[220:223], a[172:175], v[104:107], v[220:223]
    s_waitcnt vmcnt(10)
    s_nop 0
    v_mfma_f32_16x16x32_bf16 v[208:211], a[192:195], v[112:115], v[208:211]
    buffer_load_dwordx4 v[104:107], v91, s[36:39], s12 offen sc1
    v_mfma_f32_16x16x32_bf16 v[208:211], a[208:211], v[116:119], v[208:211]
    v_mfma_f32_16x16x32_bf16 v[212:215], a[212:215], v[116:119], v[212:215]
    v_mfma_f32_16x16x32_bf16 v[212:215], a[196:199], v[112:115], v[212:215]
    v_mfma_f32_16x16x32_bf16 v[216:219], a[200:203], v[112:115], v[216:219]
    buffer_load_dwordx4 v[108:111], v91, s[36:39], s13 offen sc1
    v_mfma_f32_16x16x32_bf16 v[216:219], a[216:219], v[116:119], v[216:219]
    v_mfma_f32_16x16x32_bf16 v[220:223], a[220:223], v[116:119], v[220:223]
    v_mfma_f32_16x16x32_bf16 v[220:223], a[204:207], v[112:115], v[220:223]
    s_waitcnt vmcnt(10)
    s_nop 0
    v_mfma_f32_16x16x32_bf16 v[224:227], a[0:3], v[120:123], 0
    buffer_load_dwordx4 v[112:115], v91, s[36:39], s14 offen sc1
    v_mfma_f32_16x16x32_bf16 v[224:227], a[16:19], v[124:127], v[224:227]
    v_mfma_f32_16x16x32_bf16 v[228:231], a[4:7], v[120:123], 0
    v_mfma_f32_16x16x32_bf16 v[228:231], a[20:23], v[124:127], v[228:231]
    v_mfma_f32_16x16x32_bf16 v[232:235], a[8:11], v[120:123], 0
    buffer_load_dwordx4 v[116:119], v91, s[36:39], s15 offen sc1
    v_mfma_f32_16x16x32_bf16 v[232:235], a[24:27], v[124:127], v[232:235]
    v_mfma_f32_16x16x32_bf16 v[236:239], a[12:15], v[120:123], 0
    v_mfma_f32_16x16x32_bf16 v[236:239], a[28:31], v[124:127], v[236:239]
    s_waitcnt vmcnt(9)
    s_nop 0
    v_mfma_f32_16x16x32_bf16 v[224:227], a[32:35], v[128:131], v[224:227]
    buffer_load_dwordx4 v[120:123], v91, s[36:39], s16 offen sc1
    v_mfma_f32_16x16x32_bf16 v[224:227], a[48:51], v[132:135], v[224:227]
    v_mfma_f32_16x16x32_bf16 v[228:231], a[52:55], v[132:135], v[228:231]
    v_mfma_f32_16x16x32_bf16 v[228:231], a[36:39], v[128:131], v[228:231]
    v_mfma_f32_16x16x32_bf16 v[232:235], a[40:43], v[128:131], v[232:235]
    buffer_load_dwordx4 v[124:127], v91, s[36:39], s17 offen sc1
    v_mfma_f32_16x16x32_bf16 v[232:235], a[56:59], v[132:135], v[232:235]
    s_load_dword s72, s[76:77], 32768 glc
    v_mfma_f32_16x16x32_bf16 v[236:239], a[60:63], v[132:135], v[236:239]
    v_mfma_f32_16x16x32_bf16 v[236:239], a[44:47], v[128:131], v[236:239]
    s_waitcnt vmcnt(8)
    s_nop 0
    v_mfma_f32_16x16x32_bf16 v[224:227], a[64:67], v[136:139], v[224:227]
    buffer_load_dwordx4 v[128:131], v92, s[36:39], s4 offen sc1
    v_mfma_f32_16x16x32_bf16 v[224:227], a[80:83], v[140:143], v[224:227]
    v_mfma_f32_16x16x32_bf16 v[228:231], a[84:87], v[140:143], v[228:231]
    v_mfma_f32_16x16x32_bf16 v[228:231], a[68:71], v[136:139], v[228:231]
    v_mfma_f32_16x16x32_bf16 v[232:235], a[72:75], v[136:139], v[232:235]
    buffer_load_dwordx4 v[132:135], v92, s[36:39], s5 offen sc1
    v_mfma_f32_16x16x32_bf16 v[232:235], a[88:91], v[140:143], v[232:235]
    v_mfma_f32_16x16x32_bf16 v[236:239], a[92:95], v[140:143], v[236:239]
    v_mfma_f32_16x16x32_bf16 v[236:239], a[76:79], v[136:139], v[236:239]
    s_waitcnt vmcnt(8)
    s_nop 0
    v_mfma_f32_16x16x32_bf16 v[224:227], a[96:99], v[96:99], v[224:227]
    buffer_load_dwordx4 v[136:139], v92, s[36:39], s6 offen sc1
    v_mfma_f32_16x16x32_bf16 v[224:227], a[112:115], v[100:103], v[224:227]
    v_mfma_f32_16x16x32_bf16 v[228:231], a[116:119], v[100:103], v[228:231]
    v_mfma_f32_16x16x32_bf16 v[228:231], a[100:103], v[96:99], v[228:231]
    v_mfma_f32_16x16x32_bf16 v[232:235], a[104:107], v[96:99], v[232:235]
    buffer_load_dwordx4 v[140:143], v92, s[36:39], s7 offen sc1
    v_mfma_f32_16x16x32_bf16 v[232:235], a[120:123], v[100:103], v[232:235]
    v_mfma_f32_16x16x32_bf16 v[236:239], a[124:127], v[100:103], v[236:239]
    v_mfma_f32_16x16x32_bf16 v[236:239], a[108:111], v[96:99], v[236:239]
    s_waitcnt vmcnt(8)
    s_nop 0
    v_mfma_f32_16x16x32_bf16 v[224:227], a[128:131], v[104:107], v[224:227]
    buffer_load_dwordx4 v[96:99], v92, s[36:39], s8 offen sc1
    v_mfma_f32_16x16x32_bf16 v[224:227], a[144:147], v[108:111], v[224:227]
    v_mfma_f32_16x16x32_bf16 v[228:231], a[148:151], v[108:111], v[228:231]
    v_mfma_f32_16x16x32_bf16 v[228:231], a[132:135], v[104:107], v[228:231]
    v_mfma_f32_16x16x32_bf16 v[232:235], a[136:139], v[104:107], v[232:235]
    buffer_load_dwordx4 v[100:103], v92, s[36:39], s9 offen sc1
    v_mfma_f32_16x16x32_bf16 v[232:235], a[152:155], v[108:111], v[232:235]
    v_mfma_f32_16x16x32_bf16 v[236:239], a[156:159], v[108:111], v[236:239]
    v_mfma_f32_16x16x32_bf16 v[236:239], a[140:143], v[104:107], v[236:239]
    s_waitcnt vmcnt(8)
    s_nop 0
    v_mfma_f32_16x16x32_bf16 v[224:227], a[160:163], v[112:115], v[224:227]
    buffer_load_dwordx4 v[104:107], v92, s[36:39], s10 offen sc1
    v_mfma_f32_16x16x32_bf16 v[224:227], a[176:179], v[116:119], v[224:227]
    v_mfma_f32_16x16x32_bf16 v[228:231], a[180:183], v[116:119], v[228:231]
    v_mfma_f32_16x16x32_bf16 v[228:231], a[164:167], v[112:115], v[228:231]
    v_mfma_f32_16x16x32_bf16 v[232:235], a[168:171], v[112:115], v[232:235]
    buffer_load_dwordx4 v[108:111], v92, s[36:39], s11 offen sc1
    v_mfma_f32_16x16x32_bf16 v[232:235], a[184:187], v[116:119], v[232:235]
    s_waitcnt lgkmcnt(0)
    v_mfma_f32_16x16x32_bf16 v[236:239], a[188:191], v[116:119], v[236:239]
    s_cmp_eq_u32 s72, s78
    s_cbranch_scc0 Lf_p4
Lf_p4_r:
    v_mfma_f32_16x16x32_bf16 v[236:239], a[172:175], v[112:115], v[236:239]
    s_waitcnt vmcnt(8)
    v_mfma_f32_16x16x32_bf16 v[224:227], a[192:195], v[120:123], v[224:227]
    buffer_load_dwordx4 v[112:115], v88, s[36:39], s69 offen offset:0 sc1
    v_mfma_f32_16x16x32_bf16 v[224:227], a[208:211], v[124:127], v[224:227]
    v_mfma_f32_16x16x32_bf16 v[228:231], a[212:215], v[124:127], v[228:231]
    v_mfma_f32_16x16x32_bf16 v[228:231], a[196:199], v[120:123], v[228:231]
    v_mfma_f32_16x16x32_bf16 v[232:235], a[200:203], v[120:123], v[232:235]
    buffer_load_dwordx4 v[116:119], v88, s[36:39], s69 offen offset:1024 sc1
    v_mfma_f32_16x16x32_bf16 v[232:235], a[216:219], v[124:127], v[232:235]
    v_mfma_f32_16x16x32_bf16 v[236:239], a[220:223], v[124:127], v[236:239]
    v_mfma_f32_16x16x32_bf16 v[236:239], a[204:207], v[120:123], v[236:239]
    s_waitcnt vmcnt(8)
    s_nop 0
    v_mfma_f32_16x16x32_bf16 v[240:243], a[0:3], v[128:131], 0
    buffer_load_dwordx4 v[120:123], v88, s[36:39], s69 offen offset:2048 sc1
    v_mfma_f32_16x16x32_bf16 v[240:243], a[16:19], v[132:135], v[240:243]
    v_mfma_f32_16x16x32_bf16 v[244:247], a[4:7], v[128:131], 0
    v_mfma_f32_16x16x32_bf16 v[244:247], a[20:23], v[132:135], v[244:247]
    v_mfma_f32_16x16x32_bf16 v[248:251], a[8:11], v[128:131], 0
    buffer_load_dwordx4 v[124:127], v88, s[36:39], s69 offen offset:3072 sc1
    v_mfma_f32_16x16x32_bf16 v[248:251], a[24:27], v[132:135], v[248:251]
    v_mfma_f32_16x16x32_bf16 v[252:255], a[12:15], v[128:131], 0
    v_mfma_f32_16x16x32_bf16 v[252:255], a[28:31], v[132:135], v[252:255]
    s_waitcnt vmcnt(8)
    s_nop 0
    v_mfma_f32_16x16x32_bf16 v[240:243], a[32:35], v[136:139], v[240:243]
    buffer_load_dwordx4 v[128:131], v89, s[36:39], s69 offen offset:0 sc1
    v_mfma_f32_16x16x32_bf16 v[240:243], a[48:51], v[140:143], v[240:243]
    v_mfma_f32_16x16x32_bf16 v[244:247], a[52:55], v[140:143], v[244:247]
    v_mfma_f32_16x16x32_bf16 v[244:247], a[36:39], v[136:139], v[244:247]
    v_mfma_f32_16x16x32_bf16 v[248:251], a[40:43], v[136:139], v[248:251]
    buffer_load_dwordx4 v[132:135], v89, s[36:39], s69 offen offset:1024 sc1
    v_mfma_f32_16x16x32_bf16 v[248:251], a[56:59], v[140:143], v[248:251]
    v_mfma_f32_16x16x32_bf16 v[252:255], a[60:63], v[140:143], v[252:255]
    v_mfma_f32_16x16x32_bf16 v[252:255], a[44:47], v[136:139], v[252:255]
    s_waitcnt vmcnt(8)
    s_nop 0
    v_mfma_f32_16x16x32_bf16 v[240:243], a[64:67], v[96:99], v[240:243]
    buffer_load_dwordx4 v[136:139], v89, s[36:39], s69 offen offset:2048 sc1
    v_mfma_f32_16x16x32_bf16 v[240:243], a[80:83], v[100:103], v[240:243]
    v_mfma_f32_16x16x32_bf16 v[244:247], a[84:87], v[100:103], v[244:247]
    v_mfma_f32_16x16x32_bf16 v[244:247], a[68:71], v[96:99], v[244:247]
    v_mfma_f32_16x16x32_bf16 v[248:251], a[72:75], v[96:99], v[248:251]
    buffer_load_dwordx4 v[140:143], v89, s[36:39], s69 offen offset:3072 sc1
    v_mfma_f32_16x16x32_bf16 v[248:251], a[88:91], v[100:103], v[248:251]
    v_mfma_f32_16x16x32_bf16 v[252:255], a[92:95], v[100:103], v[252:255]
    v_mfma_f32_16x16x32_bf16 v[252:255], a[76:79], v[96:99], v[252:255]
    s_waitcnt vmcnt(8)
    s_nop 0
    v_mfma_f32_16x16x32_bf16 v[240:243], a[96:99], v[104:107], v[240:243]
    buffer_load_dwordx4 v[96:99], v90, s[36:39], s69 offen offset:0 sc1
    v_mfma_f32_16x16x32_bf16 v[240:243], a[112:115], v[108:111], v[240:243]
    v_mfma_f32_16x16x32_bf16 v[244:247], a[116:119], v[108:111], v[244:247]
    v_mfma_f32_16x16x32_bf16 v[244:247], a[100:103], v[104:107], v[244:247]
    v_mfma_f32_16x16x32_bf16 v[248:251], a[104:107], v[104:107], v[248:251]
    buffer_load_dwordx4 v[100:103], v90, s[36:39], s69 offen offset:1024 sc1
    v_mfma_f32_16x16x32_bf16 v[248:251], a[120:123], v[108:111], v[248:251]
    v_mfma_f32_16x16x32_bf16 v[252:255], a[124:127], v[108:111], v[252:255]
    v_mfma_f32_16x16x32_bf16 v[252:255], a[108:111], v[104:107], v[252:255]
    s_waitcnt vmcnt(8)
    s_nop 0
    v_mfma_f32_16x16x32_bf16 v[176:179], a[224:227], v[112:115], v[176:179]
    buffer_load_dwordx4 v[104:107], v90, s[36:39], s69 offen offset:2048 sc1
    v_mfma_f32_16x16x32_bf16 v[176:179], a[240:243], v[116:119], v[176:179]
    v_mfma_f32_16x16x32_bf16 v[180:183], a[244:247], v[116:119], v[180:183]
    v_mfma_f32_16x16x32_bf16 v[180:183], a[228:231], v[112:115], v[180:183]
    v_mfma_f32_16x16x32_bf16 v[184:187], a[232:235], v[112:115], v[184:187]
    buffer_load_dwordx4 v[108:111], v90, s[36:39], s69 offen offset:3072 sc1
    v_mfma_f32_16x16x32_bf16 v[184:187], a[248:251], v[116:119], v[184:187]
    v_mfma_f32_16x16x32_bf16 v[188:191], a[252:255], v[116:119], v[188:191]
    v_mfma_f32_16x16x32_bf16 v[188:191], a[236:239], v[112:115], v[188:191]
    s_waitcnt vmcnt(8)
    s_nop 0
    v_mfma_f32_16x16x32_bf16 v[176:179], v[56:59], v[120:123], v[176:179]
    buffer_load_dwordx4 v[112:115], v91, s[36:39], s69 offen offset:0 sc1
    v_mfma_f32_16x16x32_bf16 v[176:179], v[72:75], v[124:127], v[176:179]
    v_mfma_f32_16x16x32_bf16 v[180:183], v[76:79], v[124:127], v[180:183]
    v_mfma_f32_16x16x32_bf16 v[180:183], v[60:63], v[120:123], v[180:183]
    v_mfma_f32_16x16x32_bf16 v[184:187], v[64:67], v[120:123], v[184:187]
    buffer_load_dwordx4 v[116:119], v91, s[36:39], s69 offen offset:1024 sc1
    v_mfma_f32_16x16x32_bf16 v[184:187], v[80:83], v[124:127], v[184:187]
    s_barrier
    v_mfma_f32_16x16x32_bf16 v[188:191], v[84:87], v[124:127], v[188:191]
    v_mfma_f32_16x16x32_bf16 v[188:191], v[68:71], v[120:123], v[188:191]
    s_waitcnt vmcnt(8)
    v_mfma_f32_16x16x32_bf16 v[192:195], a[224:227], v[128:131], v[192:195]
    buffer_load_dwordx4 v[120:123], v91, s[36:39], s69 offen offset:2048 sc1
    v_mfma_f32_16x16x32_bf16 v[192:195], a[240:243], v[132:135], v[192:195]
    ds_write_b128 v38, v[176:179] offset:0
    v_mfma_f32_16x16x32_bf16 v[196:199], a[244:247], v[132:135], v[196:199]
    v_mfma_f32_16x16x32_bf16 v[196:199], a[228:231], v[128:131], v[196:199]
    v_mfma_f32_16x16x32_bf16 v[200:203], a[232:235], v[128:131], v[200:203]
    buffer_load_dwordx4 v[124:127], v91, s[36:39], s69 offen offset:3072 sc1
    v_mfma_f32_16x16x32_bf16 v[200:203], a[248:251], v[132:135], v[200:203]
    ds_write_b128 v39, v[180:183] offset:0
    v_mfma_f32_16x16x32_bf16 v[204:207], a[252:255], v[132:135], v[204:207]
    v_mfma_f32_16x16x32_bf16 v[204:207], a[236:239], v[128:131], v[204:207]
    s_waitcnt vmcnt(8)
    s_nop 0
    v_mfma_f32_16x16x32_bf16 v[192:195], v[56:59], v[136:139], v[192:195]
    buffer_load_dwordx4 v[128:131], v92, s[36:39], s12 offen sc1
    v_mfma_f32_16x16x32_bf16 v[192:195], v[72:75], v[140:143], v[192:195]
    ds_write_b128 v40, v[184:187] offset:0
    v_mfma_f32_16x16x32_bf16 v[196:199], v[76:79], v[140:143], v[196:199]
    v_mfma_f32_16x16x32_bf16 v[196:199], v[60:63], v[136:139], v[196:199]
    v_mfma_f32_16x16x32_bf16 v[200:203], v[64:67], v[136:139], v[200:203]
    buffer_load_dwordx4 v[132:135], v92, s[36:39], s13 offen sc1
    v_mfma_f32_16x16x32_bf16 v[200:203], v[80:83], v[140:143], v[200:203]
    ds_write_b128 v41, v[188:191] offset:0
    v_mfma_f32_16x16x32_bf16 v[204:207], v[84:87], v[140:143], v[204:207]
    v_mfma_f32_16x16x32_bf16 v[204:207], v[68:71], v[136:139], v[204:207]
    s_waitcnt vmcnt(8)
    s_nop 0
    v_mfma_f32_16x16x32_bf16 v[208:211], a[224:227], v[96:99], v[208:211]
    buffer_load_dwordx4 v[136:139], v92, s[36:39], s14 offen sc1
    v_mfma_f32_16x16x32_bf16 v[208:211], a[240:243], v[100:103], v[208:211]
    ds_write_b128 v38, v[192:195] offset:16384
    v_mfma_f32_16x16x32_bf16 v[212:215], a[244:247], v[100:103], v[212:215]
    v_mfma_f32_16x16x32_bf16 v[212:215], a[228:231], v[96:99], v[212:215]
    s_waitcnt lgkmcnt(1)
    s_barrier
    v_mfma_f32_16x16x32_bf16 v[216:219], a[232:235], v[96:99], v[216:219]
    buffer_load_dwordx4 v[140:143], v92, s[36:39], s15 offen sc1
    v_mfma_f32_16x16x32_bf16 v[216:219], a[248:251], v[100:103], v[216:219]
    ds_write_b128 v39, v[196:199] offset:16384
    v_mfma_f32_16x16x32_bf16 v[220:223], a[252:255], v[100:103], v[220:223]
    ds_read_b128 v[144:147], v46 offset:0
    v_mfma_f32_16x16x32_bf16 v[220:223], a[236:239], v[96:99], v[220:223]
    ds_read_b128 v[148:151], v46 offset:4096
    s_waitcnt vmcnt(8)
    v_mfma_f32_16x16x32_bf16 v[208:211], v[56:59], v[104:107], v[208:211]
    buffer_load_dwordx4 v[96:99], v92, s[36:39], s16 offen sc1
    v_mfma_f32_16x16x32_bf16 v[208:211], v[72:75], v[108:111], v[208:211]
    ds_write_b128 v40, v[200:203] offset:16384
    v_mfma_f32_16x16x32_bf16 v[212:215], v[76:79], v[108:111], v[212:215]
    ds_read_b128 v[152:155], v46 offset:8192
    v_mfma_f32_16x16x32_bf16 v[212:215], v[60:63], v[104:107], v[212:215]
    ds_read_b128 v[156:159], v46 offset:12288
    v_mfma_f32_16x16x32_bf16 v[216:219], v[64:67], v[104:107], v[216:219]
    buffer_load_dwordx4 v[100:103], v92, s[36:39], s17 offen sc1
    v_mfma_f32_16x16x32_bf16 v[216:219], v[80:83], v[108:111], v[216:219]
    ds_write_b128 v41, v[204:207] offset:16384
    v_lshlrev_b32 v48, 16, v28
    v_mfma_f32_16x16x32_bf16 v[220:223], v[84:87], v[108:111], v[220:223]
    v_and_b32 v49, 0xffff0000, v28
    v_lshlrev_b32_e64 v50, 16, v29
    v_mfma_f32_16x16x32_bf16 v[220:223], v[68:71], v[104:107], v[220:223]
    v_and_b32 v51, 0xffff0000, v29
    s_waitcnt vmcnt(8)
    v_mfma_f32_16x16x32_bf16 v[224:227], a[224:227], v[112:115], v[224:227]
    buffer_load_dwordx4 v[104:107], v92, s[36:39], s69 offen offset:0 sc1
    v_mfma_f32_16x16x32_bf16 v[224:227], a[240:243], v[116:119], v[224:227]
    ds_write_b128 v38, v[208:211] offset:32768
    s_waitcnt lgkmcnt(2)
    v_mfma_f32_16x16x32_bf16 v[228:231], a[244:247], v[116:119], v[228:231]
    v_add_f32 v48, v48, v144
    v_add_f32 v49, v49, v145
    v_mfma_f32_16x16x32_bf16 v[228:231], a[228:231], v[112:115], v[228:231]
    v_add_f32 v50, v50, v146
    v_add_f32 v51, v51, v147
    v_mfma_f32_16x16x32_bf16 v[232:235], a[232:235], v[112:115], v[232:235]
    buffer_load_dwordx4 v[108:111], v92, s[36:39], s69 offen offset:1024 sc1
    v_mfma_f32_16x16x32_bf16 v[232:235], a[248:251], v[116:119], v[232:235]
    ds_write_b128 v39, v[212:215] offset:32768
    v_add_f32_e64 v48, v48, v148
    v_mfma_f32_16x16x32_bf16 v[236:239], a[252:255], v[116:119], v[236:239]
    v_add_f32 v49, v49, v149
    v_add_f32 v50, v50, v150
    v_mfma_f32_16x16x32_bf16 v[236:239], a[236:239], v[112:115], v[236:239]
    v_add_f32 v51, v51, v151
    s_waitcnt vmcnt(8)
    v_mfma_f32_16x16x32_bf16 v[224:227], v[56:59], v[120:123], v[224:227]
    buffer_load_dwordx4 v[112:115], v92, s[36:39], s69 offen offset:2048 sc1
    v_mfma_f32_16x16x32_bf16 v[224:227], v[72:75], v[124:127], v[224:227]
    ds_write_b128 v40, v[216:219] offset:32768
    v_add_f32_e64 v48, v48, v152
    v_mfma_f32_16x16x32_bf16 v[228:231], v[76:79], v[124:127], v[228:231]
    v_add_f32 v49, v49, v153
    v_add_f32 v50, v50, v154
    v_mfma_f32_16x16x32_bf16 v[228:231], v[60:63], v[120:123], v[228:231]
    v_add_f32 v51, v51, v155
    v_add_f32 v48, v48, v156
    v_mfma_f32_16x16x32_bf16 v[232:235], v[64:67], v[120:123], v[232:235]
    buffer_load_dwordx4 v[116:119], v92, s[36:39], s69 offen offset:3072 sc1
    v_mfma_f32_16x16x32_bf16 v[232:235], v[80:83], v[124:127], v[232:235]
    ds_write_b128 v41, v[220:223] offset:32768
    v_add_f32_e64 v49, v49, v157
    v_mfma_f32_16x16x32_bf16 v[236:239], v[84:87], v[124:127], v[236:239]
    v_add_f32 v50, v50, v158
    v_add_f32 v51, v51, v159
    v_mfma_f32_16x16x32_bf16 v[236:239], v[68:71], v[120:123], v[236:239]
    v_cvt_pk_bf16_f32 v28, v48, v49
    s_waitcnt vmcnt(8)
    v_mfma_f32_16x16x32_bf16 v[240:243], a[128:131], v[128:131], v[240:243]
    v_cvt_pk_bf16_f32 v29, v50, v51
    v_mfma_f32_16x16x32_bf16 v[240:243], a[144:147], v[132:135], v[240:243]
    ds_write_b128 v38, v[224:227] offset:49152
    v_mfma_f32_16x16x32_bf16 v[244:247], a[148:151], v[132:135], v[244:247]
    buffer_store_dwordx2 v[28:29], v22, s[48:51], 0 offen sc1
    v_mfma_f32_16x16x32_bf16 v[244:247], a[132:135], v[128:131], v[244:247]
    s_waitcnt lgkmcnt(5)
    s_barrier
    v_mfma_f32_16x16x32_bf16 v[248:251], a[136:139], v[128:131], v[248:251]
    ds_read_b128 v[160:163], v46 offset:16384
    v_mfma_f32_16x16x32_bf16 v[248:251], a[152:155], v[132:135], v[248:251]
    ds_write_b128 v39, v[228:231] offset:49152
    v_mfma_f32_16x16x32_bf16 v[252:255], a[156:159], v[132:135], v[252:255]
    ds_read_b128 v[164:167], v46 offset:20480
    v_mfma_f32_16x16x32_bf16 v[252:255], a[140:143], v[128:131], v[252:255]
    ds_read_b128 v[168:171], v46 offset:24576
    s_waitcnt vmcnt(7)
    v_mfma_f32_16x16x32_bf16 v[240:243], a[160:163], v[136:139], v[240:243]
    ds_read_b128 v[172:175], v46 offset:28672
    v_mfma_f32_16x16x32_bf16 v[240:243], a[176:179], v[140:143], v[240:243]
    ds_write_b128 v40, v[232:235] offset:49152
    v_lshlrev_b32_e64 v48, 16, v30
    v_mfma_f32_16x16x32_bf16 v[244:247], a[180:183], v[140:143], v[244:247]
    v_and_b32 v49, 0xffff0000, v30
    v_lshlrev_b32_e64 v50, 16, v31
    v_mfma_f32_16x16x32_bf16 v[244:247], a[164:167], v[136:139], v[244:247]
    v_and_b32 v51, 0xffff0000, v31
    v_mfma_f32_16x16x32_bf16 v[248:251], a[168:171], v[136:139], v[248:251]
    v_mfma_f32_16x16x32_bf16 v[248:251], a[184:187], v[140:143], v[248:251]
    ds_write_b128 v41, v[236:239] offset:49152
    s_waitcnt lgkmcnt(2)
    v_mfma_f32_16x16x32_bf16 v[252:255], a[188:191], v[140:143], v[252:255]
    v_add_f32 v48, v48, v160
    v_add_f32_e64 v49, v49, v161
    v_mfma_f32_16x16x32_bf16 v[252:255], a[172:175], v[136:139], v[252:255]
    v_add_f32 v50, v50, v162
    s_waitcnt vmcnt(5)
    v_mfma_f32_16x16x32_bf16 v[240:243], a[192:195], v[96:99], v[240:243]
    v_add_f32 v51, v51, v163
    v_add_f32 v48, v48, v164
    v_mfma_f32_16x16x32_bf16 v[240:243], a[208:211], v[100:103], v[240:243]
    v_add_f32 v49, v49, v165
    v_add_f32 v50, v50, v166
    v_mfma_f32_16x16x32_bf16 v[244:247], a[212:215], v[100:103], v[244:247]
    v_add_f32 v51, v51, v167
    v_add_f32 v48, v48, v168
    v_mfma_f32_16x16x32_bf16 v[244:247], a[196:199], v[96:99], v[244:247]
    v_add_f32 v49, v49, v169
    v_add_f32 v50, v50, v170
    v_mfma_f32_16x16x32_bf16 v[248:251], a[200:203], v[96:99], v[248:251]
    v_add_f32 v51, v51, v171
    v_add_f32 v48, v48, v172
    v_mfma_f32_16x16x32_bf16 v[248:251], a[216:219], v[100:103], v[248:251]
    v_add_f32 v49, v49, v173
    v_add_f32 v50, v50, v174
    v_mfma_f32_16x16x32_bf16 v[252:255], a[220:223], v[100:103], v[252:255]
    v_add_f32_e64 v51, v51, v175
    v_cvt_pk_bf16_f32 v30, v48, v49
    v_mfma_f32_16x16x32_bf16 v[252:255], a[204:207], v[96:99], v[252:255]
    v_cvt_pk_bf16_f32 v31, v50, v51
    s_waitcnt vmcnt(1)
    v_mfma_f32_16x16x32_bf16 v[240:243], a[224:227], v[104:107], v[240:243]
    buffer_store_dwordx2 v[30:31], v23, s[48:51], 0 offen sc1
    v_mfma_f32_16x16x32_bf16 v[240:243], a[240:243], v[108:111], v[240:243]
    s_barrier
    v_mfma_f32_16x16x32_bf16 v[240:243], v[56:59], v[112:115], v[240:243]
    ds_read_b128 v[144:147], v46 offset:32768
    v_mfma_f32_16x16x32_bf16 v[240:243], v[72:75], v[116:119], v[240:243]
    ds_read_b128 v[148:151], v46 offset:36864
    v_mfma_f32_16x16x32_bf16 v[244:247], v[76:79], v[116:119], v[244:247]
    ds_read_b128 v[152:155], v46 offset:40960
    v_mfma_f32_16x16x32_bf16 v[244:247], v[60:63], v[112:115], v[244:247]
    ds_read_b128 v[156:159], v46 offset:45056
    v_mfma_f32_16x16x32_bf16 v[244:247], a[244:247], v[108:111], v[244:247]
    v_lshlrev_b32_e64 v48, 16, v32
    v_and_b32 v49, 0xffff0000, v32
    v_mfma_f32_16x16x32_bf16 v[244:247], a[228:231], v[104:107], v[244:247]
    ds_write_b128 v42, v[240:243] offset:0
    v_lshlrev_b32_e64 v50, 16, v33
    v_mfma_f32_16x16x32_bf16 v[248:251], a[232:235], v[104:107], v[248:251]
    v_and_b32 v51, 0xffff0000, v33
    v_mfma_f32_16x16x32_bf16 v[248:251], a[248:251], v[108:111], v[248:251]
    v_mfma_f32_16x16x32_bf16 v[248:251], v[64:67], v[112:115], v[248:251]
    s_waitcnt lgkmcnt(1)
    v_add_f32 v48, v48, v144
    v_mfma_f32_16x16x32_bf16 v[248:251], v[80:83], v[116:119], v[248:251]
    ds_write_b128 v43, v[244:247] offset:0
    v_add_f32_e64 v49, v49, v145
    v_mfma_f32_16x16x32_bf16 v[252:255], v[84:87], v[116:119], v[252:255]
    v_add_f32 v50, v50, v146
    v_add_f32 v51, v51, v147
    v_mfma_f32_16x16x32_bf16 v[252:255], v[68:71], v[112:115], v[252:255]
    v_add_f32 v48, v48, v148
    v_add_f32 v49, v49, v149
    v_mfma_f32_16x16x32_bf16 v[252:255], a[252:255], v[108:111], v[252:255]
    v_add_f32 v50, v50, v150
    v_add_f32 v51, v51, v151
    v_mfma_f32_16x16x32_bf16 v[252:255], a[236:239], v[104:107], v[252:255]
    ds_write_b128 v44, v[248:251] offset:0
    s_nop 6
    ds_write_b128 v45, v[252:255] offset:0
    v_add_f32 v48, v48, v152
    v_add_f32 v49, v49, v153
    v_add_f32 v50, v50, v154
    v_add_f32 v51, v51, v155
    v_add_f32 v48, v48, v156
    v_add_f32 v49, v49, v157
    v_add_f32 v50, v50, v158
    v_add_f32_e64 v51, v51, v159
    v_cvt_pk_bf16_f32 v32, v48, v49
    v_cvt_pk_bf16_f32 v33, v50, v51
    buffer_store_dwordx2 v[32:33], v24, s[48:51], 0 offen sc1
    v_lshlrev_b32_e64 v48, 16, v34
    v_and_b32 v49, 0xffff0000, v34
    v_lshlrev_b32_e64 v50, 16, v35
    v_and_b32 v51, 0xffff0000, v35
    s_waitcnt lgkmcnt(0)
    s_barrier
    ds_read_b128 v[160:163], v46 offset:49152
    ds_read_b128 v[164:167], v46 offset:53248
    ds_read_b128 v[168:171], v46 offset:57344
    ds_read_b128 v[172:175], v46 offset:61440
    ds_read_b128 v[144:147], v47 offset:0
    ds_read_b128 v[148:151], v47 offset:4096
    ds_read_b128 v[152:155], v47 offset:8192
    ds_read_b128 v[156:159], v47 offset:12288
    s_waitcnt lgkmcnt(4)
    s_nop 0
    v_pk_add_f32 v[48:49], v[48:49], v[160:161]
    v_pk_add_f32 v[50:51], v[50:51], v[162:163]
    v_pk_add_f32 v[48:49], v[48:49], v[164:165]
    v_pk_add_f32 v[50:51], v[50:51], v[166:167]
    v_pk_add_f32 v[48:49], v[48:49], v[168:169]
    v_pk_add_f32 v[50:51], v[50:51], v[170:171]
    v_pk_add_f32 v[48:49], v[48:49], v[172:173]
    v_pk_add_f32 v[50:51], v[50:51], v[174:175]
    v_cvt_pk_bf16_f32 v34, v48, v49
    v_cvt_pk_bf16_f32 v35, v50, v51
    buffer_store_dwordx2 v[34:35], v25, s[48:51], 0 offen sc1
    v_lshlrev_b32_e64 v48, 16, v36
    v_and_b32 v49, 0xffff0000, v36
    v_lshlrev_b32_e64 v50, 16, v37
    v_and_b32 v51, 0xffff0000, v37
    s_waitcnt lgkmcnt(0)
    s_nop 0
    v_pk_add_f32 v[48:49], v[48:49], v[144:145]
    v_pk_add_f32 v[50:51], v[50:51], v[146:147]
    v_pk_add_f32 v[48:49], v[48:49], v[148:149]
    v_pk_add_f32 v[50:51], v[50:51], v[150:151]
    v_pk_add_f32 v[48:49], v[48:49], v[152:153]
    v_pk_add_f32 v[50:51], v[50:51], v[154:155]
    v_pk_add_f32 v[48:49], v[48:49], v[156:157]
    v_pk_add_f32 v[50:51], v[50:51], v[158:159]
    v_cvt_pk_bf16_f32 v36, v48, v49
    v_cvt_pk_bf16_f32 v37, v50, v51
    buffer_store_dwordx2 v[36:37], v26, s[48:51], 0 offen sc1
L_done:
    s_endpgm
L_attn:
    s_mul_i32 s63, s56, 113
    s_lshl4_add_u32 s63, s60, s63
    s_mul_i32 s63, s63, 896
    s_lshl_b32 s65, s60, 12
    v_add_u32 v2, s63, v54
    v_add_u32 v3, 56320, v2
    s_mov_b64 s[36:37], s[22:23]
    s_mov_b32 s38, 9699328
    s_mov_b32 s39, 0x20000
    s_mov_b64 s[52:53], s[20:21]
    s_mov_b32 s54, 256
    s_mov_b32 s55, 0x20000
    s_mov_b64 s[0:1], s[16:17]
    s_mov_b64 s[18:19], s[8:9]
    v_and_b32_e64 v56, 7, v0
    v_bfe_u32 v57, v0, 3, 1
    v_lshrrev_b32_e64 v58, 4, v0
    v_bfe_u32 v59, v0, 1, 3
    v_xor_b32 v58, v58, v59
    v_lshlrev_b32 v58, 4, v58
    v_lshl_add_u32 v58, v56, 7, v58
    v_mul_u32_u24 v57, 4096, v57
    v_add_u32 v7, v57, v58
    v_xor_b32 v8, 64, v7
    v_and_b32 v57, 15, v0
    v_cmp_eq_u32 vcc, 15, v57
    v_mov_b32 v59, 0x100
    v_lshlrev_b32 v56, 4, v56
    v_cndmask_b32 v59, 0, v59, vcc
    v_add_u32 v9, v7, v59
    v_add_u32 v10, v8, v59
    v_mov_b32 v58, 0x3f803f80
    v_mov_b32 v59, 0x3f803f80
    v_mov_b32 v60, 0x3f803f80
    v_mov_b32 v61, 0x3f803f80
    ds_write_b128 v56, v[58:61] offset:16512
    ds_write_b128 v56, v[58:61] offset:33152
    ds_write_b128 v56, v[58:61] offset:49792
    v_bfe_u32 v20, v0, 4, 1
    v_bfe_u32 v21, v0, 2, 2
    v_lshrrev_b32 v22, 5, v0
    v_and_b32 v23, 3, v0
    v_lshl_add_u32 v24, v21, 1, v20
    v_lshl_add_u32 v24, v24, 2, v23
    s_mul_i32 s61, s60, 56
    v_lshl_add_u32 v24, v24, 3, s61
    v_add_u32 v25, 32, v24
    s_sub_u32 s61, 168, s61
    v_cmp_eq_u32 vcc, 3, v23
    v_add_u32 v26, s61, v25
    s_nop 0
    v_cndmask_b32 v25, v25, v26, vcc
    v_and_b32 v24, 0xff, v24
    v_and_b32 v25, 0xff, v25
    v_mul_u32_u24 v20, 12288, v20
    v_mul_u32_u24 v22, 3072, v22
    v_lshl_add_u32 v20, v21, 8, v20
    v_add_u32_e64 v20, v20, v22
    v_add_u32 v20, 49920, v20
    v_add_u32 v11, v20, v24
    v_add_u32 v12, v20, v25
    v_add_u32 v13, 49152, v11
    v_add_u32 v14, 49152, v12
    s_add_u32 m0, s66, 0
    s_add_u32 s67, s75, 0
    buffer_load_dwordx4 v4, s[28:31], s67 offen offset:0 lds
    buffer_load_dwordx4 v5, s[28:31], s67 offen offset:1024 lds
    buffer_load_dwordx4 v6, s[28:31], s67 offen offset:2048 lds
    s_add_u32 m0, s66, 3072
    s_add_u32 s67, s75, 43008
    buffer_load_dwordx4 v4, s[28:31], s67 offen offset:0 lds
    buffer_load_dwordx4 v5, s[28:31], s67 offen offset:1024 lds
    buffer_load_dwordx4 v6, s[28:31], s67 offen offset:2048 lds
    s_add_u32 m0, s65, 0
    s_nop 0
    buffer_load_dwordx4 v2, s[24:27], s74 offen offset:0 lds
    buffer_load_dwordx4 v3, s[24:27], s74 offen offset:1024 lds
    v_and_b32_e64 v48, 1, v0
    v_cmp_eq_u32 s[80:81], 1, v48
    v_lshlrev_b32_e64 v48, 5, v48
    v_lshl_add_u32 v48, v46, 2, v48
    v_bfe_u32 v47, v0, 4, 1
    v_lshlrev_b32 v47, 6, v47
    v_sub_u32 v48, v48, v47
    s_lshl3_add_u32 s61, s60, 163776
    v_cmp_eq_u32 vcc, 0, v0
    v_add_u32 v48, s61, v48
    v_mov_b32 v46, 0
    v_cndmask_b32 v1, v49, v46, vcc
    s_waitcnt vmcnt(8)
    v_lshlrev_b32 v52, 16, v38
    v_and_b32 v53, 0xffff0000, v38
    v_pk_add_f32 v[46:47], v[52:53], 0
    v_pk_mul_f32 v[50:51], v[52:53], v[52:53]
    v_lshlrev_b32_e64 v52, 16, v39
    v_and_b32 v53, 0xffff0000, v39
    v_pk_add_f32 v[46:47], v[46:47], v[52:53]
    v_pk_fma_f32 v[50:51], v[52:53], v[52:53], v[50:51]
    v_lshlrev_b32_e64 v52, 16, v40
    v_and_b32 v53, 0xffff0000, v40
    v_pk_add_f32 v[46:47], v[46:47], v[52:53]
    v_pk_fma_f32 v[50:51], v[52:53], v[52:53], v[50:51]
    v_lshlrev_b32_e64 v52, 16, v41
    v_and_b32 v53, 0xffff0000, v41
    v_pk_add_f32 v[46:47], v[46:47], v[52:53]
    v_pk_fma_f32 v[50:51], v[52:53], v[52:53], v[50:51]
    v_lshlrev_b32_e64 v52, 16, v42
    v_and_b32 v53, 0xffff0000, v42
    v_pk_add_f32 v[46:47], v[46:47], v[52:53]
    v_pk_fma_f32 v[50:51], v[52:53], v[52:53], v[50:51]
    v_lshlrev_b32_e64 v52, 16, v43
    v_and_b32 v53, 0xffff0000, v43
    v_pk_add_f32 v[46:47], v[46:47], v[52:53]
    v_pk_fma_f32 v[50:51], v[52:53], v[52:53], v[50:51]
    v_lshlrev_b32_e64 v52, 16, v44
    v_and_b32 v53, 0xffff0000, v44
    v_pk_add_f32 v[46:47], v[46:47], v[52:53]
    v_pk_fma_f32 v[50:51], v[52:53], v[52:53], v[50:51]
    v_lshlrev_b32_e64 v52, 16, v45
    v_and_b32 v53, 0xffff0000, v45
    v_pk_add_f32 v[46:47], v[46:47], v[52:53]
    v_pk_fma_f32 v[50:51], v[52:53], v[52:53], v[50:51]
    v_add_f32_e64 v51, v50, v51
    v_add_f32 v50, v46, v47
    s_nop 0
    v_add_f32_dpp v51, v51, v51 quad_perm:[1,0,3,2] row_mask:0xf bank_mask:0xf
    v_add_f32_dpp v50, v50, v50 quad_perm:[1,0,3,2] row_mask:0xf bank_mask:0xf
    s_nop 0
    v_add_f32_dpp v51, v51, v51 quad_perm:[2,3,0,1] row_mask:0xf bank_mask:0xf
    v_add_f32_dpp v50, v50, v50 quad_perm:[2,3,0,1] row_mask:0xf bank_mask:0xf
    s_nop 0
    v_add_f32_dpp v51, v51, v51 row_half_mirror row_mask:0xf bank_mask:0xf
    v_add_f32_dpp v50, v50, v50 row_half_mirror row_mask:0xf bank_mask:0xf
    s_nop 0
    v_add_f32_dpp v51, v51, v51 row_mirror row_mask:0xf bank_mask:0xf
    v_add_f32_dpp v50, v50, v50 row_mirror row_mask:0xf bank_mask:0xf
    s_nop 0
    v_add_f32_dpp v51, v51, v51 row_bcast:15 row_mask:0xa bank_mask:0xf
    v_add_f32_dpp v50, v50, v50 row_bcast:15 row_mask:0xa bank_mask:0xf
    v_mul_f32 v50, 0x3b124925, v50
    v_mul_f32 v51, 0x3b124925, v51
    v_fma_f32 v51, -v50, v50, v51
    v_max_f32_e64 v51, 0, v51
    v_cvt_pk_bf16_f32 v50, -v50, v51
    v_and_b32 v51, 0xffff0000, v50
    v_lshlrev_b32_e64 v50, 16, v50
    v_add_f32 v51, 0x3727c5ac, v51
    v_cvt_pk_bf16_f32 v51, v51, v51
    v_and_b32 v51, 0xffff0000, v51
    v_sqrt_f32 v51, v51
    s_nop 0
    v_cvt_pk_bf16_f32 v51, v51, v51
    v_and_b32 v51, 0xffff0000, v51
    v_rcp_f32 v51, v51
    s_nop 0
    v_cndmask_b32 v50, v50, v51, s[80:81]
    v_or_b32_e64 v50, 1, v50
    ds_write_b32 v48, v50
    s_add_u32 m0, s65, 1152
    s_nop 0
    s_nop 0
    buffer_load_dwordx4 v2, s[24:27], s74 offen offset:896 lds
    buffer_load_dwordx4 v3, s[24:27], s74 offen offset:1920 lds
    s_add_u32 m0, s66, 24576
    s_add_u32 s67, s75, 86016
    buffer_load_dwordx4 v4, s[28:31], s67 offen offset:0 lds
    buffer_load_dwordx4 v5, s[28:31], s67 offen offset:1024 lds
    buffer_load_dwordx4 v6, s[28:31], s67 offen offset:2048 lds
    s_add_u32 m0, s66, 27648
    s_add_u32 s67, s75, 129024
    buffer_load_dwordx4 v4, s[28:31], s67 offen offset:0 lds
    buffer_load_dwordx4 v5, s[28:31], s67 offen offset:1024 lds
    buffer_load_dwordx4 v6, s[28:31], s67 offen offset:2048 lds
    s_waitcnt vmcnt(6) lgkmcnt(0)
    s_barrier
    buffer_load_dword v27, off, s[52:55], 0 offset:0 sc1
    ds_read_b64_tr_b16 a[32:33], v11 offset:0
    ds_read_b64_tr_b16 a[34:35], v11 offset:6144
    ds_read_b64_tr_b16 a[36:37], v12 offset:0
    ds_read_b64_tr_b16 a[38:39], v12 offset:6144
    ds_read_b64_tr_b16 a[40:41], v11 offset:1024
    ds_read_b64_tr_b16 a[42:43], v11 offset:7168
    ds_read_b64_tr_b16 a[44:45], v12 offset:1024
    ds_read_b64_tr_b16 a[46:47], v12 offset:7168
    ds_read_b64_tr_b16 a[48:49], v11 offset:2048
    ds_read_b64_tr_b16 a[50:51], v11 offset:8192
    ds_read_b64_tr_b16 a[52:53], v12 offset:2048
    ds_read_b64_tr_b16 a[54:55], v12 offset:8192
    ds_read_b128 a[0:3], v7 offset:0
    ds_read_b128 a[8:11], v7 offset:8192
    s_waitcnt lgkmcnt(1)
    v_mfma_f32_16x16x32_bf16 v[64:67], a[32:35], a[0:3], 0
    s_add_u32 s74, s74, 128
    ds_read_b128 a[16:19], v7 offset:1024
    v_mfma_f32_16x16x32_bf16 v[68:71], a[36:39], a[0:3], 0
    s_cmp_eq_u32 s74, 896
    s_cselect_b32 s74, 0, s74
    v_mfma_f32_16x16x32_bf16 v[128:131], a[40:43], a[0:3], 0
    s_add_u32 m0, s65, 16640
    v_and_b32_e64 v42, 3, v0
    v_mfma_f32_16x16x32_bf16 v[132:135], a[44:47], a[0:3], 0
    buffer_load_dwordx4 v2, s[24:27], s74 offen offset:0 lds
    v_mfma_f32_16x16x32_bf16 v[192:195], a[0:3], a[48:51], 0
    buffer_load_dwordx4 v3, s[24:27], s74 offen offset:1024 lds
    v_mfma_f32_16x16x32_bf16 v[224:227], a[0:3], a[52:55], 0
    s_add_u32 m0, s65, 17792
    s_waitcnt lgkmcnt(1)
    v_mfma_f32_16x16x32_bf16 v[228:231], a[8:11], a[52:55], 0
    buffer_load_dwordx4 v2, s[24:27], s74 offen offset:896 lds
    buffer_load_dwordx4 v3, s[24:27], s74 offen offset:1920 lds
    s_add_u32 m0, s66, 49152
    s_add_u32 s75, s75, 172032
    s_cmp_eq_u32 s75, 1204224
    s_cselect_b32 s75, 0, s75
    s_add_u32 s67, s75, 0
    buffer_load_dwordx4 v4, s[28:31], s67 offen offset:0 lds
    buffer_load_dwordx4 v5, s[28:31], s67 offen offset:1024 lds
    buffer_load_dwordx4 v6, s[28:31], s67 offen offset:2048 lds
    s_waitcnt vmcnt(8)
    s_barrier
    v_mfma_f32_16x16x32_bf16 v[196:199], a[8:11], a[48:51], 0
    ds_read_b128 a[24:27], v7 offset:9216
    s_add_u32 m0, s66, 52224
    v_mfma_f32_16x16x32_bf16 v[140:143], a[44:47], a[8:11], 0
    ds_read_b64_tr_b16 a[56:57], v11 offset:24576
    s_add_u32 s67, s75, 43008
    v_mfma_f32_16x16x32_bf16 v[136:139], a[40:43], a[8:11], 0
    ds_read_b64_tr_b16 a[58:59], v11 offset:30720
    v_lshlrev_b32 v42, 4, v42
    v_mfma_f32_16x16x32_bf16 v[76:79], a[36:39], a[8:11], 0
    ds_read_b64_tr_b16 a[60:61], v12 offset:24576
    v_add_u32 v42, 163712, v42
    v_mfma_f32_16x16x32_bf16 v[72:75], a[32:35], a[8:11], 0
    ds_read_b64_tr_b16 a[62:63], v12 offset:30720
    s_waitcnt lgkmcnt(5)
    v_mfma_f32_16x16x32_bf16 v[80:83], a[32:35], a[16:19], 0
    ds_read_b64_tr_b16 a[64:65], v11 offset:25600
    v_mfma_f32_16x16x32_bf16 v[84:87], a[36:39], a[16:19], 0
    ds_read_b64_tr_b16 a[66:67], v11 offset:31744
    v_mfma_f32_16x16x32_bf16 v[144:147], a[40:43], a[16:19], 0
    ds_read_b64_tr_b16 a[68:69], v12 offset:25600
    v_mfma_f32_16x16x32_bf16 v[148:151], a[44:47], a[16:19], 0
    ds_read_b64_tr_b16 a[70:71], v12 offset:31744
    v_mfma_f32_16x16x32_bf16 v[200:203], a[16:19], a[48:51], 0
    ds_read_b64_tr_b16 a[72:73], v11 offset:26624
    v_mfma_f32_16x16x32_bf16 v[232:235], a[16:19], a[52:55], 0
    ds_read_b64_tr_b16 a[74:75], v11 offset:32768
    s_waitcnt lgkmcnt(10)
    v_mfma_f32_16x16x32_bf16 v[236:239], a[24:27], a[52:55], 0
    ds_read_b64_tr_b16 a[76:77], v12 offset:26624
    v_mfma_f32_16x16x32_bf16 v[204:207], a[24:27], a[48:51], 0
    ds_read_b64_tr_b16 a[78:79], v12 offset:32768
    v_mfma_f32_16x16x32_bf16 v[156:159], a[44:47], a[24:27], 0
    ds_read_b128 a[0:3], v9 offset:11264
    v_mfma_f32_16x16x32_bf16 v[152:155], a[40:43], a[24:27], 0
    ds_read_b128 a[4:7], v10 offset:11264
    v_mfma_f32_16x16x32_bf16 v[92:95], a[36:39], a[24:27], 0
    ds_read_b128 a[8:11], v7 offset:2048
    v_mfma_f32_16x16x32_bf16 v[88:91], a[32:35], a[24:27], 0
    ds_read_b128 a[12:15], v8 offset:2048
    s_waitcnt lgkmcnt(2)
    v_mfma_f32_16x16x32_bf16 v[120:123], a[32:35], a[0:3], 0
    buffer_load_dwordx4 v4, s[28:31], s67 offen offset:0 lds
    v_mfma_f32_16x16x32_bf16 v[120:123], a[56:59], a[4:7], v[120:123]
    buffer_load_dwordx4 v5, s[28:31], s67 offen offset:1024 lds
    v_mfma_f32_16x16x32_bf16 v[124:127], a[60:63], a[4:7], 0
    ds_read_b128 a[16:19], v7 offset:10240
    v_mfma_f32_16x16x32_bf16 v[124:127], a[36:39], a[0:3], v[124:127]
    ds_read_b128 a[20:23], v8 offset:10240
    v_mfma_f32_16x16x32_bf16 v[184:187], a[40:43], a[0:3], 0
    buffer_load_dwordx4 v6, s[28:31], s67 offen offset:2048 lds
    v_mfma_f32_16x16x32_bf16 v[184:187], a[64:67], a[4:7], v[184:187]
    s_add_u32 m0, s66, 73728
    s_add_u32 s67, s75, 86016
    v_mfma_f32_16x16x32_bf16 v[188:191], a[68:71], a[4:7], 0
    ds_read_b128 v[38:41], v42
    s_lshl_b32 s61, s71, 6
    v_mfma_f32_16x16x32_bf16 v[188:191], a[44:47], a[0:3], v[188:191]
    buffer_load_dwordx4 v4, s[28:31], s67 offen offset:0 lds
    v_mfma_f32_16x16x32_bf16 v[220:223], a[0:3], a[48:51], 0
    s_add_u32 s61, s61, 9511040
    v_mfma_f32_16x16x32_bf16 v[220:223], a[4:7], a[72:75], v[220:223]
    s_cmp_eq_u32 s60, 0
    s_cselect_b32 s61, s61, 2147483632
    v_mfma_f32_16x16x32_bf16 v[252:255], a[4:7], a[76:79], 0
    buffer_load_dwordx4 v5, s[28:31], s67 offen offset:1024 lds
    v_mfma_f32_16x16x32_bf16 v[252:255], a[0:3], a[52:55], v[252:255]
    v_add_u32_e64 v42, s61, v42
    s_waitcnt lgkmcnt(3)
    v_mfma_f32_16x16x32_bf16 v[96:99], a[32:35], a[8:11], 0
    ds_read_b128 a[24:27], v7 offset:3072
    v_cmp_gt_u32_e64 vcc, 4, v0
    v_mfma_f32_16x16x32_bf16 v[96:99], a[56:59], a[12:15], v[96:99]
    ds_read_b128 a[28:31], v8 offset:3072
    v_cndmask_b32_e64 v42, v1, v42, vcc
    v_mfma_f32_16x16x32_bf16 v[100:103], a[60:63], a[12:15], 0
    buffer_load_dwordx4 v6, s[28:31], s67 offen offset:2048 lds
    v_mfma_f32_16x16x32_bf16 v[100:103], a[36:39], a[8:11], v[100:103]
    s_add_u32 m0, s66, 76800
    s_add_u32 s67, s75, 129024
    v_mfma_f32_16x16x32_bf16 v[160:163], a[40:43], a[8:11], 0
    v_mfma_f32_16x16x32_bf16 v[160:163], a[64:67], a[12:15], v[160:163]
    buffer_load_dwordx4 v4, s[28:31], s67 offen offset:0 lds
    v_mfma_f32_16x16x32_bf16 v[164:167], a[68:71], a[12:15], 0
    v_mfma_f32_16x16x32_bf16 v[164:167], a[44:47], a[8:11], v[164:167]
    v_mfma_f32_16x16x32_bf16 v[208:211], a[8:11], a[48:51], 0
    buffer_load_dwordx4 v5, s[28:31], s67 offen offset:1024 lds
    v_mfma_f32_16x16x32_bf16 v[208:211], a[12:15], a[72:75], v[208:211]
    v_mfma_f32_16x16x32_bf16 v[240:243], a[12:15], a[76:79], 0
    v_mfma_f32_16x16x32_bf16 v[240:243], a[8:11], a[52:55], v[240:243]
    s_waitcnt lgkmcnt(3)
    s_nop 0
    v_mfma_f32_16x16x32_bf16 v[104:107], a[32:35], a[16:19], 0
    buffer_load_dwordx4 v6, s[28:31], s67 offen offset:2048 lds
    s_add_u32 s74, s74, 128
    s_cmp_eq_u32 s74, 896
    s_cselect_b32 s74, 0, s74
    s_add_u32 m0, s65, 33280
    s_nop 0
    buffer_load_dwordx4 v2, s[24:27], s74 offen offset:0 lds
    buffer_load_dwordx4 v3, s[24:27], s74 offen offset:1024 lds
    s_waitcnt vmcnt(8)
    s_barrier
    v_mfma_f32_16x16x32_bf16 v[104:107], a[56:59], a[20:23], v[104:107]
    s_add_u32 m0, s65, 34432
    ds_read_b128 a[0:3], v8 offset:0
    v_mfma_f32_16x16x32_bf16 v[108:111], a[60:63], a[20:23], 0
    buffer_load_dwordx4 v2, s[24:27], s74 offen offset:896 lds
    v_mfma_f32_16x16x32_bf16 v[108:111], a[36:39], a[16:19], v[108:111]
    ds_read_b128 a[4:7], v7 offset:16640
    v_mfma_f32_16x16x32_bf16 v[168:171], a[40:43], a[16:19], 0
    ds_read_b64_tr_b16 a[80:81], v13 offset:0
    v_mfma_f32_16x16x32_bf16 v[168:171], a[64:67], a[20:23], v[168:171]
    ds_read_b64_tr_b16 a[82:83], v13 offset:6144
    v_mfma_f32_16x16x32_bf16 v[172:175], a[68:71], a[20:23], 0
    ds_read_b64_tr_b16 a[84:85], v14 offset:0
    v_mfma_f32_16x16x32_bf16 v[172:175], a[44:47], a[16:19], v[172:175]
    ds_read_b64_tr_b16 a[86:87], v14 offset:6144
    v_mfma_f32_16x16x32_bf16 v[212:215], a[16:19], a[48:51], 0
    ds_read_b64_tr_b16 a[88:89], v13 offset:1024
    v_mfma_f32_16x16x32_bf16 v[212:215], a[20:23], a[72:75], v[212:215]
    ds_read_b64_tr_b16 a[90:91], v13 offset:7168
    v_mfma_f32_16x16x32_bf16 v[244:247], a[20:23], a[76:79], 0
    ds_read_b64_tr_b16 a[92:93], v14 offset:1024
    v_mfma_f32_16x16x32_bf16 v[244:247], a[16:19], a[52:55], v[244:247]
    ds_read_b64_tr_b16 a[94:95], v14 offset:7168
    s_waitcnt lgkmcnt(10)
    v_mfma_f32_16x16x32_bf16 v[112:115], a[32:35], a[24:27], 0
    ds_read_b64_tr_b16 a[96:97], v13 offset:2048
    v_mfma_f32_16x16x32_bf16 v[112:115], a[56:59], a[28:31], v[112:115]
    ds_read_b64_tr_b16 a[98:99], v13 offset:8192
    v_mfma_f32_16x16x32_bf16 v[116:119], a[60:63], a[28:31], 0
    ds_read_b64_tr_b16 a[100:101], v14 offset:2048
    v_mfma_f32_16x16x32_bf16 v[116:119], a[36:39], a[24:27], v[116:119]
    ds_read_b64_tr_b16 a[102:103], v14 offset:8192
    v_mfma_f32_16x16x32_bf16 v[176:179], a[40:43], a[24:27], 0
    ds_read_b128 a[8:11], v8 offset:8192
    v_mfma_f32_16x16x32_bf16 v[176:179], a[64:67], a[28:31], v[176:179]
    ds_read_b128 a[12:15], v7 offset:24832
    v_mfma_f32_16x16x32_bf16 v[180:183], a[68:71], a[28:31], 0
    buffer_load_dwordx4 v3, s[24:27], s74 offen offset:1920 lds
    v_mfma_f32_16x16x32_bf16 v[180:183], a[44:47], a[24:27], v[180:183]
    s_add_u32 m0, s66, 0
    s_add_u32 s75, s75, 172032
    v_mfma_f32_16x16x32_bf16 v[216:219], a[24:27], a[48:51], 0
    s_cmp_eq_u32 s75, 1204224
    s_cselect_b32 s75, 0, s75
    v_mfma_f32_16x16x32_bf16 v[216:219], a[28:31], a[72:75], v[216:219]
    s_add_u32 s67, s75, 0
    v_mfma_f32_16x16x32_bf16 v[248:251], a[28:31], a[76:79], 0
    buffer_load_dwordx4 v4, s[28:31], s67 offen offset:0 lds
    v_mfma_f32_16x16x32_bf16 v[248:251], a[24:27], a[52:55], v[248:251]
    s_waitcnt lgkmcnt(2)
    v_and_b32_e64 v56, 15, v0
    v_lshlrev_b32 v15, 2, v56
    v_add_u32 v15, 148224, v15
    v_lshlrev_b32_e64 v16, 4, v55
    v_add_u32 v16, 148224, v16
    v_cmp_gt_u32 s[82:83], 48, v0
    v_lshlrev_b32 v57, 2, v55
    v_sub_u32 v57, v56, v57
    v_mov_b32 v59, 0xf149f2ca
    v_add_u32_e64 v58, 16, v57
    v_cmp_gt_u32 s[80:81], 8, v58
    s_nop 1
    v_cndmask_b32 v28, v59, 0, s[80:81]
    v_add_u32 v58, 15, v57
    v_cmp_gt_u32 s[80:81], 8, v58
    s_nop 1
    v_cndmask_b32 v29, v59, 0, s[80:81]
    v_add_u32 v58, 14, v57
    v_cmp_gt_u32 s[80:81], 8, v58
    s_nop 1
    v_cndmask_b32 v30, v59, 0, s[80:81]
    v_add_u32 v58, 13, v57
    v_cmp_gt_u32 s[80:81], 8, v58
    s_nop 1
    v_cndmask_b32 v31, v59, 0, s[80:81]
    v_add_u32 v58, 0, v57
    v_cmp_gt_u32 s[80:81], 8, v58
    s_nop 1
    v_cndmask_b32 v32, v59, 0, s[80:81]
    v_add_u32 v58, -1, v57
    v_cmp_gt_u32 s[80:81], 8, v58
    s_nop 1
    v_cndmask_b32 v33, v59, 0, s[80:81]
    v_add_u32 v58, -2, v57
    v_cmp_gt_u32 s[80:81], 8, v58
    s_nop 1
    v_cndmask_b32 v34, v59, 0, s[80:81]
    v_add_u32 v58, -3, v57
    v_cmp_gt_u32 s[80:81], 8, v58
    s_nop 1
    v_cndmask_b32 v35, v59, 0, s[80:81]
    s_mul_i32 s69, s56, 113
    s_lshl2_add_u32 s64, s57, s60
    s_add_u32 s64, s64, 56
    s_lshl_b32 s70, s64, 10
    s_cmp_eq_u32 s56, 0
    s_cselect_b32 s64, 0, 14
    s_mov_b32 s58, 26547
    s_mov_b32 s59, 368640
    s_mov_b32 s68, 73728
    v_mov_b32 v63, 2147483632
    v_lshl_add_u32 v57, v0, 1, 0
    v_add_u32_e64 v58, s69, v57
    v_mul_u32_u24 v59, s58, v58
    v_lshrrev_b32 v59, 22, v59
    v_mul_u32_u24 v60, 158, v59
    v_sub_u32_e64 v58, v58, v60
    v_bfe_u32 v60, v58, 4, 1
    v_lshl_add_u32 v59, v59, 1, v60
    v_mul_u32_u24 v59, s59, v59
    v_lshrrev_b32 v60, 5, v58
    v_mad_u32_u24 v59, v60, s68, v59
    v_bfe_u32 v60, v58, 1, 3
    v_lshl_add_u32 v59, v60, 4, v59
    v_and_b32_e64 v60, 1, v58
    v_lshl_add_u32 v20, v60, 7, v59
    v_cmp_le_u32 s[80:81], s64, v57
    s_nop 1
    v_cndmask_b32 v20, v63, v20, s[80:81]
    v_lshl_add_u32 v57, v0, 1, 1
    v_add_u32 v58, s69, v57
    v_mul_u32_u24 v59, s58, v58
    v_lshrrev_b32 v59, 22, v59
    v_mul_u32_u24 v60, 158, v59
    v_sub_u32_e64 v58, v58, v60
    v_bfe_u32 v60, v58, 4, 1
    v_lshl_add_u32 v59, v59, 1, v60
    v_mul_u32_u24 v59, s59, v59
    v_lshrrev_b32 v60, 5, v58
    v_mad_u32_u24 v59, v60, s68, v59
    v_bfe_u32 v60, v58, 1, 3
    v_lshl_add_u32 v59, v60, 4, v59
    v_and_b32_e64 v60, 1, v58
    v_lshl_add_u32 v21, v60, 7, v59
    v_cmp_le_u32 s[80:81], s64, v57
    s_nop 1
    v_cndmask_b32 v21, v63, v21, s[80:81]
    v_cmp_gt_u32 s[80:81], 63, v0
    s_nop 1
    v_cndmask_b32 v21, v63, v21, s[80:81]
    s_add_u32 s64, s64, s69
    s_mul_i32 s64, s64, 26547
    s_lshr_b32 s64, s64, 22
    s_add_u32 s69, s69, 126
    s_mul_i32 s69, s69, 26547
    s_lshr_b32 s69, s69, 22
    s_sub_u32 s69, s69, s64
    v_cmp_ge_u32 s[80:81], s69, v0
    v_lshlrev_b32_e64 v17, 9, v0
    s_lshl2_add_u32 s64, s64, s57
    s_lshl_b32 s64, s64, 7
    s_add_u32 s3, s64, 9666560
    v_cndmask_b32 v17, v63, v17, s[80:81]
    v_mfma_f32_16x16x32_bf16 v[64:67], a[56:59], a[0:3], v[64:67]
    buffer_load_dwordx4 v5, s[28:31], s67 offen offset:1024 lds
    v_mfma_f32_16x16x32_bf16 v[64:67], a[80:83], a[4:7], v[64:67]
    ds_read_b128 a[16:19], v8 offset:1024
    v_mfma_f32_16x16x32_bf16 v[68:71], a[84:87], a[4:7], v[68:71]
    buffer_load_dwordx4 v6, s[28:31], s67 offen offset:2048 lds
    v_mfma_f32_16x16x32_bf16 v[68:71], a[60:63], a[0:3], v[68:71]
    s_add_u32 m0, s66, 3072
    s_add_u32 s67, s75, 43008
    v_mfma_f32_16x16x32_bf16 v[128:131], a[64:67], a[0:3], v[128:131]
    ds_read_b128 a[20:23], v7 offset:17664
    v_mfma_f32_16x16x32_bf16 v[128:131], a[88:91], a[4:7], v[128:131]
    buffer_load_dwordx4 v4, s[28:31], s67 offen offset:0 lds
    v_mfma_f32_16x16x32_bf16 v[132:135], a[92:95], a[4:7], v[132:135]
    v_cmp_eq_u32_e64 vcc, 0, v27
    s_nop 4
    s_cbranch_vccnz La_cert
La_cert_r:
    v_mfma_f32_16x16x32_bf16 v[132:135], a[68:71], a[0:3], v[132:135]
    buffer_store_dwordx4 v[38:41], v42, s[36:39], 0 offen sc1
    v_mfma_f32_16x16x32_bf16 v[192:195], a[0:3], a[72:75], v[192:195]
    buffer_load_dwordx4 v5, s[28:31], s67 offen offset:1024 lds
    v_mfma_f32_16x16x32_bf16 v[192:195], a[4:7], a[96:99], v[192:195]
    s_and_b32 s61, s60, 1
    s_mul_i32 s62, s56, 113
    v_mfma_f32_16x16x32_bf16 v[224:227], a[4:7], a[100:103], v[224:227]
    s_add_u32 s62, s62, s61
    s_lshr_b32 s63, s62, 1
    v_mfma_f32_16x16x32_bf16 v[224:227], a[0:3], a[76:79], v[224:227]
    v_add_u32_e64 v44, s63, v0
    s_waitcnt lgkmcnt(2)
    v_mfma_f32_16x16x32_bf16 v[72:75], a[56:59], a[8:11], v[72:75]
    buffer_load_dwordx4 v6, s[28:31], s67 offen offset:2048 lds
    v_mfma_f32_16x16x32_bf16 v[72:75], a[80:83], a[12:15], v[72:75]
    s_add_u32 m0, s66, 24576
    s_add_u32 s67, s75, 86016
    v_mfma_f32_16x16x32_bf16 v[76:79], a[84:87], a[12:15], v[76:79]
    ds_read_b128 a[24:27], v8 offset:9216
    v_min_u32 v44, 1023, v44
    v_mfma_f32_16x16x32_bf16 v[76:79], a[60:63], a[8:11], v[76:79]
    buffer_load_dwordx4 v4, s[28:31], s67 offen offset:0 lds
    v_mfma_f32_16x16x32_bf16 v[136:139], a[64:67], a[8:11], v[136:139]
    ds_read_b128 a[28:31], v7 offset:25856
    v_and_b32_e64 v45, 7, v44
    v_mfma_f32_16x16x32_bf16 v[136:139], a[88:91], a[12:15], v[136:139]
    v_lshrrev_b32 v44, 3, v44
    v_lshlrev_b32 v44, 7, v44
    v_mfma_f32_16x16x32_bf16 v[140:143], a[92:95], a[12:15], v[140:143]
    buffer_load_dwordx4 v5, s[28:31], s67 offen offset:1024 lds
    v_mfma_f32_16x16x32_bf16 v[140:143], a[68:71], a[8:11], v[140:143]
    v_lshl_add_u32 v44, v45, 2, v44
    s_and_b32 s62, s62, 1
    v_mfma_f32_16x16x32_bf16 v[196:199], a[8:11], a[72:75], v[196:199]
    s_lshr_b32 s63, s60, 1
    s_lshl1_add_u32 s62, s62, s63
    v_mfma_f32_16x16x32_bf16 v[196:199], a[12:15], a[96:99], v[196:199]
    s_lshl_b32 s62, s62, 5
    s_add_u32 s62, s62, 9674752
    v_mfma_f32_16x16x32_bf16 v[228:231], a[12:15], a[100:103], v[228:231]
    buffer_load_dwordx4 v6, s[28:31], s67 offen offset:2048 lds
    v_mfma_f32_16x16x32_bf16 v[228:231], a[8:11], a[76:79], v[228:231]
    s_add_u32 m0, s66, 27648
    s_waitcnt lgkmcnt(2)
    v_mfma_f32_16x16x32_bf16 v[80:83], a[56:59], a[16:19], v[80:83]
    s_waitcnt vmcnt(14)
    s_barrier
    v_mfma_f32_16x16x32_bf16 v[80:83], a[80:83], a[20:23], v[80:83]
    s_add_u32 s67, s75, 129024
    ds_read_b128 a[0:3], v9 offset:27904
    v_mfma_f32_16x16x32_bf16 v[84:87], a[84:87], a[20:23], v[84:87]
    buffer_load_dwordx4 v4, s[28:31], s67 offen offset:0 lds
    v_mfma_f32_16x16x32_bf16 v[84:87], a[60:63], a[16:19], v[84:87]
    ds_read_b128 a[4:7], v10 offset:27904
    s_lshl1_add_u32 s61, s61, s63
    v_mfma_f32_16x16x32_bf16 v[144:147], a[64:67], a[16:19], v[144:147]
    ds_read_b64_tr_b16 a[32:33], v13 offset:24576
    s_lshl_b32 s61, s61, 8
    v_mfma_f32_16x16x32_bf16 v[144:147], a[88:91], a[20:23], v[144:147]
    ds_read_b64_tr_b16 a[34:35], v13 offset:30720
    s_add_u32 s61, s61, 148224
    v_mfma_f32_16x16x32_bf16 v[148:151], a[92:95], a[20:23], v[148:151]
    ds_read_b64_tr_b16 a[36:37], v14 offset:24576
    v_lshl_add_u32 v45, v0, 2, s61
    v_mfma_f32_16x16x32_bf16 v[148:151], a[68:71], a[16:19], v[148:151]
    ds_read_b64_tr_b16 a[38:39], v14 offset:30720
    v_mfma_f32_16x16x32_bf16 v[200:203], a[16:19], a[72:75], v[200:203]
    ds_read_b64_tr_b16 a[40:41], v13 offset:25600
    v_mfma_f32_16x16x32_bf16 v[200:203], a[20:23], a[96:99], v[200:203]
    ds_read_b64_tr_b16 a[42:43], v13 offset:31744
    v_mfma_f32_16x16x32_bf16 v[232:235], a[20:23], a[100:103], v[232:235]
    ds_read_b64_tr_b16 a[44:45], v14 offset:25600
    v_mfma_f32_16x16x32_bf16 v[232:235], a[16:19], a[76:79], v[232:235]
    ds_read_b64_tr_b16 a[46:47], v14 offset:31744
    s_waitcnt lgkmcnt(10)
    v_mfma_f32_16x16x32_bf16 v[88:91], a[56:59], a[24:27], v[88:91]
    ds_read_b64_tr_b16 a[48:49], v13 offset:26624
    v_mfma_f32_16x16x32_bf16 v[88:91], a[80:83], a[28:31], v[88:91]
    ds_read_b64_tr_b16 a[50:51], v13 offset:32768
    v_mfma_f32_16x16x32_bf16 v[92:95], a[84:87], a[28:31], v[92:95]
    ds_read_b64_tr_b16 a[52:53], v14 offset:26624
    v_mfma_f32_16x16x32_bf16 v[92:95], a[60:63], a[24:27], v[92:95]
    ds_read_b64_tr_b16 a[54:55], v14 offset:32768
    v_mfma_f32_16x16x32_bf16 v[152:155], a[64:67], a[24:27], v[152:155]
    ds_read_b128 a[8:11], v7 offset:18688
    v_mfma_f32_16x16x32_bf16 v[152:155], a[88:91], a[28:31], v[152:155]
    ds_read_b128 a[12:15], v8 offset:18688
    v_mfma_f32_16x16x32_bf16 v[156:159], a[92:95], a[28:31], v[156:159]
    buffer_load_dwordx4 v5, s[28:31], s67 offen offset:1024 lds
    v_mfma_f32_16x16x32_bf16 v[156:159], a[68:71], a[24:27], v[156:159]
    buffer_load_dwordx4 v6, s[28:31], s67 offen offset:2048 lds
    v_mfma_f32_16x16x32_bf16 v[204:207], a[24:27], a[72:75], v[204:207]
    s_add_u32 m0, s66, 49152
    s_add_u32 s75, s75, 172032
    v_mfma_f32_16x16x32_bf16 v[204:207], a[28:31], a[96:99], v[204:207]
    s_cmp_eq_u32 s75, 1204224
    s_cselect_b32 s75, 0, s75
    v_mfma_f32_16x16x32_bf16 v[236:239], a[28:31], a[100:103], v[236:239]
    s_add_u32 s67, s75, 0
    v_mfma_f32_16x16x32_bf16 v[236:239], a[24:27], a[76:79], v[236:239]
    s_waitcnt lgkmcnt(2)
    s_nop 0
    v_mfma_f32_16x16x32_bf16 v[120:123], a[80:83], a[0:3], v[120:123]
    buffer_load_dwordx4 v4, s[28:31], s67 offen offset:0 lds
    v_mfma_f32_16x16x32_bf16 v[120:123], a[32:35], a[4:7], v[120:123]
    ds_read_b128 a[16:19], v7 offset:26880
    v_mfma_f32_16x16x32_bf16 v[124:127], a[36:39], a[4:7], v[124:127]
    buffer_load_dwordx4 v5, s[28:31], s67 offen offset:1024 lds
    v_mfma_f32_16x16x32_bf16 v[124:127], a[84:87], a[0:3], v[124:127]
    ds_read_b128 a[20:23], v8 offset:26880
    v_mfma_f32_16x16x32_bf16 v[184:187], a[88:91], a[0:3], v[184:187]
    v_mfma_f32_16x16x32_bf16 v[184:187], a[40:43], a[4:7], v[184:187]
    v_mfma_f32_16x16x32_bf16 v[188:191], a[44:47], a[4:7], v[188:191]
    v_mfma_f32_16x16x32_bf16 v[188:191], a[92:95], a[0:3], v[188:191]
    buffer_load_dwordx4 v6, s[28:31], s67 offen offset:2048 lds
    v_mfma_f32_16x16x32_bf16 v[220:223], a[0:3], a[96:99], v[220:223]
    s_add_u32 m0, s66, 52224
    s_add_u32 s67, s75, 43008
    v_mfma_f32_16x16x32_bf16 v[220:223], a[4:7], a[48:51], v[220:223]
    v_mfma_f32_16x16x32_bf16 v[252:255], a[4:7], a[52:55], v[252:255]
    v_mfma_f32_16x16x32_bf16 v[252:255], a[0:3], a[100:103], v[252:255]
    s_waitcnt lgkmcnt(2)
    s_nop 0
    v_mfma_f32_16x16x32_bf16 v[96:99], a[80:83], a[8:11], v[96:99]
    buffer_load_dwordx4 v4, s[28:31], s67 offen offset:0 lds
    v_mfma_f32_16x16x32_bf16 v[96:99], a[32:35], a[12:15], v[96:99]
    ds_read_b128 a[24:27], v7 offset:19712
    v_mfma_f32_16x16x32_bf16 v[100:103], a[36:39], a[12:15], v[100:103]
    ds_read_b128 a[28:31], v8 offset:19712
    v_mfma_f32_16x16x32_bf16 v[100:103], a[84:87], a[8:11], v[100:103]
    v_mfma_f32_16x16x32_bf16 v[160:163], a[88:91], a[8:11], v[160:163]
    v_mfma_f32_16x16x32_bf16 v[160:163], a[40:43], a[12:15], v[160:163]
    buffer_load_dwordx4 v5, s[28:31], s67 offen offset:1024 lds
    v_mfma_f32_16x16x32_bf16 v[164:167], a[44:47], a[12:15], v[164:167]
    v_mfma_f32_16x16x32_bf16 v[164:167], a[92:95], a[8:11], v[164:167]
    v_mfma_f32_16x16x32_bf16 v[208:211], a[8:11], a[96:99], v[208:211]
    v_mfma_f32_16x16x32_bf16 v[208:211], a[12:15], a[48:51], v[208:211]
    v_mfma_f32_16x16x32_bf16 v[240:243], a[12:15], a[52:55], v[240:243]
    buffer_load_dwordx4 v6, s[28:31], s67 offen offset:2048 lds
    v_mfma_f32_16x16x32_bf16 v[240:243], a[8:11], a[100:103], v[240:243]
    s_add_u32 s74, s74, 128
    s_waitcnt lgkmcnt(2)
    v_mfma_f32_16x16x32_bf16 v[104:107], a[80:83], a[16:19], v[104:107]
    s_waitcnt vmcnt(12)
    s_barrier
    v_mfma_f32_16x16x32_bf16 v[104:107], a[32:35], a[20:23], v[104:107]
    s_cmp_eq_u32 s74, 896
    s_cselect_b32 s74, 0, s74
    v_mfma_f32_16x16x32_bf16 v[108:111], a[36:39], a[20:23], v[108:111]
    ds_read_b128 a[0:3], v8 offset:16640
    s_add_u32 m0, s65, 0
    v_mfma_f32_16x16x32_bf16 v[108:111], a[84:87], a[16:19], v[108:111]
    ds_read_b128 a[4:7], v7 offset:33280
    v_mfma_f32_16x16x32_bf16 v[168:171], a[88:91], a[16:19], v[168:171]
    ds_read_b64_tr_b16 a[56:57], v11 offset:0
    v_mfma_f32_16x16x32_bf16 v[168:171], a[40:43], a[20:23], v[168:171]
    ds_read_b64_tr_b16 a[58:59], v11 offset:6144
    v_mfma_f32_16x16x32_bf16 v[172:175], a[44:47], a[20:23], v[172:175]
    ds_read_b64_tr_b16 a[60:61], v12 offset:0
    v_mfma_f32_16x16x32_bf16 v[172:175], a[92:95], a[16:19], v[172:175]
    ds_read_b64_tr_b16 a[62:63], v12 offset:6144
    v_mfma_f32_16x16x32_bf16 v[212:215], a[16:19], a[96:99], v[212:215]
    ds_read_b64_tr_b16 a[64:65], v11 offset:1024
    v_mfma_f32_16x16x32_bf16 v[212:215], a[20:23], a[48:51], v[212:215]
    ds_read_b64_tr_b16 a[66:67], v11 offset:7168
    v_mfma_f32_16x16x32_bf16 v[244:247], a[20:23], a[52:55], v[244:247]
    ds_read_b64_tr_b16 a[68:69], v12 offset:1024
    v_mfma_f32_16x16x32_bf16 v[244:247], a[16:19], a[100:103], v[244:247]
    ds_read_b64_tr_b16 a[70:71], v12 offset:7168
    s_waitcnt lgkmcnt(10)
    v_mfma_f32_16x16x32_bf16 v[112:115], a[80:83], a[24:27], v[112:115]
    ds_read_b64_tr_b16 a[72:73], v11 offset:2048
    v_mfma_f32_16x16x32_bf16 v[112:115], a[32:35], a[28:31], v[112:115]
    ds_read_b64_tr_b16 a[74:75], v11 offset:8192
    v_mfma_f32_16x16x32_bf16 v[116:119], a[36:39], a[28:31], v[116:119]
    ds_read_b64_tr_b16 a[76:77], v12 offset:2048
    v_mfma_f32_16x16x32_bf16 v[116:119], a[84:87], a[24:27], v[116:119]
    ds_read_b64_tr_b16 a[78:79], v12 offset:8192
    v_mfma_f32_16x16x32_bf16 v[176:179], a[88:91], a[24:27], v[176:179]
    ds_read_b128 a[8:11], v8 offset:24832
    v_mfma_f32_16x16x32_bf16 v[176:179], a[40:43], a[28:31], v[176:179]
    ds_read_b128 a[12:15], v7 offset:41472
    v_mfma_f32_16x16x32_bf16 v[180:183], a[44:47], a[28:31], v[180:183]
    buffer_load_dwordx4 v2, s[24:27], s74 offen offset:0 lds
    v_mfma_f32_16x16x32_bf16 v[180:183], a[92:95], a[24:27], v[180:183]
    buffer_load_dwordx4 v3, s[24:27], s74 offen offset:1024 lds
    v_mfma_f32_16x16x32_bf16 v[216:219], a[24:27], a[96:99], v[216:219]
    s_add_u32 m0, s65, 1152
    v_mfma_f32_16x16x32_bf16 v[216:219], a[28:31], a[48:51], v[216:219]
    v_mfma_f32_16x16x32_bf16 v[248:251], a[28:31], a[52:55], v[248:251]
    v_mfma_f32_16x16x32_bf16 v[248:251], a[24:27], a[100:103], v[248:251]
    s_waitcnt lgkmcnt(2)
    s_nop 0
    v_mfma_f32_16x16x32_bf16 v[64:67], a[32:35], a[0:3], v[64:67]
    buffer_load_dwordx4 v2, s[24:27], s74 offen offset:896 lds
    v_mfma_f32_16x16x32_bf16 v[64:67], a[56:59], a[4:7], v[64:67]
    ds_read_b128 a[16:19], v8 offset:17664
    v_mfma_f32_16x16x32_bf16 v[68:71], a[60:63], a[4:7], v[68:71]
    ds_read_b128 a[20:23], v7 offset:34304
    v_mfma_f32_16x16x32_bf16 v[68:71], a[36:39], a[0:3], v[68:71]
    v_mfma_f32_16x16x32_bf16 v[128:131], a[40:43], a[0:3], v[128:131]
    buffer_load_dwordx4 v3, s[24:27], s74 offen offset:1920 lds
    v_mfma_f32_16x16x32_bf16 v[128:131], a[64:67], a[4:7], v[128:131]
    s_add_u32 m0, s66, 73728
    s_add_u32 s67, s75, 86016
    v_mfma_f32_16x16x32_bf16 v[132:135], a[68:71], a[4:7], v[132:135]
    v_mfma_f32_16x16x32_bf16 v[132:135], a[44:47], a[0:3], v[132:135]
    v_mfma_f32_16x16x32_bf16 v[192:195], a[0:3], a[48:51], v[192:195]
    v_mfma_f32_16x16x32_bf16 v[192:195], a[4:7], a[72:75], v[192:195]
    buffer_load_dwordx4 v4, s[28:31], s67 offen offset:0 lds
    v_mfma_f32_16x16x32_bf16 v[224:227], a[4:7], a[76:79], v[224:227]
    v_mfma_f32_16x16x32_bf16 v[224:227], a[0:3], a[52:55], v[224:227]
    s_waitcnt lgkmcnt(2)
    s_nop 0
    v_mfma_f32_16x16x32_bf16 v[72:75], a[32:35], a[8:11], v[72:75]
    ds_read_b128 a[24:27], v8 offset:25856
    v_mfma_f32_16x16x32_bf16 v[72:75], a[56:59], a[12:15], v[72:75]
    ds_read_b128 a[28:31], v7 offset:42496
    v_mfma_f32_16x16x32_bf16 v[76:79], a[60:63], a[12:15], v[76:79]
    buffer_load_dwordx4 v5, s[28:31], s67 offen offset:1024 lds
    v_mfma_f32_16x16x32_bf16 v[76:79], a[36:39], a[8:11], v[76:79]
    s_lshl2_add_u32 s79, s56, s57
    s_lshl2_add_u32 s79, s79, s60
    v_mfma_f32_16x16x32_bf16 v[136:139], a[40:43], a[8:11], v[136:139]
    s_mul_i32 s72, s79, 44
    s_mul_i32 s79, s79, 11
    v_mfma_f32_16x16x32_bf16 v[136:139], a[64:67], a[12:15], v[136:139]
    v_min_u32 v18, 43, v0
    v_add_u32 v18, s72, v18
    v_mfma_f32_16x16x32_bf16 v[140:143], a[68:71], a[12:15], v[140:143]
    v_min_u32 v18, 12543, v18
    v_lshlrev_b32_e64 v18, 7, v18
    v_mfma_f32_16x16x32_bf16 v[140:143], a[44:47], a[8:11], v[140:143]
    global_load_dword v19, v18, s[16:17]
    v_mfma_f32_16x16x32_bf16 v[196:199], a[8:11], a[48:51], v[196:199]
    v_min_u32 v18, 10, v0
    v_add_u32 v18, s79, v18
    v_mfma_f32_16x16x32_bf16 v[196:199], a[12:15], a[72:75], v[196:199]
    v_min_u32 v18, 3135, v18
    v_lshlrev_b32_e64 v18, 7, v18
    v_mfma_f32_16x16x32_bf16 v[228:231], a[12:15], a[76:79], v[228:231]
    global_load_dword v19, v18, s[8:9]
    v_mfma_f32_16x16x32_bf16 v[228:231], a[8:11], a[52:55], v[228:231]
    s_waitcnt lgkmcnt(2)
    v_mfma_f32_16x16x32_bf16 v[80:83], a[32:35], a[16:19], v[80:83]
    s_waitcnt vmcnt(14)
    s_barrier
    v_mfma_f32_16x16x32_bf16 v[80:83], a[56:59], a[20:23], v[80:83]
    buffer_load_dwordx4 v6, s[28:31], s67 offen offset:2048 lds
    v_mfma_f32_16x16x32_bf16 v[84:87], a[60:63], a[20:23], v[84:87]
    ds_read_b128 a[0:3], v9 offset:44544
    s_add_u32 m0, s66, 76800
    v_mfma_f32_16x16x32_bf16 v[84:87], a[36:39], a[16:19], v[84:87]
    ds_read_b128 a[4:7], v10 offset:44544
    s_add_u32 s67, s75, 129024
    v_mfma_f32_16x16x32_bf16 v[144:147], a[40:43], a[16:19], v[144:147]
    ds_read_b64_tr_b16 a[80:81], v11 offset:24576
    v_mfma_f32_16x16x32_bf16 v[144:147], a[64:67], a[20:23], v[144:147]
    ds_read_b64_tr_b16 a[82:83], v11 offset:30720
    v_mfma_f32_16x16x32_bf16 v[148:151], a[68:71], a[20:23], v[148:151]
    ds_read_b64_tr_b16 a[84:85], v12 offset:24576
    v_mfma_f32_16x16x32_bf16 v[148:151], a[44:47], a[16:19], v[148:151]
    ds_read_b64_tr_b16 a[86:87], v12 offset:30720
    v_mfma_f32_16x16x32_bf16 v[200:203], a[16:19], a[48:51], v[200:203]
    ds_read_b64_tr_b16 a[88:89], v11 offset:25600
    v_mfma_f32_16x16x32_bf16 v[200:203], a[20:23], a[72:75], v[200:203]
    ds_read_b64_tr_b16 a[90:91], v11 offset:31744
    v_mfma_f32_16x16x32_bf16 v[232:235], a[20:23], a[76:79], v[232:235]
    ds_read_b64_tr_b16 a[92:93], v12 offset:25600
    v_mfma_f32_16x16x32_bf16 v[232:235], a[16:19], a[52:55], v[232:235]
    ds_read_b64_tr_b16 a[94:95], v12 offset:31744
    s_waitcnt lgkmcnt(10)
    v_mfma_f32_16x16x32_bf16 v[88:91], a[32:35], a[24:27], v[88:91]
    ds_read_b64_tr_b16 a[96:97], v11 offset:26624
    v_mfma_f32_16x16x32_bf16 v[88:91], a[56:59], a[28:31], v[88:91]
    ds_read_b64_tr_b16 a[98:99], v11 offset:32768
    v_mfma_f32_16x16x32_bf16 v[92:95], a[60:63], a[28:31], v[92:95]
    ds_read_b64_tr_b16 a[100:101], v12 offset:26624
    v_mfma_f32_16x16x32_bf16 v[92:95], a[36:39], a[24:27], v[92:95]
    ds_read_b64_tr_b16 a[102:103], v12 offset:32768
    v_mfma_f32_16x16x32_bf16 v[152:155], a[40:43], a[24:27], v[152:155]
    ds_read_b128 a[8:11], v7 offset:35328
    v_mfma_f32_16x16x32_bf16 v[152:155], a[64:67], a[28:31], v[152:155]
    ds_read_b128 a[12:15], v8 offset:35328
    v_mfma_f32_16x16x32_bf16 v[156:159], a[68:71], a[28:31], v[156:159]
    buffer_load_dwordx4 v4, s[28:31], s67 offen offset:0 lds
    v_mfma_f32_16x16x32_bf16 v[156:159], a[44:47], a[24:27], v[156:159]
    buffer_load_dwordx4 v5, s[28:31], s67 offen offset:1024 lds
    v_mfma_f32_16x16x32_bf16 v[204:207], a[24:27], a[48:51], v[204:207]
    v_mfma_f32_16x16x32_bf16 v[204:207], a[28:31], a[72:75], v[204:207]
    v_mfma_f32_16x16x32_bf16 v[236:239], a[28:31], a[76:79], v[236:239]
    v_mfma_f32_16x16x32_bf16 v[236:239], a[24:27], a[52:55], v[236:239]
    s_waitcnt lgkmcnt(2)
    v_mfma_f32_16x16x32_bf16 v[120:123], a[56:59], a[0:3], v[120:123]
    buffer_load_dwordx4 v6, s[28:31], s67 offen offset:2048 lds
    v_mfma_f32_16x16x32_bf16 v[120:123], a[80:83], a[4:7], v[120:123]
    s_add_u32 m0, s66, 0
    s_add_u32 s75, s75, 172032
    v_mfma_f32_16x16x32_bf16 v[124:127], a[84:87], a[4:7], v[124:127]
    s_cmp_eq_u32 s75, 1204224
    s_cselect_b32 s75, 0, s75
    v_mfma_f32_16x16x32_bf16 v[124:127], a[60:63], a[0:3], v[124:127]
    s_add_u32 s67, s75, 0
    ds_read_b128 a[16:19], v7 offset:43520
    v_mfma_f32_16x16x32_bf16 v[184:187], a[64:67], a[0:3], v[184:187]
    buffer_load_dwordx4 v4, s[28:31], s67 offen offset:0 lds
    v_mfma_f32_16x16x32_bf16 v[184:187], a[88:91], a[4:7], v[184:187]
    ds_read_b128 a[20:23], v8 offset:43520
    v_mfma_f32_16x16x32_bf16 v[188:191], a[92:95], a[4:7], v[188:191]
    v_mfma_f32_16x16x32_bf16 v[188:191], a[68:71], a[0:3], v[188:191]
    v_mfma_f32_16x16x32_bf16 v[220:223], a[0:3], a[72:75], v[220:223]
    v_mfma_f32_16x16x32_bf16 v[220:223], a[4:7], a[96:99], v[220:223]
    buffer_load_dwordx4 v5, s[28:31], s67 offen offset:1024 lds
    v_mfma_f32_16x16x32_bf16 v[252:255], a[4:7], a[100:103], v[252:255]
    v_mfma_f32_16x16x32_bf16 v[252:255], a[0:3], a[76:79], v[252:255]
    s_waitcnt lgkmcnt(2)
    s_nop 0
    v_mfma_f32_16x16x32_bf16 v[96:99], a[56:59], a[8:11], v[96:99]
    ds_read_b128 a[24:27], v7 offset:36352
    v_mfma_f32_16x16x32_bf16 v[96:99], a[80:83], a[12:15], v[96:99]
    ds_read_b128 a[28:31], v8 offset:36352
    v_mfma_f32_16x16x32_bf16 v[100:103], a[84:87], a[12:15], v[100:103]
    buffer_load_dwordx4 v6, s[28:31], s67 offen offset:2048 lds
    v_mfma_f32_16x16x32_bf16 v[100:103], a[60:63], a[8:11], v[100:103]
    s_add_u32 m0, s66, 3072
    s_add_u32 s67, s75, 43008
    v_mfma_f32_16x16x32_bf16 v[160:163], a[64:67], a[8:11], v[160:163]
    v_mfma_f32_16x16x32_bf16 v[160:163], a[88:91], a[12:15], v[160:163]
    v_mfma_f32_16x16x32_bf16 v[164:167], a[92:95], a[12:15], v[164:167]
    v_mfma_f32_16x16x32_bf16 v[164:167], a[68:71], a[8:11], v[164:167]
    buffer_load_dwordx4 v4, s[28:31], s67 offen offset:0 lds
    v_mfma_f32_16x16x32_bf16 v[208:211], a[8:11], a[72:75], v[208:211]
    v_mfma_f32_16x16x32_bf16 v[208:211], a[12:15], a[96:99], v[208:211]
    v_mfma_f32_16x16x32_bf16 v[240:243], a[12:15], a[100:103], v[240:243]
    v_mfma_f32_16x16x32_bf16 v[240:243], a[8:11], a[76:79], v[240:243]
    s_waitcnt lgkmcnt(2)
    v_mfma_f32_16x16x32_bf16 v[104:107], a[56:59], a[16:19], v[104:107]
    s_waitcnt vmcnt(12)
    s_barrier
    v_mfma_f32_16x16x32_bf16 v[104:107], a[80:83], a[20:23], v[104:107]
    buffer_load_dwordx4 v5, s[28:31], s67 offen offset:1024 lds
    v_mfma_f32_16x16x32_bf16 v[108:111], a[84:87], a[20:23], v[108:111]
    ds_read_b128 a[0:3], v8 offset:33280
    v_mfma_f32_16x16x32_bf16 v[108:111], a[60:63], a[16:19], v[108:111]
    ds_read_b128 a[4:7], v7 offset:0
    v_mfma_f32_16x16x32_bf16 v[168:171], a[64:67], a[16:19], v[168:171]
    ds_read_b64_tr_b16 a[32:33], v13 offset:0
    v_mfma_f32_16x16x32_bf16 v[168:171], a[88:91], a[20:23], v[168:171]
    ds_read_b64_tr_b16 a[34:35], v13 offset:6144
    v_mfma_f32_16x16x32_bf16 v[172:175], a[92:95], a[20:23], v[172:175]
    ds_read_b64_tr_b16 a[36:37], v14 offset:0
    v_mfma_f32_16x16x32_bf16 v[172:175], a[68:71], a[16:19], v[172:175]
    ds_read_b64_tr_b16 a[38:39], v14 offset:6144
    v_mfma_f32_16x16x32_bf16 v[212:215], a[16:19], a[72:75], v[212:215]
    ds_read_b64_tr_b16 a[40:41], v13 offset:1024
    v_mfma_f32_16x16x32_bf16 v[212:215], a[20:23], a[96:99], v[212:215]
    ds_read_b64_tr_b16 a[42:43], v13 offset:7168
    v_mfma_f32_16x16x32_bf16 v[244:247], a[20:23], a[100:103], v[244:247]
    ds_read_b64_tr_b16 a[44:45], v14 offset:1024
    v_mfma_f32_16x16x32_bf16 v[244:247], a[16:19], a[76:79], v[244:247]
    ds_read_b64_tr_b16 a[46:47], v14 offset:7168
    s_waitcnt lgkmcnt(10)
    v_mfma_f32_16x16x32_bf16 v[112:115], a[56:59], a[24:27], v[112:115]
    ds_read_b64_tr_b16 a[48:49], v13 offset:2048
    v_mfma_f32_16x16x32_bf16 v[112:115], a[80:83], a[28:31], v[112:115]
    ds_read_b64_tr_b16 a[50:51], v13 offset:8192
    v_mfma_f32_16x16x32_bf16 v[116:119], a[84:87], a[28:31], v[116:119]
    ds_read_b64_tr_b16 a[52:53], v14 offset:2048
    v_mfma_f32_16x16x32_bf16 v[116:119], a[60:63], a[24:27], v[116:119]
    ds_read_b64_tr_b16 a[54:55], v14 offset:8192
    v_mfma_f32_16x16x32_bf16 v[176:179], a[64:67], a[24:27], v[176:179]
    ds_read_b128 a[8:11], v8 offset:41472
    v_mfma_f32_16x16x32_bf16 v[176:179], a[88:91], a[28:31], v[176:179]
    ds_read_b128 a[12:15], v7 offset:8192
    v_mfma_f32_16x16x32_bf16 v[180:183], a[92:95], a[28:31], v[180:183]
    buffer_load_dwordx4 v6, s[28:31], s67 offen offset:2048 lds
    v_mfma_f32_16x16x32_bf16 v[180:183], a[68:71], a[24:27], v[180:183]
    s_add_u32 s74, s74, 128
    v_mfma_f32_16x16x32_bf16 v[216:219], a[24:27], a[72:75], v[216:219]
    s_cmp_eq_u32 s74, 896
    s_cselect_b32 s74, 0, s74
    v_mfma_f32_16x16x32_bf16 v[216:219], a[28:31], a[96:99], v[216:219]
    s_add_u32 m0, s65, 16640
    v_mfma_f32_16x16x32_bf16 v[248:251], a[28:31], a[100:103], v[248:251]
    buffer_load_dwordx4 v2, s[24:27], s74 offen offset:0 lds
    v_mfma_f32_16x16x32_bf16 v[248:251], a[24:27], a[76:79], v[248:251]
    s_waitcnt lgkmcnt(2)
    v_mfma_f32_16x16x32_bf16 v[64:67], a[80:83], a[0:3], v[64:67]
    buffer_load_dwordx4 v3, s[24:27], s74 offen offset:1024 lds
    v_mfma_f32_16x16x32_bf16 v[64:67], a[32:35], a[4:7], v[64:67]
    s_add_u32 m0, s65, 17792
    ds_read_b128 a[16:19], v8 offset:34304
    v_mfma_f32_16x16x32_bf16 v[68:71], a[36:39], a[4:7], v[68:71]
    ds_read_b128 a[20:23], v7 offset:1024
    v_mfma_f32_16x16x32_bf16 v[68:71], a[84:87], a[0:3], v[68:71]
    v_mfma_f32_16x16x32_bf16 v[128:131], a[88:91], a[0:3], v[128:131]
    v_mfma_f32_16x16x32_bf16 v[128:131], a[40:43], a[4:7], v[128:131]
    buffer_load_dwordx4 v2, s[24:27], s74 offen offset:896 lds
    v_mfma_f32_16x16x32_bf16 v[132:135], a[44:47], a[4:7], v[132:135]
    v_mfma_f32_16x16x32_bf16 v[132:135], a[92:95], a[0:3], v[132:135]
    v_mfma_f32_16x16x32_bf16 v[192:195], a[0:3], a[96:99], v[192:195]
    v_mfma_f32_16x16x32_bf16 v[192:195], a[4:7], a[48:51], v[192:195]
    v_mfma_f32_16x16x32_bf16 v[224:227], a[4:7], a[52:55], v[224:227]
    buffer_load_dwordx4 v3, s[24:27], s74 offen offset:1920 lds
    v_mfma_f32_16x16x32_bf16 v[224:227], a[0:3], a[100:103], v[224:227]
    s_add_u32 m0, s66, 24576
    s_waitcnt lgkmcnt(2)
    v_mfma_f32_16x16x32_bf16 v[72:75], a[80:83], a[8:11], v[72:75]
    s_add_u32 s67, s75, 86016
    ds_read_b128 a[24:27], v8 offset:42496
    v_mfma_f32_16x16x32_bf16 v[72:75], a[32:35], a[12:15], v[72:75]
    ds_read_b128 a[28:31], v7 offset:9216
    v_mfma_f32_16x16x32_bf16 v[76:79], a[36:39], a[12:15], v[76:79]
    v_mfma_f32_16x16x32_bf16 v[76:79], a[84:87], a[8:11], v[76:79]
    buffer_load_dwordx4 v4, s[28:31], s67 offen offset:0 lds
    v_mfma_f32_16x16x32_bf16 v[136:139], a[88:91], a[8:11], v[136:139]
    v_mfma_f32_16x16x32_bf16 v[136:139], a[40:43], a[12:15], v[136:139]
    v_mfma_f32_16x16x32_bf16 v[140:143], a[44:47], a[12:15], v[140:143]
    v_mfma_f32_16x16x32_bf16 v[140:143], a[92:95], a[8:11], v[140:143]
    v_mfma_f32_16x16x32_bf16 v[196:199], a[8:11], a[96:99], v[196:199]
    buffer_load_dwordx4 v5, s[28:31], s67 offen offset:1024 lds
    v_mfma_f32_16x16x32_bf16 v[196:199], a[12:15], a[48:51], v[196:199]
    v_mfma_f32_16x16x32_bf16 v[228:231], a[12:15], a[52:55], v[228:231]
    v_mfma_f32_16x16x32_bf16 v[228:231], a[8:11], a[100:103], v[228:231]
    s_waitcnt lgkmcnt(2)
    v_mfma_f32_16x16x32_bf16 v[80:83], a[80:83], a[16:19], v[80:83]
    s_waitcnt vmcnt(12)
    s_barrier
    v_mfma_f32_16x16x32_bf16 v[80:83], a[32:35], a[20:23], v[80:83]
    ds_read_b128 a[0:3], v9 offset:11264
    v_mfma_f32_16x16x32_bf16 v[84:87], a[36:39], a[20:23], v[84:87]
    buffer_load_dwordx4 v6, s[28:31], s67 offen offset:2048 lds
    v_mfma_f32_16x16x32_bf16 v[84:87], a[84:87], a[16:19], v[84:87]
    ds_read_b128 a[4:7], v10 offset:11264
    s_add_u32 m0, s66, 27648
    v_mfma_f32_16x16x32_bf16 v[144:147], a[88:91], a[16:19], v[144:147]
    ds_read_b64_tr_b16 a[56:57], v13 offset:24576
    s_add_u32 s67, s75, 129024
    v_mfma_f32_16x16x32_bf16 v[144:147], a[40:43], a[20:23], v[144:147]
    ds_read_b64_tr_b16 a[58:59], v13 offset:30720
    v_mfma_f32_16x16x32_bf16 v[148:151], a[44:47], a[20:23], v[148:151]
    ds_read_b64_tr_b16 a[60:61], v14 offset:24576
    v_mfma_f32_16x16x32_bf16 v[148:151], a[92:95], a[16:19], v[148:151]
    ds_read_b64_tr_b16 a[62:63], v14 offset:30720
    v_mfma_f32_16x16x32_bf16 v[200:203], a[16:19], a[96:99], v[200:203]
    ds_read_b64_tr_b16 a[64:65], v13 offset:25600
    v_mfma_f32_16x16x32_bf16 v[200:203], a[20:23], a[48:51], v[200:203]
    ds_read_b64_tr_b16 a[66:67], v13 offset:31744
    v_mfma_f32_16x16x32_bf16 v[232:235], a[20:23], a[52:55], v[232:235]
    ds_read_b64_tr_b16 a[68:69], v14 offset:25600
    v_mfma_f32_16x16x32_bf16 v[232:235], a[16:19], a[100:103], v[232:235]
    ds_read_b64_tr_b16 a[70:71], v14 offset:31744
    s_waitcnt lgkmcnt(10)
    v_mfma_f32_16x16x32_bf16 v[88:91], a[80:83], a[24:27], v[88:91]
    ds_read_b64_tr_b16 a[72:73], v13 offset:26624
    v_mfma_f32_16x16x32_bf16 v[88:91], a[32:35], a[28:31], v[88:91]
    ds_read_b64_tr_b16 a[74:75], v13 offset:32768
    v_mfma_f32_16x16x32_bf16 v[92:95], a[36:39], a[28:31], v[92:95]
    ds_read_b64_tr_b16 a[76:77], v14 offset:26624
    v_mfma_f32_16x16x32_bf16 v[92:95], a[84:87], a[24:27], v[92:95]
    ds_read_b64_tr_b16 a[78:79], v14 offset:32768
    v_mfma_f32_16x16x32_bf16 v[152:155], a[88:91], a[24:27], v[152:155]
    ds_read_b128 a[8:11], v7 offset:2048
    v_mfma_f32_16x16x32_bf16 v[152:155], a[40:43], a[28:31], v[152:155]
    ds_read_b128 a[12:15], v8 offset:2048
    v_mfma_f32_16x16x32_bf16 v[156:159], a[44:47], a[28:31], v[156:159]
    buffer_load_dwordx4 v4, s[28:31], s67 offen offset:0 lds
    v_mfma_f32_16x16x32_bf16 v[156:159], a[92:95], a[24:27], v[156:159]
    buffer_load_dwordx4 v5, s[28:31], s67 offen offset:1024 lds
    v_mfma_f32_16x16x32_bf16 v[204:207], a[24:27], a[96:99], v[204:207]
    v_mfma_f32_16x16x32_bf16 v[204:207], a[28:31], a[48:51], v[204:207]
    v_mfma_f32_16x16x32_bf16 v[236:239], a[28:31], a[52:55], v[236:239]
    v_mfma_f32_16x16x32_bf16 v[236:239], a[24:27], a[100:103], v[236:239]
    s_waitcnt lgkmcnt(2)
    v_mfma_f32_16x16x32_bf16 v[120:123], a[32:35], a[0:3], v[120:123]
    buffer_load_dwordx4 v6, s[28:31], s67 offen offset:2048 lds
    v_mfma_f32_16x16x32_bf16 v[120:123], a[56:59], a[4:7], v[120:123]
    s_add_u32 m0, s66, 49152
    s_add_u32 s75, s75, 172032
    v_mfma_f32_16x16x32_bf16 v[124:127], a[60:63], a[4:7], v[124:127]
    s_cmp_eq_u32 s75, 1204224
    s_cselect_b32 s75, 0, s75
    v_mfma_f32_16x16x32_bf16 v[124:127], a[36:39], a[0:3], v[124:127]
    s_add_u32 s67, s75, 0
    ds_read_b128 a[16:19], v7 offset:10240
    v_mfma_f32_16x16x32_bf16 v[184:187], a[40:43], a[0:3], v[184:187]
    buffer_load_dwordx4 v4, s[28:31], s67 offen offset:0 lds
    v_mfma_f32_16x16x32_bf16 v[184:187], a[64:67], a[4:7], v[184:187]
    ds_read_b128 a[20:23], v8 offset:10240
    v_mfma_f32_16x16x32_bf16 v[188:191], a[68:71], a[4:7], v[188:191]
    buffer_load_dword v46, v44, s[36:39], s62 offen sc1
    v_mfma_f32_16x16x32_bf16 v[188:191], a[44:47], a[0:3], v[188:191]
    buffer_load_dword v27, off, s[52:55], 0 offset:128 sc1
    v_mfma_f32_16x16x32_bf16 v[220:223], a[0:3], a[48:51], v[220:223]
    v_mfma_f32_16x16x32_bf16 v[220:223], a[4:7], a[72:75], v[220:223]
    buffer_load_dwordx4 v5, s[28:31], s67 offen offset:1024 lds
    v_mfma_f32_16x16x32_bf16 v[252:255], a[4:7], a[76:79], v[252:255]
    v_mfma_f32_16x16x32_bf16 v[252:255], a[0:3], a[52:55], v[252:255]
    s_waitcnt lgkmcnt(2)
    s_nop 0
    v_mfma_f32_16x16x32_bf16 v[96:99], a[32:35], a[8:11], v[96:99]
    ds_read_b128 a[24:27], v7 offset:3072
    v_mfma_f32_16x16x32_bf16 v[96:99], a[56:59], a[12:15], v[96:99]
    ds_read_b128 a[28:31], v8 offset:3072
    v_mfma_f32_16x16x32_bf16 v[100:103], a[60:63], a[12:15], v[100:103]
    buffer_load_dwordx4 v6, s[28:31], s67 offen offset:2048 lds
    v_mfma_f32_16x16x32_bf16 v[100:103], a[36:39], a[8:11], v[100:103]
    s_add_u32 m0, s66, 52224
    s_add_u32 s67, s75, 43008
    v_mfma_f32_16x16x32_bf16 v[160:163], a[40:43], a[8:11], v[160:163]
    v_mfma_f32_16x16x32_bf16 v[160:163], a[64:67], a[12:15], v[160:163]
    v_mfma_f32_16x16x32_bf16 v[164:167], a[68:71], a[12:15], v[164:167]
    v_mfma_f32_16x16x32_bf16 v[164:167], a[44:47], a[8:11], v[164:167]
    buffer_load_dwordx4 v4, s[28:31], s67 offen offset:0 lds
    v_mfma_f32_16x16x32_bf16 v[208:211], a[8:11], a[48:51], v[208:211]
    v_mfma_f32_16x16x32_bf16 v[208:211], a[12:15], a[72:75], v[208:211]
    v_mfma_f32_16x16x32_bf16 v[240:243], a[12:15], a[76:79], v[240:243]
    v_mfma_f32_16x16x32_bf16 v[240:243], a[8:11], a[52:55], v[240:243]
    s_waitcnt lgkmcnt(2)
    v_mfma_f32_16x16x32_bf16 v[104:107], a[32:35], a[16:19], v[104:107]
    s_waitcnt vmcnt(12)
    s_barrier
    v_mfma_f32_16x16x32_bf16 v[104:107], a[56:59], a[20:23], v[104:107]
    buffer_load_dwordx4 v5, s[28:31], s67 offen offset:1024 lds
    v_mfma_f32_16x16x32_bf16 v[108:111], a[60:63], a[20:23], v[108:111]
    ds_read_b128 a[0:3], v8 offset:0
    v_mfma_f32_16x16x32_bf16 v[108:111], a[36:39], a[16:19], v[108:111]
    ds_read_b128 a[4:7], v7 offset:16640
    v_mfma_f32_16x16x32_bf16 v[168:171], a[40:43], a[16:19], v[168:171]
    ds_read_b64_tr_b16 a[80:81], v11 offset:0
    v_mfma_f32_16x16x32_bf16 v[168:171], a[64:67], a[20:23], v[168:171]
    ds_read_b64_tr_b16 a[82:83], v11 offset:6144
    v_mfma_f32_16x16x32_bf16 v[172:175], a[68:71], a[20:23], v[172:175]
    ds_read_b64_tr_b16 a[84:85], v12 offset:0
    v_mfma_f32_16x16x32_bf16 v[172:175], a[44:47], a[16:19], v[172:175]
    ds_read_b64_tr_b16 a[86:87], v12 offset:6144
    v_mfma_f32_16x16x32_bf16 v[212:215], a[16:19], a[48:51], v[212:215]
    ds_read_b64_tr_b16 a[88:89], v11 offset:1024
    v_mfma_f32_16x16x32_bf16 v[212:215], a[20:23], a[72:75], v[212:215]
    ds_read_b64_tr_b16 a[90:91], v11 offset:7168
    v_mfma_f32_16x16x32_bf16 v[244:247], a[20:23], a[76:79], v[244:247]
    ds_read_b64_tr_b16 a[92:93], v12 offset:1024
    v_mfma_f32_16x16x32_bf16 v[244:247], a[16:19], a[52:55], v[244:247]
    ds_read_b64_tr_b16 a[94:95], v12 offset:7168
    s_waitcnt lgkmcnt(10)
    v_mfma_f32_16x16x32_bf16 v[112:115], a[32:35], a[24:27], v[112:115]
    ds_read_b64_tr_b16 a[96:97], v11 offset:2048
    v_mfma_f32_16x16x32_bf16 v[112:115], a[56:59], a[28:31], v[112:115]
    ds_read_b64_tr_b16 a[98:99], v11 offset:8192
    v_mfma_f32_16x16x32_bf16 v[116:119], a[60:63], a[28:31], v[116:119]
    ds_read_b64_tr_b16 a[100:101], v12 offset:2048
    v_mfma_f32_16x16x32_bf16 v[116:119], a[36:39], a[24:27], v[116:119]
    ds_read_b64_tr_b16 a[102:103], v12 offset:8192
    v_mfma_f32_16x16x32_bf16 v[176:179], a[40:43], a[24:27], v[176:179]
    ds_read_b128 a[8:11], v8 offset:8192
    v_mfma_f32_16x16x32_bf16 v[176:179], a[64:67], a[28:31], v[176:179]
    ds_read_b128 a[12:15], v7 offset:24832
    v_mfma_f32_16x16x32_bf16 v[180:183], a[68:71], a[28:31], v[180:183]
    buffer_load_dwordx4 v6, s[28:31], s67 offen offset:2048 lds
    v_mfma_f32_16x16x32_bf16 v[180:183], a[44:47], a[24:27], v[180:183]
    s_add_u32 s74, s74, 128
    v_mfma_f32_16x16x32_bf16 v[216:219], a[24:27], a[48:51], v[216:219]
    s_cmp_eq_u32 s74, 896
    s_cselect_b32 s74, 0, s74
    v_mfma_f32_16x16x32_bf16 v[216:219], a[28:31], a[72:75], v[216:219]
    s_add_u32 m0, s65, 33280
    v_mfma_f32_16x16x32_bf16 v[248:251], a[28:31], a[76:79], v[248:251]
    buffer_load_dwordx4 v2, s[24:27], s74 offen offset:0 lds
    v_mfma_f32_16x16x32_bf16 v[248:251], a[24:27], a[52:55], v[248:251]
    s_waitcnt lgkmcnt(2)
    v_mfma_f32_16x16x32_bf16 v[64:67], a[56:59], a[0:3], v[64:67]
    buffer_load_dwordx4 v3, s[24:27], s74 offen offset:1024 lds
    v_mfma_f32_16x16x32_bf16 v[64:67], a[80:83], a[4:7], v[64:67]
    s_add_u32 m0, s65, 34432
    ds_read_b128 a[16:19], v8 offset:1024
    v_mfma_f32_16x16x32_bf16 v[68:71], a[84:87], a[4:7], v[68:71]
    ds_read_b128 a[20:23], v7 offset:17664
    v_mfma_f32_16x16x32_bf16 v[68:71], a[60:63], a[0:3], v[68:71]
    v_mfma_f32_16x16x32_bf16 v[128:131], a[64:67], a[0:3], v[128:131]
    v_mfma_f32_16x16x32_bf16 v[128:131], a[88:91], a[4:7], v[128:131]
    buffer_load_dwordx4 v2, s[24:27], s74 offen offset:896 lds
    v_mfma_f32_16x16x32_bf16 v[132:135], a[92:95], a[4:7], v[132:135]
    v_mfma_f32_16x16x32_bf16 v[132:135], a[68:71], a[0:3], v[132:135]
    v_mfma_f32_16x16x32_bf16 v[192:195], a[0:3], a[72:75], v[192:195]
    v_mfma_f32_16x16x32_bf16 v[192:195], a[4:7], a[96:99], v[192:195]
    v_mfma_f32_16x16x32_bf16 v[224:227], a[4:7], a[100:103], v[224:227]
    buffer_load_dwordx4 v3, s[24:27], s74 offen offset:1920 lds
    v_mfma_f32_16x16x32_bf16 v[224:227], a[0:3], a[76:79], v[224:227]
    s_add_u32 m0, s66, 73728
    s_waitcnt lgkmcnt(2)
    v_mfma_f32_16x16x32_bf16 v[72:75], a[56:59], a[8:11], v[72:75]
    s_add_u32 s67, s75, 86016
    ds_read_b128 a[24:27], v8 offset:9216
    v_mfma_f32_16x16x32_bf16 v[72:75], a[80:83], a[12:15], v[72:75]
    ds_read_b128 a[28:31], v7 offset:25856
    v_mfma_f32_16x16x32_bf16 v[76:79], a[84:87], a[12:15], v[76:79]
    v_mfma_f32_16x16x32_bf16 v[76:79], a[60:63], a[8:11], v[76:79]
    buffer_load_dwordx4 v4, s[28:31], s67 offen offset:0 lds
    v_mfma_f32_16x16x32_bf16 v[136:139], a[64:67], a[8:11], v[136:139]
    v_mfma_f32_16x16x32_bf16 v[136:139], a[88:91], a[12:15], v[136:139]
    v_mfma_f32_16x16x32_bf16 v[140:143], a[92:95], a[12:15], v[140:143]
    v_mfma_f32_16x16x32_bf16 v[140:143], a[68:71], a[8:11], v[140:143]
    v_mfma_f32_16x16x32_bf16 v[196:199], a[8:11], a[72:75], v[196:199]
    buffer_load_dwordx4 v5, s[28:31], s67 offen offset:1024 lds
    v_mfma_f32_16x16x32_bf16 v[196:199], a[12:15], a[96:99], v[196:199]
    v_mfma_f32_16x16x32_bf16 v[228:231], a[12:15], a[100:103], v[228:231]
    v_mfma_f32_16x16x32_bf16 v[228:231], a[8:11], a[76:79], v[228:231]
    s_waitcnt lgkmcnt(2)
    v_mfma_f32_16x16x32_bf16 v[80:83], a[56:59], a[16:19], v[80:83]
    s_waitcnt vmcnt(14)
    s_barrier
    v_mfma_f32_16x16x32_bf16 v[80:83], a[80:83], a[20:23], v[80:83]
    ds_read_b128 a[0:3], v9 offset:27904
    v_mfma_f32_16x16x32_bf16 v[84:87], a[84:87], a[20:23], v[84:87]
    buffer_load_dwordx4 v6, s[28:31], s67 offen offset:2048 lds
    v_mfma_f32_16x16x32_bf16 v[84:87], a[60:63], a[16:19], v[84:87]
    ds_read_b128 a[4:7], v10 offset:27904
    s_add_u32 m0, s66, 76800
    v_mfma_f32_16x16x32_bf16 v[144:147], a[64:67], a[16:19], v[144:147]
    ds_read_b64_tr_b16 a[32:33], v11 offset:24576
    s_add_u32 s67, s75, 129024
    v_mfma_f32_16x16x32_bf16 v[144:147], a[88:91], a[20:23], v[144:147]
    ds_read_b64_tr_b16 a[34:35], v11 offset:30720
    v_mfma_f32_16x16x32_bf16 v[148:151], a[92:95], a[20:23], v[148:151]
    ds_read_b64_tr_b16 a[36:37], v12 offset:24576
    v_mfma_f32_16x16x32_bf16 v[148:151], a[68:71], a[16:19], v[148:151]
    ds_read_b64_tr_b16 a[38:39], v12 offset:30720
    v_mfma_f32_16x16x32_bf16 v[200:203], a[16:19], a[72:75], v[200:203]
    ds_read_b64_tr_b16 a[40:41], v11 offset:25600
    v_mfma_f32_16x16x32_bf16 v[200:203], a[20:23], a[96:99], v[200:203]
    ds_read_b64_tr_b16 a[42:43], v11 offset:31744
    v_mfma_f32_16x16x32_bf16 v[232:235], a[20:23], a[100:103], v[232:235]
    ds_read_b64_tr_b16 a[44:45], v12 offset:25600
    v_mfma_f32_16x16x32_bf16 v[232:235], a[16:19], a[76:79], v[232:235]
    ds_read_b64_tr_b16 a[46:47], v12 offset:31744
    s_waitcnt lgkmcnt(10)
    v_mfma_f32_16x16x32_bf16 v[88:91], a[56:59], a[24:27], v[88:91]
    ds_read_b64_tr_b16 a[48:49], v11 offset:26624
    v_mfma_f32_16x16x32_bf16 v[88:91], a[80:83], a[28:31], v[88:91]
    ds_read_b64_tr_b16 a[50:51], v11 offset:32768
    v_mfma_f32_16x16x32_bf16 v[92:95], a[84:87], a[28:31], v[92:95]
    ds_read_b64_tr_b16 a[52:53], v12 offset:26624
    v_mfma_f32_16x16x32_bf16 v[92:95], a[60:63], a[24:27], v[92:95]
    ds_read_b64_tr_b16 a[54:55], v12 offset:32768
    v_mfma_f32_16x16x32_bf16 v[152:155], a[64:67], a[24:27], v[152:155]
    ds_read_b128 a[8:11], v7 offset:18688
    v_mfma_f32_16x16x32_bf16 v[152:155], a[88:91], a[28:31], v[152:155]
    ds_read_b128 a[12:15], v8 offset:18688
    v_mfma_f32_16x16x32_bf16 v[156:159], a[92:95], a[28:31], v[156:159]
    buffer_load_dwordx4 v4, s[28:31], s67 offen offset:0 lds
    v_mfma_f32_16x16x32_bf16 v[156:159], a[68:71], a[24:27], v[156:159]
    buffer_load_dwordx4 v5, s[28:31], s67 offen offset:1024 lds
    v_mfma_f32_16x16x32_bf16 v[204:207], a[24:27], a[72:75], v[204:207]
    v_mfma_f32_16x16x32_bf16 v[204:207], a[28:31], a[96:99], v[204:207]
    v_mfma_f32_16x16x32_bf16 v[236:239], a[28:31], a[100:103], v[236:239]
    v_mfma_f32_16x16x32_bf16 v[236:239], a[24:27], a[76:79], v[236:239]
    s_waitcnt lgkmcnt(2)
    v_mfma_f32_16x16x32_bf16 v[120:123], a[80:83], a[0:3], v[120:123]
    buffer_load_dwordx4 v6, s[28:31], s67 offen offset:2048 lds
    v_mfma_f32_16x16x32_bf16 v[120:123], a[32:35], a[4:7], v[120:123]
    s_add_u32 m0, s66, 0
    s_add_u32 s75, s75, 172032
    v_mfma_f32_16x16x32_bf16 v[124:127], a[36:39], a[4:7], v[124:127]
    s_cmp_eq_u32 s75, 1204224
    s_cselect_b32 s75, 0, s75
    v_mfma_f32_16x16x32_bf16 v[124:127], a[84:87], a[0:3], v[124:127]
    s_add_u32 s67, s75, 0
    ds_read_b128 a[16:19], v7 offset:26880
    v_mfma_f32_16x16x32_bf16 v[184:187], a[88:91], a[0:3], v[184:187]
    buffer_load_dwordx4 v4, s[28:31], s67 offen offset:0 lds
    v_mfma_f32_16x16x32_bf16 v[184:187], a[40:43], a[4:7], v[184:187]
    ds_read_b128 a[20:23], v8 offset:26880
    v_mfma_f32_16x16x32_bf16 v[188:191], a[44:47], a[4:7], v[188:191]
    v_mfma_f32_16x16x32_bf16 v[188:191], a[92:95], a[0:3], v[188:191]
    v_mfma_f32_16x16x32_bf16 v[220:223], a[0:3], a[96:99], v[220:223]
    v_mfma_f32_16x16x32_bf16 v[220:223], a[4:7], a[48:51], v[220:223]
    buffer_load_dwordx4 v5, s[28:31], s67 offen offset:1024 lds
    v_mfma_f32_16x16x32_bf16 v[252:255], a[4:7], a[52:55], v[252:255]
    v_mfma_f32_16x16x32_bf16 v[252:255], a[0:3], a[100:103], v[252:255]
    s_waitcnt lgkmcnt(2)
    v_mfma_f32_16x16x32_bf16 v[96:99], a[80:83], a[8:11], v[96:99]
    ds_read_b128 a[24:27], v7 offset:19712
    v_mfma_f32_16x16x32_bf16 v[96:99], a[32:35], a[12:15], v[96:99]
    ds_read_b128 a[28:31], v8 offset:19712
    v_mfma_f32_16x16x32_bf16 v[100:103], a[36:39], a[12:15], v[100:103]
    buffer_load_dwordx4 v6, s[28:31], s67 offen offset:2048 lds
    v_mfma_f32_16x16x32_bf16 v[100:103], a[84:87], a[8:11], v[100:103]
    s_add_u32 m0, s66, 3072
    s_add_u32 s67, s75, 43008
    v_mfma_f32_16x16x32_bf16 v[160:163], a[88:91], a[8:11], v[160:163]
    v_mfma_f32_16x16x32_bf16 v[160:163], a[40:43], a[12:15], v[160:163]
    v_mfma_f32_16x16x32_bf16 v[164:167], a[44:47], a[12:15], v[164:167]
    v_mfma_f32_16x16x32_bf16 v[164:167], a[92:95], a[8:11], v[164:167]
    buffer_load_dwordx4 v4, s[28:31], s67 offen offset:0 lds
    v_mfma_f32_16x16x32_bf16 v[208:211], a[8:11], a[96:99], v[208:211]
    v_mfma_f32_16x16x32_bf16 v[208:211], a[12:15], a[48:51], v[208:211]
    v_mfma_f32_16x16x32_bf16 v[240:243], a[12:15], a[52:55], v[240:243]
    v_mfma_f32_16x16x32_bf16 v[240:243], a[8:11], a[100:103], v[240:243]
    s_waitcnt lgkmcnt(2)
    v_mfma_f32_16x16x32_bf16 v[104:107], a[80:83], a[16:19], v[104:107]
    s_waitcnt vmcnt(10)
    s_barrier
    v_mfma_f32_16x16x32_bf16 v[104:107], a[32:35], a[20:23], v[104:107]
    buffer_load_dwordx4 v5, s[28:31], s67 offen offset:1024 lds
    v_mfma_f32_16x16x32_bf16 v[108:111], a[36:39], a[20:23], v[108:111]
    ds_read_b128 a[0:3], v8 offset:16640
    v_mfma_f32_16x16x32_bf16 v[108:111], a[84:87], a[16:19], v[108:111]
    ds_read_b128 a[4:7], v7 offset:33280
    v_mfma_f32_16x16x32_bf16 v[168:171], a[88:91], a[16:19], v[168:171]
    ds_read_b64_tr_b16 a[56:57], v13 offset:0
    v_mfma_f32_16x16x32_bf16 v[168:171], a[40:43], a[20:23], v[168:171]
    ds_read_b64_tr_b16 a[58:59], v13 offset:6144
    v_mfma_f32_16x16x32_bf16 v[172:175], a[44:47], a[20:23], v[172:175]
    ds_read_b64_tr_b16 a[60:61], v14 offset:0
    v_mfma_f32_16x16x32_bf16 v[172:175], a[92:95], a[16:19], v[172:175]
    ds_read_b64_tr_b16 a[62:63], v14 offset:6144
    v_mfma_f32_16x16x32_bf16 v[212:215], a[16:19], a[96:99], v[212:215]
    ds_read_b64_tr_b16 a[64:65], v13 offset:1024
    v_mfma_f32_16x16x32_bf16 v[212:215], a[20:23], a[48:51], v[212:215]
    ds_read_b64_tr_b16 a[66:67], v13 offset:7168
    v_mfma_f32_16x16x32_bf16 v[244:247], a[20:23], a[52:55], v[244:247]
    ds_read_b64_tr_b16 a[68:69], v14 offset:1024
    v_mfma_f32_16x16x32_bf16 v[244:247], a[16:19], a[100:103], v[244:247]
    ds_read_b64_tr_b16 a[70:71], v14 offset:7168
    s_waitcnt lgkmcnt(10)
    v_mfma_f32_16x16x32_bf16 v[112:115], a[80:83], a[24:27], v[112:115]
    ds_read_b64_tr_b16 a[72:73], v13 offset:2048
    v_mfma_f32_16x16x32_bf16 v[112:115], a[32:35], a[28:31], v[112:115]
    ds_read_b64_tr_b16 a[74:75], v13 offset:8192
    v_mfma_f32_16x16x32_bf16 v[116:119], a[36:39], a[28:31], v[116:119]
    ds_read_b64_tr_b16 a[76:77], v14 offset:2048
    v_mfma_f32_16x16x32_bf16 v[116:119], a[84:87], a[24:27], v[116:119]
    ds_read_b64_tr_b16 a[78:79], v14 offset:8192
    v_mfma_f32_16x16x32_bf16 v[176:179], a[88:91], a[24:27], v[176:179]
    ds_read_b128 a[8:11], v8 offset:24832
    v_mfma_f32_16x16x32_bf16 v[176:179], a[40:43], a[28:31], v[176:179]
    ds_read_b128 a[12:15], v7 offset:41472
    v_mfma_f32_16x16x32_bf16 v[180:183], a[44:47], a[28:31], v[180:183]
    buffer_load_dwordx4 v6, s[28:31], s67 offen offset:2048 lds
    v_mfma_f32_16x16x32_bf16 v[180:183], a[92:95], a[24:27], v[180:183]
    s_add_u32 s74, s74, 128
    v_mfma_f32_16x16x32_bf16 v[216:219], a[24:27], a[96:99], v[216:219]
    s_cmp_eq_u32 s74, 896
    s_cselect_b32 s74, 0, s74
    v_mfma_f32_16x16x32_bf16 v[216:219], a[28:31], a[48:51], v[216:219]
    s_add_u32 m0, s65, 0
    v_mfma_f32_16x16x32_bf16 v[248:251], a[28:31], a[52:55], v[248:251]
    buffer_load_dwordx4 v2, s[24:27], s74 offen offset:0 lds
    v_mfma_f32_16x16x32_bf16 v[248:251], a[24:27], a[100:103], v[248:251]
    s_waitcnt lgkmcnt(2)
    s_nop 0
    v_mfma_f32_16x16x32_bf16 v[64:67], a[32:35], a[0:3], v[64:67]
    buffer_load_dwordx4 v3, s[24:27], s74 offen offset:1024 lds
    v_mfma_f32_16x16x32_bf16 v[64:67], a[56:59], a[4:7], v[64:67]
    s_add_u32 m0, s65, 1152
    ds_read_b128 a[16:19], v8 offset:17664
    v_mfma_f32_16x16x32_bf16 v[68:71], a[60:63], a[4:7], v[68:71]
    ds_read_b128 a[20:23], v7 offset:34304
    v_mfma_f32_16x16x32_bf16 v[68:71], a[36:39], a[0:3], v[68:71]
    v_min_u32 v27, v46, v27
    v_cmp_eq_u32 vcc, 0, v27
    s_nop 4
    s_cbranch_vccnz La_par
La_par_r:
    v_mfma_f32_16x16x32_bf16 v[128:131], a[40:43], a[0:3], v[128:131]
    ds_write_b32 v45, v46
    v_mfma_f32_16x16x32_bf16 v[128:131], a[64:67], a[4:7], v[128:131]
    buffer_load_dwordx4 v2, s[24:27], s74 offen offset:896 lds
    v_mfma_f32_16x16x32_bf16 v[132:135], a[68:71], a[4:7], v[132:135]
    v_mfma_f32_16x16x32_bf16 v[132:135], a[44:47], a[0:3], v[132:135]
    v_mfma_f32_16x16x32_bf16 v[192:195], a[0:3], a[48:51], v[192:195]
    v_mfma_f32_16x16x32_bf16 v[192:195], a[4:7], a[72:75], v[192:195]
    v_mfma_f32_16x16x32_bf16 v[224:227], a[4:7], a[76:79], v[224:227]
    buffer_load_dwordx4 v3, s[24:27], s74 offen offset:1920 lds
    v_mfma_f32_16x16x32_bf16 v[224:227], a[0:3], a[52:55], v[224:227]
    s_add_u32 m0, s66, 24576
    s_waitcnt lgkmcnt(3)
    v_mfma_f32_16x16x32_bf16 v[72:75], a[32:35], a[8:11], v[72:75]
    s_add_u32 s67, s75, 86016
    ds_read_b128 a[24:27], v8 offset:25856
    v_mfma_f32_16x16x32_bf16 v[72:75], a[56:59], a[12:15], v[72:75]
    ds_read_b128 a[28:31], v7 offset:42496
    v_mfma_f32_16x16x32_bf16 v[76:79], a[60:63], a[12:15], v[76:79]
    v_mfma_f32_16x16x32_bf16 v[76:79], a[36:39], a[8:11], v[76:79]
    buffer_load_dwordx4 v4, s[28:31], s67 offen offset:0 lds
    v_mfma_f32_16x16x32_bf16 v[136:139], a[40:43], a[8:11], v[136:139]
    v_mfma_f32_16x16x32_bf16 v[136:139], a[64:67], a[12:15], v[136:139]
    v_mfma_f32_16x16x32_bf16 v[140:143], a[68:71], a[12:15], v[140:143]
    v_mfma_f32_16x16x32_bf16 v[140:143], a[44:47], a[8:11], v[140:143]
    v_mfma_f32_16x16x32_bf16 v[196:199], a[8:11], a[48:51], v[196:199]
    buffer_load_dwordx4 v5, s[28:31], s67 offen offset:1024 lds
    v_mfma_f32_16x16x32_bf16 v[196:199], a[12:15], a[72:75], v[196:199]
    v_mfma_f32_16x16x32_bf16 v[228:231], a[12:15], a[76:79], v[228:231]
    v_mfma_f32_16x16x32_bf16 v[228:231], a[8:11], a[52:55], v[228:231]
    s_waitcnt lgkmcnt(3)
    v_mfma_f32_16x16x32_bf16 v[80:83], a[32:35], a[16:19], v[80:83]
    s_waitcnt vmcnt(12)
    s_barrier
    v_mfma_f32_16x16x32_bf16 v[80:83], a[56:59], a[20:23], v[80:83]
    ds_read_b128 a[0:3], v9 offset:44544
    v_mfma_f32_16x16x32_bf16 v[84:87], a[60:63], a[20:23], v[84:87]
    buffer_load_dwordx4 v6, s[28:31], s67 offen offset:2048 lds
    v_mfma_f32_16x16x32_bf16 v[84:87], a[36:39], a[16:19], v[84:87]
    ds_read_b128 a[4:7], v10 offset:44544
    s_add_u32 m0, s66, 27648
    v_mfma_f32_16x16x32_bf16 v[144:147], a[40:43], a[16:19], v[144:147]
    ds_read_b64_tr_b16 a[80:81], v13 offset:24576
    s_add_u32 s67, s75, 129024
    v_mfma_f32_16x16x32_bf16 v[144:147], a[64:67], a[20:23], v[144:147]
    ds_read_b64_tr_b16 a[82:83], v13 offset:30720
    v_mfma_f32_16x16x32_bf16 v[148:151], a[68:71], a[20:23], v[148:151]
    ds_read_b64_tr_b16 a[84:85], v14 offset:24576
    v_mfma_f32_16x16x32_bf16 v[148:151], a[44:47], a[16:19], v[148:151]
    ds_read_b64_tr_b16 a[86:87], v14 offset:30720
    v_mfma_f32_16x16x32_bf16 v[200:203], a[16:19], a[48:51], v[200:203]
    ds_read_b64_tr_b16 a[88:89], v13 offset:25600
    v_mfma_f32_16x16x32_bf16 v[200:203], a[20:23], a[72:75], v[200:203]
    ds_read_b64_tr_b16 a[90:91], v13 offset:31744
    v_mfma_f32_16x16x32_bf16 v[232:235], a[20:23], a[76:79], v[232:235]
    ds_read_b64_tr_b16 a[92:93], v14 offset:25600
    v_mfma_f32_16x16x32_bf16 v[232:235], a[16:19], a[52:55], v[232:235]
    ds_read_b64_tr_b16 a[94:95], v14 offset:31744
    s_waitcnt lgkmcnt(10)
    v_mfma_f32_16x16x32_bf16 v[88:91], a[32:35], a[24:27], v[88:91]
    ds_read_b64_tr_b16 a[96:97], v13 offset:26624
    v_mfma_f32_16x16x32_bf16 v[88:91], a[56:59], a[28:31], v[88:91]
    ds_read_b64_tr_b16 a[98:99], v13 offset:32768
    v_mfma_f32_16x16x32_bf16 v[92:95], a[60:63], a[28:31], v[92:95]
    ds_read_b64_tr_b16 a[100:101], v14 offset:26624
    v_mfma_f32_16x16x32_bf16 v[92:95], a[36:39], a[24:27], v[92:95]
    ds_read_b64_tr_b16 a[102:103], v14 offset:32768
    v_mfma_f32_16x16x32_bf16 v[152:155], a[40:43], a[24:27], v[152:155]
    ds_read_b128 a[8:11], v7 offset:35328
    v_mfma_f32_16x16x32_bf16 v[152:155], a[64:67], a[28:31], v[152:155]
    ds_read_b128 a[12:15], v8 offset:35328
    v_mfma_f32_16x16x32_bf16 v[156:159], a[68:71], a[28:31], v[156:159]
    buffer_load_dwordx4 v4, s[28:31], s67 offen offset:0 lds
    v_mfma_f32_16x16x32_bf16 v[156:159], a[44:47], a[24:27], v[156:159]
    buffer_load_dwordx4 v5, s[28:31], s67 offen offset:1024 lds
    v_mfma_f32_16x16x32_bf16 v[204:207], a[24:27], a[48:51], v[204:207]
    v_mfma_f32_16x16x32_bf16 v[204:207], a[28:31], a[72:75], v[204:207]
    v_mfma_f32_16x16x32_bf16 v[236:239], a[28:31], a[76:79], v[236:239]
    v_mfma_f32_16x16x32_bf16 v[236:239], a[24:27], a[52:55], v[236:239]
    s_waitcnt lgkmcnt(2)
    v_mfma_f32_16x16x32_bf16 v[120:123], a[56:59], a[0:3], v[120:123]
    buffer_load_dwordx4 v6, s[28:31], s67 offen offset:2048 lds
    v_mfma_f32_16x16x32_bf16 v[120:123], a[80:83], a[4:7], v[120:123]
    ds_read_b128 a[16:19], v7 offset:43520
    v_mfma_f32_16x16x32_bf16 v[124:127], a[84:87], a[4:7], v[124:127]
    ds_read_b128 a[20:23], v8 offset:43520
    v_mfma_f32_16x16x32_bf16 v[124:127], a[60:63], a[0:3], v[124:127]
    v_mfma_f32_16x16x32_bf16 v[184:187], a[64:67], a[0:3], v[184:187]
    v_mfma_f32_16x16x32_bf16 v[184:187], a[88:91], a[4:7], v[184:187]
    v_mfma_f32_16x16x32_bf16 v[188:191], a[92:95], a[4:7], v[188:191]
    v_mfma_f32_16x16x32_bf16 v[188:191], a[68:71], a[0:3], v[188:191]
    v_mfma_f32_16x16x32_bf16 v[220:223], a[0:3], a[72:75], v[220:223]
    v_mfma_f32_16x16x32_bf16 v[220:223], a[4:7], a[96:99], v[220:223]
    v_mfma_f32_16x16x32_bf16 v[252:255], a[4:7], a[100:103], v[252:255]
    v_mfma_f32_16x16x32_bf16 v[252:255], a[0:3], a[76:79], v[252:255]
    s_waitcnt lgkmcnt(2)
    s_nop 0
    v_mfma_f32_16x16x32_bf16 v[96:99], a[56:59], a[8:11], v[96:99]
    ds_read_b128 a[24:27], v7 offset:36352
    v_mfma_f32_16x16x32_bf16 v[96:99], a[80:83], a[12:15], v[96:99]
    ds_read_b128 a[28:31], v8 offset:36352
    v_mfma_f32_16x16x32_bf16 v[100:103], a[84:87], a[12:15], v[100:103]
    v_mfma_f32_16x16x32_bf16 v[100:103], a[60:63], a[8:11], v[100:103]
    v_mfma_f32_16x16x32_bf16 v[160:163], a[64:67], a[8:11], v[160:163]
    v_mfma_f32_16x16x32_bf16 v[160:163], a[88:91], a[12:15], v[160:163]
    v_mfma_f32_16x16x32_bf16 v[164:167], a[92:95], a[12:15], v[164:167]
    v_mfma_f32_16x16x32_bf16 v[164:167], a[68:71], a[8:11], v[164:167]
    v_mfma_f32_16x16x32_bf16 v[208:211], a[8:11], a[72:75], v[208:211]
    v_mfma_f32_16x16x32_bf16 v[208:211], a[12:15], a[96:99], v[208:211]
    v_mfma_f32_16x16x32_bf16 v[240:243], a[12:15], a[100:103], v[240:243]
    v_mfma_f32_16x16x32_bf16 v[240:243], a[8:11], a[76:79], v[240:243]
    s_waitcnt lgkmcnt(2)
    v_mfma_f32_16x16x32_bf16 v[104:107], a[56:59], a[16:19], v[104:107]
    s_waitcnt vmcnt(6)
    s_barrier
    v_mfma_f32_16x16x32_bf16 v[104:107], a[80:83], a[20:23], v[104:107]
    ds_read_b128 a[0:3], v8 offset:33280
    v_mfma_f32_16x16x32_bf16 v[108:111], a[84:87], a[20:23], v[108:111]
    ds_read_b128 a[4:7], v7 offset:0
    v_mfma_f32_16x16x32_bf16 v[108:111], a[60:63], a[16:19], v[108:111]
    ds_read_b64_tr_b16 a[32:33], v11 offset:0
    v_mfma_f32_16x16x32_bf16 v[168:171], a[64:67], a[16:19], v[168:171]
    ds_read_b64_tr_b16 a[34:35], v11 offset:6144
    v_mfma_f32_16x16x32_bf16 v[168:171], a[88:91], a[20:23], v[168:171]
    ds_read_b64_tr_b16 a[36:37], v12 offset:0
    v_mfma_f32_16x16x32_bf16 v[172:175], a[92:95], a[20:23], v[172:175]
    ds_read_b64_tr_b16 a[38:39], v12 offset:6144
    v_mfma_f32_16x16x32_bf16 v[172:175], a[68:71], a[16:19], v[172:175]
    ds_read_b64_tr_b16 a[40:41], v11 offset:1024
    v_mfma_f32_16x16x32_bf16 v[212:215], a[16:19], a[72:75], v[212:215]
    ds_read_b64_tr_b16 a[42:43], v11 offset:7168
    v_mfma_f32_16x16x32_bf16 v[212:215], a[20:23], a[96:99], v[212:215]
    ds_read_b64_tr_b16 a[44:45], v12 offset:1024
    v_mfma_f32_16x16x32_bf16 v[244:247], a[20:23], a[100:103], v[244:247]
    ds_read_b64_tr_b16 a[46:47], v12 offset:7168
    v_mfma_f32_16x16x32_bf16 v[244:247], a[16:19], a[76:79], v[244:247]
    ds_read_b64_tr_b16 a[48:49], v11 offset:2048
    s_waitcnt lgkmcnt(11)
    v_mfma_f32_16x16x32_bf16 v[112:115], a[56:59], a[24:27], v[112:115]
    ds_read_b64_tr_b16 a[50:51], v11 offset:8192
    v_mfma_f32_16x16x32_bf16 v[112:115], a[80:83], a[28:31], v[112:115]
    ds_read_b64_tr_b16 a[52:53], v12 offset:2048
    v_mfma_f32_16x16x32_bf16 v[116:119], a[84:87], a[28:31], v[116:119]
    ds_read_b64_tr_b16 a[54:55], v12 offset:8192
    v_mfma_f32_16x16x32_bf16 v[116:119], a[60:63], a[24:27], v[116:119]
    ds_read_b128 a[8:11], v8 offset:41472
    v_mfma_f32_16x16x32_bf16 v[176:179], a[64:67], a[24:27], v[176:179]
    ds_read_b128 a[12:15], v7 offset:8192
    v_mfma_f32_16x16x32_bf16 v[176:179], a[88:91], a[28:31], v[176:179]
    v_mfma_f32_16x16x32_bf16 v[180:183], a[92:95], a[28:31], v[180:183]
    v_mfma_f32_16x16x32_bf16 v[180:183], a[68:71], a[24:27], v[180:183]
    v_mfma_f32_16x16x32_bf16 v[216:219], a[24:27], a[72:75], v[216:219]
    v_mfma_f32_16x16x32_bf16 v[216:219], a[28:31], a[96:99], v[216:219]
    v_mfma_f32_16x16x32_bf16 v[248:251], a[28:31], a[100:103], v[248:251]
    v_mfma_f32_16x16x32_bf16 v[248:251], a[24:27], a[76:79], v[248:251]
    s_waitcnt lgkmcnt(2)
    s_nop 0
    v_mfma_f32_16x16x32_bf16 v[64:67], a[80:83], a[0:3], v[64:67]
    ds_read_b128 a[16:19], v8 offset:34304
    v_mfma_f32_16x16x32_bf16 v[64:67], a[32:35], a[4:7], v[64:67]
    ds_read_b128 a[20:23], v7 offset:1024
    v_mfma_f32_16x16x32_bf16 v[68:71], a[36:39], a[4:7], v[68:71]
    v_mfma_f32_16x16x32_bf16 v[68:71], a[84:87], a[0:3], v[68:71]
    v_mfma_f32_16x16x32_bf16 v[128:131], a[88:91], a[0:3], v[128:131]
    v_mfma_f32_16x16x32_bf16 v[128:131], a[40:43], a[4:7], v[128:131]
    v_mfma_f32_16x16x32_bf16 v[132:135], a[44:47], a[4:7], v[132:135]
    v_mfma_f32_16x16x32_bf16 v[132:135], a[92:95], a[0:3], v[132:135]
    v_mfma_f32_16x16x32_bf16 v[192:195], a[0:3], a[96:99], v[192:195]
    v_mfma_f32_16x16x32_bf16 v[192:195], a[4:7], a[48:51], v[192:195]
    v_mfma_f32_16x16x32_bf16 v[224:227], a[4:7], a[52:55], v[224:227]
    v_mfma_f32_16x16x32_bf16 v[224:227], a[0:3], a[100:103], v[224:227]
    s_waitcnt lgkmcnt(2)
    s_nop 0
    v_mfma_f32_16x16x32_bf16 v[72:75], a[80:83], a[8:11], v[72:75]
    ds_read_b128 a[24:27], v8 offset:42496
    v_mfma_f32_16x16x32_bf16 v[72:75], a[32:35], a[12:15], v[72:75]
    ds_read_b128 a[28:31], v7 offset:9216
    v_mfma_f32_16x16x32_bf16 v[76:79], a[36:39], a[12:15], v[76:79]
    v_mfma_f32_16x16x32_bf16 v[76:79], a[84:87], a[8:11], v[76:79]
    v_mfma_f32_16x16x32_bf16 v[136:139], a[88:91], a[8:11], v[136:139]
    v_mfma_f32_16x16x32_bf16 v[136:139], a[40:43], a[12:15], v[136:139]
    v_mfma_f32_16x16x32_bf16 v[140:143], a[44:47], a[12:15], v[140:143]
    v_mfma_f32_16x16x32_bf16 v[140:143], a[92:95], a[8:11], v[140:143]
    v_mfma_f32_16x16x32_bf16 v[196:199], a[8:11], a[96:99], v[196:199]
    v_mfma_f32_16x16x32_bf16 v[196:199], a[12:15], a[48:51], v[196:199]
    v_mfma_f32_16x16x32_bf16 v[228:231], a[12:15], a[52:55], v[228:231]
    v_mfma_f32_16x16x32_bf16 v[228:231], a[8:11], a[100:103], v[228:231]
    s_waitcnt lgkmcnt(2)
    v_mfma_f32_16x16x32_bf16 v[80:83], a[80:83], a[16:19], v[80:83]
    s_waitcnt vmcnt(0)
    s_barrier
    v_mfma_f32_16x16x32_bf16 v[80:83], a[32:35], a[20:23], v[80:83]
    ds_read_b128 a[0:3], v9 offset:11264
    v_mfma_f32_16x16x32_bf16 v[84:87], a[36:39], a[20:23], v[84:87]
    ds_read_b128 a[4:7], v10 offset:11264
    v_mfma_f32_16x16x32_bf16 v[84:87], a[84:87], a[16:19], v[84:87]
    ds_read_b64_tr_b16 a[56:57], v11 offset:24576
    v_mfma_f32_16x16x32_bf16 v[144:147], a[88:91], a[16:19], v[144:147]
    ds_read_b64_tr_b16 a[58:59], v11 offset:30720
    v_mfma_f32_16x16x32_bf16 v[144:147], a[40:43], a[20:23], v[144:147]
    ds_read_b64_tr_b16 a[60:61], v12 offset:24576
    v_mfma_f32_16x16x32_bf16 v[148:151], a[44:47], a[20:23], v[148:151]
    ds_read_b64_tr_b16 a[62:63], v12 offset:30720
    v_mfma_f32_16x16x32_bf16 v[148:151], a[92:95], a[16:19], v[148:151]
    ds_read_b64_tr_b16 a[64:65], v11 offset:25600
    v_mfma_f32_16x16x32_bf16 v[200:203], a[16:19], a[96:99], v[200:203]
    ds_read_b64_tr_b16 a[66:67], v11 offset:31744
    v_mfma_f32_16x16x32_bf16 v[200:203], a[20:23], a[48:51], v[200:203]
    ds_read_b64_tr_b16 a[68:69], v12 offset:25600
    v_mfma_f32_16x16x32_bf16 v[232:235], a[20:23], a[52:55], v[232:235]
    ds_read_b64_tr_b16 a[70:71], v12 offset:31744
    v_mfma_f32_16x16x32_bf16 v[232:235], a[16:19], a[100:103], v[232:235]
    ds_read_b64_tr_b16 a[72:73], v11 offset:26624
    s_waitcnt lgkmcnt(11)
    v_mfma_f32_16x16x32_bf16 v[88:91], a[80:83], a[24:27], v[88:91]
    ds_read_b64_tr_b16 a[74:75], v11 offset:32768
    v_mfma_f32_16x16x32_bf16 v[88:91], a[32:35], a[28:31], v[88:91]
    ds_read_b64_tr_b16 a[76:77], v12 offset:26624
    v_mfma_f32_16x16x32_bf16 v[92:95], a[36:39], a[28:31], v[92:95]
    ds_read_b64_tr_b16 a[78:79], v12 offset:32768
    v_mfma_f32_16x16x32_bf16 v[92:95], a[84:87], a[24:27], v[92:95]
    ds_read_b128 a[8:11], v7 offset:2048
    v_mfma_f32_16x16x32_bf16 v[152:155], a[88:91], a[24:27], v[152:155]
    ds_read_b128 a[12:15], v8 offset:2048
    v_mfma_f32_16x16x32_bf16 v[152:155], a[40:43], a[28:31], v[152:155]
    ds_read2_b32 v[38:39], v15 offset0:0 offset1:64
    v_mfma_f32_16x16x32_bf16 v[156:159], a[44:47], a[28:31], v[156:159]
    ds_read2_b32 v[40:41], v15 offset0:16 offset1:80
    v_mfma_f32_16x16x32_bf16 v[156:159], a[92:95], a[24:27], v[156:159]
    ds_read2_b32 v[42:43], v15 offset0:32 offset1:96
    v_mfma_f32_16x16x32_bf16 v[204:207], a[24:27], a[96:99], v[204:207]
    ds_read2_b32 v[44:45], v15 offset0:48 offset1:112
    v_mfma_f32_16x16x32_bf16 v[204:207], a[28:31], a[48:51], v[204:207]
    ds_read2_b32 v[46:47], v15 offset0:128 offset1:192
    v_mfma_f32_16x16x32_bf16 v[236:239], a[28:31], a[52:55], v[236:239]
    ds_read2_b32 v[48:49], v15 offset0:144 offset1:208
    v_mfma_f32_16x16x32_bf16 v[236:239], a[24:27], a[100:103], v[236:239]
    ds_read2_b32 v[50:51], v15 offset0:160 offset1:224
    s_waitcnt lgkmcnt(9)
    v_mfma_f32_16x16x32_bf16 v[120:123], a[32:35], a[0:3], v[120:123]
    ds_read_b128 a[16:19], v7 offset:10240
    v_mfma_f32_16x16x32_bf16 v[120:123], a[56:59], a[4:7], v[120:123]
    ds_read_b128 a[20:23], v8 offset:10240
    v_mfma_f32_16x16x32_bf16 v[124:127], a[60:63], a[4:7], v[124:127]
    ds_read2_b32 v[52:53], v15 offset0:176 offset1:240
    v_mfma_f32_16x16x32_bf16 v[124:127], a[36:39], a[0:3], v[124:127]
    v_mfma_f32_16x16x32_bf16 v[184:187], a[40:43], a[0:3], v[184:187]
    v_mfma_f32_16x16x32_bf16 v[184:187], a[64:67], a[4:7], v[184:187]
    v_mfma_f32_16x16x32_bf16 v[188:191], a[68:71], a[4:7], v[188:191]
    v_mfma_f32_16x16x32_bf16 v[188:191], a[44:47], a[0:3], v[188:191]
    v_mfma_f32_16x16x32_bf16 v[220:223], a[0:3], a[48:51], v[220:223]
    v_mfma_f32_16x16x32_bf16 v[220:223], a[4:7], a[72:75], v[220:223]
    v_mfma_f32_16x16x32_bf16 v[252:255], a[4:7], a[76:79], v[252:255]
    v_mfma_f32_16x16x32_bf16 v[252:255], a[0:3], a[52:55], v[252:255]
    s_waitcnt lgkmcnt(10)
    v_mfma_f32_16x16x32_bf16 v[96:99], a[32:35], a[8:11], v[96:99]
    ds_read_b128 a[24:27], v7 offset:3072
    v_mfma_f32_16x16x32_bf16 v[96:99], a[56:59], a[12:15], v[96:99]
    ds_read_b128 a[28:31], v8 offset:3072
    v_mfma_f32_16x16x32_bf16 v[100:103], a[60:63], a[12:15], v[100:103]
    v_mfma_f32_16x16x32_bf16 v[100:103], a[36:39], a[8:11], v[100:103]
    v_mfma_f32_16x16x32_bf16 v[160:163], a[40:43], a[8:11], v[160:163]
    v_mov_b32_dpp v54, v184 row_newbcast:15 row_mask:0xf bank_mask:0xf
    v_mov_b32_dpp v55, v185 row_newbcast:15 row_mask:0xf bank_mask:0xf
    v_mfma_f32_16x16x32_bf16 v[160:163], a[64:67], a[12:15], v[160:163]
    v_mov_b32_dpp v56, v186 row_newbcast:15 row_mask:0xf bank_mask:0xf
    v_mov_b32_dpp v57, v187 row_newbcast:15 row_mask:0xf bank_mask:0xf
    v_mfma_f32_16x16x32_bf16 v[164:167], a[68:71], a[12:15], v[164:167]
    v_mov_b32_dpp v58, v188 row_newbcast:15 row_mask:0xf bank_mask:0xf
    v_mov_b32_dpp v59, v189 row_newbcast:15 row_mask:0xf bank_mask:0xf
    v_mfma_f32_16x16x32_bf16 v[164:167], a[44:47], a[8:11], v[164:167]
    v_mov_b32_dpp v60, v190 row_newbcast:15 row_mask:0xf bank_mask:0xf
    v_mov_b32_dpp v61, v191 row_newbcast:15 row_mask:0xf bank_mask:0xf
    v_mfma_f32_16x16x32_bf16 v[208:211], a[8:11], a[48:51], v[208:211]
    v_mov_b32 v62, v223
    v_mov_b32 v63, v223
    v_mfma_f32_16x16x32_bf16 v[208:211], a[12:15], a[72:75], v[208:211]
    s_nop 0
    v_permlane32_swap_b32_e64 v62, v63
    v_mov_b32 v36, v63
    v_mfma_f32_16x16x32_bf16 v[240:243], a[12:15], a[76:79], v[240:243]
    s_nop 0
    v_permlane16_swap_b32_e64 v63, v36
    v_mov_b32 v62, v255
    v_mfma_f32_16x16x32_bf16 v[240:243], a[8:11], a[52:55], v[240:243]
    v_mov_b32 v63, v255
    s_waitcnt lgkmcnt(3)
    v_mfma_f32_16x16x32_bf16 v[104:107], a[32:35], a[16:19], v[104:107]
    s_barrier
    v_mfma_f32_16x16x32_bf16 v[104:107], a[56:59], a[20:23], v[104:107]
    ds_read_b128 a[0:3], v8 offset:0
    v_permlane32_swap_b32 v62, v63
    v_mfma_f32_16x16x32_bf16 v[108:111], a[60:63], a[20:23], v[108:111]
    v_mov_b32_e64 v37, v63
    s_nop 1
    v_permlane16_swap_b32 v63, v37
    v_mfma_f32_16x16x32_bf16 v[108:111], a[36:39], a[16:19], v[108:111]
    s_waitcnt lgkmcnt(3)
    v_fmac_f32 v184, v54, v52
    v_mfma_f32_16x16x32_bf16 v[168:171], a[40:43], a[16:19], v[168:171]
    v_fmac_f32 v185, v55, v52
    v_fmac_f32 v186, v56, v52
    v_mfma_f32_16x16x32_bf16 v[168:171], a[64:67], a[20:23], v[168:171]
    v_fmac_f32 v187, v57, v52
    v_fmac_f32 v188, v58, v52
    v_mfma_f32_16x16x32_bf16 v[172:175], a[68:71], a[20:23], v[172:175]
    v_fmac_f32 v189, v59, v52
    v_fmac_f32 v190, v60, v52
    v_mfma_f32_16x16x32_bf16 v[172:175], a[44:47], a[16:19], v[172:175]
    v_fmac_f32 v191, v61, v52
    v_mul_f32 v184, v184, v53
    v_mfma_f32_16x16x32_bf16 v[212:215], a[16:19], a[48:51], v[212:215]
    v_mul_f32 v185, v185, v53
    v_mul_f32 v186, v186, v53
    v_mfma_f32_16x16x32_bf16 v[212:215], a[20:23], a[72:75], v[212:215]
    v_mul_f32 v187, v187, v53
    v_mul_f32 v188, v188, v53
    v_mfma_f32_16x16x32_bf16 v[244:247], a[20:23], a[76:79], v[244:247]
    v_mul_f32 v189, v189, v53
    v_mul_f32 v190, v190, v53
    v_mfma_f32_16x16x32_bf16 v[244:247], a[16:19], a[52:55], v[244:247]
    v_mul_f32 v191, v191, v53
    s_waitcnt lgkmcnt(1)
    v_mfma_f32_16x16x32_bf16 v[112:115], a[32:35], a[24:27], v[112:115]
    ds_read_b128 a[8:11], v8 offset:8192
    v_fmac_f32_e64 v160, v54, v46
    v_mfma_f32_16x16x32_bf16 v[112:115], a[56:59], a[28:31], v[112:115]
    v_fmac_f32 v161, v55, v46
    v_fmac_f32 v162, v56, v46
    v_mfma_f32_16x16x32_bf16 v[116:119], a[60:63], a[28:31], v[116:119]
    v_fmac_f32 v163, v57, v46
    v_fmac_f32 v164, v58, v46
    v_mfma_f32_16x16x32_bf16 v[116:119], a[36:39], a[24:27], v[116:119]
    v_fmac_f32 v165, v59, v46
    v_fmac_f32 v166, v60, v46
    v_mfma_f32_16x16x32_bf16 v[176:179], a[40:43], a[24:27], v[176:179]
    v_fmac_f32 v167, v61, v46
    v_mul_f32 v160, v160, v47
    v_mfma_f32_16x16x32_bf16 v[176:179], a[64:67], a[28:31], v[176:179]
    v_mul_f32 v161, v161, v47
    v_mul_f32 v162, v162, v47
    v_mfma_f32_16x16x32_bf16 v[180:183], a[68:71], a[28:31], v[180:183]
    v_mul_f32 v163, v163, v47
    v_mul_f32 v164, v164, v47
    v_mfma_f32_16x16x32_bf16 v[180:183], a[44:47], a[24:27], v[180:183]
    v_mul_f32 v165, v165, v47
    v_mul_f32 v166, v166, v47
    v_mfma_f32_16x16x32_bf16 v[216:219], a[24:27], a[48:51], v[216:219]
    v_mul_f32_e64 v167, v167, v47
    v_fmac_f32_dpp v96, v120, v46 row_newbcast:15 row_mask:0xf bank_mask:0xf
    v_mfma_f32_16x16x32_bf16 v[216:219], a[28:31], a[72:75], v[216:219]
    v_fmac_f32_dpp v97, v121, v46 row_newbcast:15 row_mask:0xf bank_mask:0xf
    v_fmac_f32_dpp v98, v122, v46 row_newbcast:15 row_mask:0xf bank_mask:0xf
    v_mfma_f32_16x16x32_bf16 v[248:251], a[28:31], a[76:79], v[248:251]
    v_fmac_f32_dpp v99, v123, v46 row_newbcast:15 row_mask:0xf bank_mask:0xf
    v_fmac_f32_dpp v100, v124, v46 row_newbcast:15 row_mask:0xf bank_mask:0xf
    v_mfma_f32_16x16x32_bf16 v[248:251], a[24:27], a[52:55], v[248:251]
    v_fmac_f32_dpp v101, v125, v46 row_newbcast:15 row_mask:0xf bank_mask:0xf
    s_waitcnt lgkmcnt(1)
    v_mfma_f32_16x16x32_bf16 v[64:67], a[56:59], a[0:3], v[64:67]
    ds_read_b128 a[16:19], v8 offset:1024
    v_fmac_f32_dpp v102, v126, v46 row_newbcast:15 row_mask:0xf bank_mask:0xf
    v_mfma_f32_16x16x32_bf16 v[68:71], a[60:63], a[0:3], v[68:71]
    v_fmac_f32_dpp v103, v127, v46 row_newbcast:15 row_mask:0xf bank_mask:0xf
    v_fmac_f32 v168, v54, v48
    v_mfma_f32_16x16x32_bf16 v[128:131], a[64:67], a[0:3], v[128:131]
    v_fmac_f32 v169, v55, v48
    v_fmac_f32 v170, v56, v48
    v_mfma_f32_16x16x32_bf16 v[132:135], a[68:71], a[0:3], v[132:135]
    v_fmac_f32 v171, v57, v48
    v_fmac_f32 v172, v58, v48
    v_mfma_f32_16x16x32_bf16 v[192:195], a[0:3], a[72:75], v[192:195]
    v_fmac_f32 v173, v59, v48
    v_fmac_f32 v174, v60, v48
    v_mfma_f32_16x16x32_bf16 v[224:227], a[0:3], a[76:79], v[224:227]
    v_fmac_f32 v175, v61, v48
    s_waitcnt lgkmcnt(1)
    v_mfma_f32_16x16x32_bf16 v[228:231], a[8:11], a[76:79], v[228:231]
    ds_read_b128 a[24:27], v8 offset:9216
    v_mul_f32_e64 v168, v168, v49
    v_mfma_f32_16x16x32_bf16 v[196:199], a[8:11], a[72:75], v[196:199]
    v_mul_f32 v169, v169, v49
    v_mul_f32 v170, v170, v49
    v_mfma_f32_16x16x32_bf16 v[140:143], a[68:71], a[8:11], v[140:143]
    v_mul_f32 v171, v171, v49
    v_mul_f32 v172, v172, v49
    v_mfma_f32_16x16x32_bf16 v[136:139], a[64:67], a[8:11], v[136:139]
    v_mul_f32 v173, v173, v49
    v_mul_f32 v174, v174, v49
    v_mfma_f32_16x16x32_bf16 v[76:79], a[60:63], a[8:11], v[76:79]
    v_mul_f32_e64 v175, v175, v49
    v_fmac_f32_dpp v104, v120, v48 row_newbcast:15 row_mask:0xf bank_mask:0xf
    v_mfma_f32_16x16x32_bf16 v[72:75], a[56:59], a[8:11], v[72:75]
    v_fmac_f32_dpp v105, v121, v48 row_newbcast:15 row_mask:0xf bank_mask:0xf
    s_waitcnt lgkmcnt(1)
    v_mfma_f32_16x16x32_bf16 v[80:83], a[56:59], a[16:19], v[80:83]
    v_fmac_f32_dpp v106, v122, v48 row_newbcast:15 row_mask:0xf bank_mask:0xf
    v_fmac_f32_dpp v107, v123, v48 row_newbcast:15 row_mask:0xf bank_mask:0xf
    v_mfma_f32_16x16x32_bf16 v[84:87], a[60:63], a[16:19], v[84:87]
    v_mov_b32_dpp v2, v120 row_newbcast:15 row_mask:0xf bank_mask:0xf
    v_mov_b32_dpp v3, v121 row_newbcast:15 row_mask:0xf bank_mask:0xf
    v_mfma_f32_16x16x32_bf16 v[144:147], a[64:67], a[16:19], v[144:147]
    v_mov_b32_dpp v4, v122 row_newbcast:15 row_mask:0xf bank_mask:0xf
    v_mov_b32_dpp v5, v123 row_newbcast:15 row_mask:0xf bank_mask:0xf
    v_mfma_f32_16x16x32_bf16 v[148:151], a[68:71], a[16:19], v[148:151]
    v_mov_b32_dpp v6, v124 row_newbcast:15 row_mask:0xf bank_mask:0xf
    v_mov_b32_dpp v7, v125 row_newbcast:15 row_mask:0xf bank_mask:0xf
    v_mfma_f32_16x16x32_bf16 v[200:203], a[16:19], a[72:75], v[200:203]
    v_mov_b32_dpp v8, v126 row_newbcast:15 row_mask:0xf bank_mask:0xf
    v_mov_b32_dpp v9, v127 row_newbcast:15 row_mask:0xf bank_mask:0xf
    v_mfma_f32_16x16x32_bf16 v[232:235], a[16:19], a[76:79], v[232:235]
    v_fmac_f32_dpp v108, v124, v48 row_newbcast:15 row_mask:0xf bank_mask:0xf
    s_waitcnt lgkmcnt(0)
    v_mfma_f32_16x16x32_bf16 v[236:239], a[24:27], a[76:79], v[236:239]
    v_fmac_f32_dpp v109, v125, v48 row_newbcast:15 row_mask:0xf bank_mask:0xf
    v_fmac_f32_dpp v110, v126, v48 row_newbcast:15 row_mask:0xf bank_mask:0xf
    v_mfma_f32_16x16x32_bf16 v[204:207], a[24:27], a[72:75], v[204:207]
    v_fmac_f32_dpp v111, v127, v48 row_newbcast:15 row_mask:0xf bank_mask:0xf
    v_fmac_f32_e64 v176, v54, v50
    v_mfma_f32_16x16x32_bf16 v[156:159], a[68:71], a[24:27], v[156:159]
    v_fmac_f32 v177, v55, v50
    v_fmac_f32 v178, v56, v50
    v_mfma_f32_16x16x32_bf16 v[152:155], a[64:67], a[24:27], v[152:155]
    v_fmac_f32 v179, v57, v50
    v_fmac_f32 v180, v58, v50
    v_mfma_f32_16x16x32_bf16 v[92:95], a[60:63], a[24:27], v[92:95]
    v_fmac_f32 v181, v59, v50
    v_fmac_f32 v182, v60, v50
    v_mfma_f32_16x16x32_bf16 v[88:91], a[56:59], a[24:27], v[88:91]
    v_fmac_f32_e64 v183, v61, v50
    v_mul_f32 v176, v176, v51
    v_mul_f32 v177, v177, v51
    v_mul_f32 v178, v178, v51
    v_mul_f32 v179, v179, v51
    v_mul_f32 v180, v180, v51
    v_mul_f32 v181, v181, v51
    v_mul_f32 v182, v182, v51
    v_mul_f32 v183, v183, v51
    v_pk_fma_f32 v[64:65], v[2:3], v[38:39], v[64:65] op_sel_hi:[1,0,1]
    v_pk_fma_f32 v[66:67], v[4:5], v[38:39], v[66:67] op_sel_hi:[1,0,1]
    v_pk_fma_f32 v[68:69], v[6:7], v[38:39], v[68:69] op_sel_hi:[1,0,1]
    v_pk_fma_f32 v[70:71], v[8:9], v[38:39], v[70:71] op_sel_hi:[1,0,1]
    v_pk_fma_f32 v[128:129], v[54:55], v[38:39], v[128:129] op_sel_hi:[1,0,1]
    v_pk_fma_f32 v[130:131], v[56:57], v[38:39], v[130:131] op_sel_hi:[1,0,1]
    v_pk_fma_f32 v[132:133], v[58:59], v[38:39], v[132:133] op_sel_hi:[1,0,1]
    v_pk_fma_f32 v[134:135], v[60:61], v[38:39], v[134:135] op_sel_hi:[1,0,1]
    v_pk_mul_f32 v[128:129], v[128:129], v[38:39] op_sel:[0,1] op_sel_hi:[1,1]
    v_pk_mul_f32 v[130:131], v[130:131], v[38:39] op_sel:[0,1] op_sel_hi:[1,1]
    v_pk_mul_f32 v[132:133], v[132:133], v[38:39] op_sel:[0,1] op_sel_hi:[1,1]
    v_pk_mul_f32 v[134:135], v[134:135], v[38:39] op_sel:[0,1] op_sel_hi:[1,1]
    v_pk_fma_f32 v[72:73], v[2:3], v[40:41], v[72:73] op_sel_hi:[1,0,1]
    v_pk_fma_f32 v[74:75], v[4:5], v[40:41], v[74:75] op_sel_hi:[1,0,1]
    v_pk_fma_f32 v[76:77], v[6:7], v[40:41], v[76:77] op_sel_hi:[1,0,1]
    v_pk_fma_f32 v[78:79], v[8:9], v[40:41], v[78:79] op_sel_hi:[1,0,1]
    v_pk_fma_f32 v[136:137], v[54:55], v[40:41], v[136:137] op_sel_hi:[1,0,1]
    v_pk_fma_f32 v[138:139], v[56:57], v[40:41], v[138:139] op_sel_hi:[1,0,1]
    v_pk_fma_f32 v[140:141], v[58:59], v[40:41], v[140:141] op_sel_hi:[1,0,1]
    v_pk_fma_f32 v[142:143], v[60:61], v[40:41], v[142:143] op_sel_hi:[1,0,1]
    v_pk_mul_f32 v[136:137], v[136:137], v[40:41] op_sel:[0,1] op_sel_hi:[1,1]
    v_pk_mul_f32 v[138:139], v[138:139], v[40:41] op_sel:[0,1] op_sel_hi:[1,1]
    v_pk_mul_f32 v[140:141], v[140:141], v[40:41] op_sel:[0,1] op_sel_hi:[1,1]
    v_pk_mul_f32 v[142:143], v[142:143], v[40:41] op_sel:[0,1] op_sel_hi:[1,1]
    v_pk_fma_f32 v[80:81], v[2:3], v[42:43], v[80:81] op_sel_hi:[1,0,1]
    v_pk_fma_f32 v[82:83], v[4:5], v[42:43], v[82:83] op_sel_hi:[1,0,1]
    v_pk_fma_f32 v[84:85], v[6:7], v[42:43], v[84:85] op_sel_hi:[1,0,1]
    v_pk_fma_f32 v[86:87], v[8:9], v[42:43], v[86:87] op_sel_hi:[1,0,1]
    v_pk_fma_f32 v[144:145], v[54:55], v[42:43], v[144:145] op_sel_hi:[1,0,1]
    v_pk_fma_f32 v[146:147], v[56:57], v[42:43], v[146:147] op_sel_hi:[1,0,1]
    v_pk_fma_f32 v[148:149], v[58:59], v[42:43], v[148:149] op_sel_hi:[1,0,1]
    v_pk_fma_f32 v[150:151], v[60:61], v[42:43], v[150:151] op_sel_hi:[1,0,1]
    v_pk_mul_f32 v[144:145], v[144:145], v[42:43] op_sel:[0,1] op_sel_hi:[1,1]
    v_pk_mul_f32 v[146:147], v[146:147], v[42:43] op_sel:[0,1] op_sel_hi:[1,1]
    v_pk_mul_f32 v[148:149], v[148:149], v[42:43] op_sel:[0,1] op_sel_hi:[1,1]
    v_pk_mul_f32 v[150:151], v[150:151], v[42:43] op_sel:[0,1] op_sel_hi:[1,1]
    v_pk_fma_f32 v[88:89], v[2:3], v[44:45], v[88:89] op_sel_hi:[1,0,1]
    v_pk_fma_f32 v[90:91], v[4:5], v[44:45], v[90:91] op_sel_hi:[1,0,1]
    v_pk_fma_f32 v[92:93], v[6:7], v[44:45], v[92:93] op_sel_hi:[1,0,1]
    v_pk_fma_f32 v[94:95], v[8:9], v[44:45], v[94:95] op_sel_hi:[1,0,1]
    v_pk_fma_f32 v[152:153], v[54:55], v[44:45], v[152:153] op_sel_hi:[1,0,1]
    v_pk_fma_f32 v[154:155], v[56:57], v[44:45], v[154:155] op_sel_hi:[1,0,1]
    v_pk_fma_f32 v[156:157], v[58:59], v[44:45], v[156:157] op_sel_hi:[1,0,1]
    v_pk_fma_f32 v[158:159], v[60:61], v[44:45], v[158:159] op_sel_hi:[1,0,1]
    v_pk_mul_f32 v[152:153], v[152:153], v[44:45] op_sel:[0,1] op_sel_hi:[1,1]
    v_pk_mul_f32 v[154:155], v[154:155], v[44:45] op_sel:[0,1] op_sel_hi:[1,1]
    v_pk_mul_f32 v[156:157], v[156:157], v[44:45] op_sel:[0,1] op_sel_hi:[1,1]
    v_pk_mul_f32 v[158:159], v[158:159], v[44:45] op_sel:[0,1] op_sel_hi:[1,1]
    v_pk_fma_f32 v[112:113], v[2:3], v[50:51], v[112:113] op_sel_hi:[1,0,1]
    v_pk_fma_f32 v[114:115], v[4:5], v[50:51], v[114:115] op_sel_hi:[1,0,1]
    v_pk_fma_f32 v[116:117], v[6:7], v[50:51], v[116:117] op_sel_hi:[1,0,1]
    v_pk_fma_f32 v[118:119], v[8:9], v[50:51], v[118:119] op_sel_hi:[1,0,1]
    v_pk_fma_f32 v[120:121], v[2:3], v[52:53], v[120:121] op_sel_hi:[1,0,1]
    v_pk_fma_f32 v[122:123], v[4:5], v[52:53], v[122:123] op_sel_hi:[1,0,1]
    v_pk_fma_f32 v[124:125], v[6:7], v[52:53], v[124:125] op_sel_hi:[1,0,1]
    v_pk_fma_f32 v[126:127], v[8:9], v[52:53], v[126:127] op_sel_hi:[1,0,1]
    ds_read_b128 v[2:5], v16 offset:0
    ds_read_b128 v[6:9], v16 offset:256
    ds_read_b128 v[54:57], v16 offset:64
    ds_read_b128 v[58:61], v16 offset:320
    v_cvt_pk_bf16_f32 v64, v64, v65
    v_cvt_pk_bf16_f32 v65, v66, v67
    v_cvt_pk_bf16_f32 v66, v68, v69
    v_cvt_pk_bf16_f32 v67, v70, v71
    v_cvt_pk_bf16_f32 v128, v128, v129
    v_cvt_pk_bf16_f32 v129, v130, v131
    v_cvt_pk_bf16_f32 v130, v132, v133
    v_cvt_pk_bf16_f32 v131, v134, v135
    s_waitcnt lgkmcnt(2)
    s_nop 0
    v_pk_fma_f32 v[192:193], v[2:3], v[36:37], v[192:193] op_sel:[0,0,0] op_sel_hi:[1,0,1]
    v_pk_fma_f32 v[194:195], v[4:5], v[36:37], v[194:195] op_sel:[0,0,0] op_sel_hi:[1,0,1]
    v_pk_fma_f32 v[224:225], v[2:3], v[36:37], v[224:225] op_sel:[0,1,0] op_sel_hi:[1,1,1]
    v_pk_fma_f32 v[226:227], v[4:5], v[36:37], v[226:227] op_sel:[0,1,0] op_sel_hi:[1,1,1]
    v_pk_mul_f32 v[192:193], v[192:193], v[6:7]
    v_pk_mul_f32 v[194:195], v[194:195], v[8:9]
    v_pk_mul_f32 v[224:225], v[224:225], v[6:7]
    v_pk_mul_f32 v[226:227], v[226:227], v[8:9]
    ds_read_b128 v[2:5], v16 offset:128
    ds_read_b128 v[6:9], v16 offset:384
    v_cvt_pk_bf16_f32 v68, v72, v73
    v_cvt_pk_bf16_f32 v69, v74, v75
    v_cvt_pk_bf16_f32 v70, v76, v77
    v_cvt_pk_bf16_f32 v71, v78, v79
    v_cvt_pk_bf16_f32 v132, v136, v137
    v_cvt_pk_bf16_f32 v133, v138, v139
    v_cvt_pk_bf16_f32 v134, v140, v141
    v_cvt_pk_bf16_f32 v135, v142, v143
    s_waitcnt lgkmcnt(2)
    s_nop 0
    v_pk_fma_f32 v[196:197], v[54:55], v[36:37], v[196:197] op_sel:[0,0,0] op_sel_hi:[1,0,1]
    v_pk_fma_f32 v[198:199], v[56:57], v[36:37], v[198:199] op_sel:[0,0,0] op_sel_hi:[1,0,1]
    v_pk_fma_f32 v[228:229], v[54:55], v[36:37], v[228:229] op_sel:[0,1,0] op_sel_hi:[1,1,1]
    v_pk_fma_f32 v[230:231], v[56:57], v[36:37], v[230:231] op_sel:[0,1,0] op_sel_hi:[1,1,1]
    v_pk_mul_f32 v[196:197], v[196:197], v[58:59]
    v_pk_mul_f32 v[198:199], v[198:199], v[60:61]
    v_pk_mul_f32 v[228:229], v[228:229], v[58:59]
    v_pk_mul_f32 v[230:231], v[230:231], v[60:61]
    ds_read_b128 v[54:57], v16 offset:192
    ds_read_b128 v[58:61], v16 offset:448
    v_cvt_pk_bf16_f32 v72, v80, v81
    v_cvt_pk_bf16_f32 v73, v82, v83
    v_cvt_pk_bf16_f32 v74, v84, v85
    v_cvt_pk_bf16_f32 v75, v86, v87
    v_cvt_pk_bf16_f32 v136, v144, v145
    v_cvt_pk_bf16_f32 v137, v146, v147
    v_cvt_pk_bf16_f32 v138, v148, v149
    v_cvt_pk_bf16_f32 v139, v150, v151
    s_waitcnt lgkmcnt(2)
    s_nop 0
    v_pk_fma_f32 v[200:201], v[2:3], v[36:37], v[200:201] op_sel:[0,0,0] op_sel_hi:[1,0,1]
    v_pk_fma_f32 v[202:203], v[4:5], v[36:37], v[202:203] op_sel:[0,0,0] op_sel_hi:[1,0,1]
    v_pk_fma_f32 v[232:233], v[2:3], v[36:37], v[232:233] op_sel:[0,1,0] op_sel_hi:[1,1,1]
    v_pk_fma_f32 v[234:235], v[4:5], v[36:37], v[234:235] op_sel:[0,1,0] op_sel_hi:[1,1,1]
    v_pk_mul_f32 v[200:201], v[200:201], v[6:7]
    v_pk_mul_f32 v[202:203], v[202:203], v[8:9]
    v_pk_mul_f32 v[232:233], v[232:233], v[6:7]
    v_pk_mul_f32 v[234:235], v[234:235], v[8:9]
    ds_read_b128 v[2:5], v16 offset:512
    ds_read_b128 v[6:9], v16 offset:768
    v_cvt_pk_bf16_f32 v76, v88, v89
    v_cvt_pk_bf16_f32 v77, v90, v91
    v_cvt_pk_bf16_f32 v78, v92, v93
    v_cvt_pk_bf16_f32 v79, v94, v95
    v_cvt_pk_bf16_f32 v140, v152, v153
    v_cvt_pk_bf16_f32 v141, v154, v155
    v_cvt_pk_bf16_f32 v142, v156, v157
    v_cvt_pk_bf16_f32 v143, v158, v159
    s_waitcnt lgkmcnt(2)
    s_nop 0
    v_pk_fma_f32 v[204:205], v[54:55], v[36:37], v[204:205] op_sel:[0,0,0] op_sel_hi:[1,0,1]
    v_pk_fma_f32 v[206:207], v[56:57], v[36:37], v[206:207] op_sel:[0,0,0] op_sel_hi:[1,0,1]
    v_pk_fma_f32 v[236:237], v[54:55], v[36:37], v[236:237] op_sel:[0,1,0] op_sel_hi:[1,1,1]
    v_pk_fma_f32 v[238:239], v[56:57], v[36:37], v[238:239] op_sel:[0,1,0] op_sel_hi:[1,1,1]
    v_pk_mul_f32 v[204:205], v[204:205], v[58:59]
    v_pk_mul_f32 v[206:207], v[206:207], v[60:61]
    v_pk_mul_f32 v[236:237], v[236:237], v[58:59]
    v_pk_mul_f32 v[238:239], v[238:239], v[60:61]
    ds_read_b128 v[54:57], v16 offset:576
    ds_read_b128 v[58:61], v16 offset:832
    v_cvt_pk_bf16_f32 v80, v96, v97
    v_cvt_pk_bf16_f32 v81, v98, v99
    v_cvt_pk_bf16_f32 v82, v100, v101
    v_cvt_pk_bf16_f32 v83, v102, v103
    v_cvt_pk_bf16_f32 v144, v160, v161
    v_cvt_pk_bf16_f32 v145, v162, v163
    v_cvt_pk_bf16_f32 v146, v164, v165
    v_cvt_pk_bf16_f32 v147, v166, v167
    s_waitcnt lgkmcnt(2)
    s_nop 0
    v_pk_fma_f32 v[208:209], v[2:3], v[36:37], v[208:209] op_sel:[0,0,0] op_sel_hi:[1,0,1]
    v_pk_fma_f32 v[210:211], v[4:5], v[36:37], v[210:211] op_sel:[0,0,0] op_sel_hi:[1,0,1]
    v_pk_fma_f32 v[240:241], v[2:3], v[36:37], v[240:241] op_sel:[0,1,0] op_sel_hi:[1,1,1]
    v_pk_fma_f32 v[242:243], v[4:5], v[36:37], v[242:243] op_sel:[0,1,0] op_sel_hi:[1,1,1]
    v_pk_mul_f32 v[208:209], v[208:209], v[6:7]
    v_pk_mul_f32 v[210:211], v[210:211], v[8:9]
    v_pk_mul_f32 v[240:241], v[240:241], v[6:7]
    v_pk_mul_f32 v[242:243], v[242:243], v[8:9]
    ds_read_b128 v[2:5], v16 offset:640
    ds_read_b128 v[6:9], v16 offset:896
    v_cvt_pk_bf16_f32 v84, v104, v105
    v_cvt_pk_bf16_f32 v85, v106, v107
    v_cvt_pk_bf16_f32 v86, v108, v109
    v_cvt_pk_bf16_f32 v87, v110, v111
    v_cvt_pk_bf16_f32 v148, v168, v169
    v_cvt_pk_bf16_f32 v149, v170, v171
    v_cvt_pk_bf16_f32 v150, v172, v173
    v_cvt_pk_bf16_f32 v151, v174, v175
    s_waitcnt lgkmcnt(2)
    s_nop 0
    v_pk_fma_f32 v[212:213], v[54:55], v[36:37], v[212:213] op_sel:[0,0,0] op_sel_hi:[1,0,1]
    v_pk_fma_f32 v[214:215], v[56:57], v[36:37], v[214:215] op_sel:[0,0,0] op_sel_hi:[1,0,1]
    v_pk_fma_f32 v[244:245], v[54:55], v[36:37], v[244:245] op_sel:[0,1,0] op_sel_hi:[1,1,1]
    v_pk_fma_f32 v[246:247], v[56:57], v[36:37], v[246:247] op_sel:[0,1,0] op_sel_hi:[1,1,1]
    v_pk_mul_f32 v[212:213], v[212:213], v[58:59]
    v_pk_mul_f32 v[214:215], v[214:215], v[60:61]
    v_pk_mul_f32 v[244:245], v[244:245], v[58:59]
    v_pk_mul_f32 v[246:247], v[246:247], v[60:61]
    ds_read_b128 v[54:57], v16 offset:704
    ds_read_b128 v[58:61], v16 offset:960
    v_cvt_pk_bf16_f32 v88, v112, v113
    v_cvt_pk_bf16_f32 v89, v114, v115
    v_cvt_pk_bf16_f32 v90, v116, v117
    v_cvt_pk_bf16_f32 v91, v118, v119
    v_cvt_pk_bf16_f32 v152, v176, v177
    v_cvt_pk_bf16_f32 v153, v178, v179
    v_cvt_pk_bf16_f32 v154, v180, v181
    v_cvt_pk_bf16_f32 v155, v182, v183
    s_waitcnt lgkmcnt(2)
    s_nop 0
    v_pk_fma_f32 v[216:217], v[2:3], v[36:37], v[216:217] op_sel:[0,0,0] op_sel_hi:[1,0,1]
    v_pk_fma_f32 v[218:219], v[4:5], v[36:37], v[218:219] op_sel:[0,0,0] op_sel_hi:[1,0,1]
    v_pk_fma_f32 v[248:249], v[2:3], v[36:37], v[248:249] op_sel:[0,1,0] op_sel_hi:[1,1,1]
    v_pk_fma_f32 v[250:251], v[4:5], v[36:37], v[250:251] op_sel:[0,1,0] op_sel_hi:[1,1,1]
    v_pk_mul_f32 v[216:217], v[216:217], v[6:7]
    v_pk_mul_f32 v[218:219], v[218:219], v[8:9]
    v_pk_mul_f32 v[248:249], v[248:249], v[6:7]
    v_pk_mul_f32 v[250:251], v[250:251], v[8:9]
    v_cvt_pk_bf16_f32 v92, v120, v121
    v_cvt_pk_bf16_f32 v93, v122, v123
    v_cvt_pk_bf16_f32 v94, v124, v125
    v_cvt_pk_bf16_f32 v95, v126, v127
    v_cvt_pk_bf16_f32 v156, v184, v185
    v_cvt_pk_bf16_f32 v157, v186, v187
    v_cvt_pk_bf16_f32 v158, v188, v189
    v_cvt_pk_bf16_f32 v159, v190, v191
    s_waitcnt lgkmcnt(0)
    s_nop 0
    v_pk_fma_f32 v[220:221], v[54:55], v[36:37], v[220:221] op_sel:[0,0,0] op_sel_hi:[1,0,1]
    v_pk_fma_f32 v[222:223], v[56:57], v[36:37], v[222:223] op_sel:[0,0,0] op_sel_hi:[1,0,1]
    v_pk_fma_f32 v[252:253], v[54:55], v[36:37], v[252:253] op_sel:[0,1,0] op_sel_hi:[1,1,1]
    v_pk_fma_f32 v[254:255], v[56:57], v[36:37], v[254:255] op_sel:[0,1,0] op_sel_hi:[1,1,1]
    v_pk_mul_f32 v[220:221], v[220:221], v[58:59]
    v_pk_mul_f32 v[222:223], v[222:223], v[60:61]
    v_pk_mul_f32 v[252:253], v[252:253], v[58:59]
    v_pk_mul_f32 v[254:255], v[254:255], v[60:61]
    v_mfma_f32_16x16x32_bf16 v[100:103], v[128:131], v[64:67], v[32:35]
    v_cvt_pk_bf16_f32 v192, v192, v193
    v_cvt_pk_bf16_f32 v193, v194, v195
    v_mfma_f32_16x16x32_bf16 v[104:107], v[128:131], v[68:71], v[28:31]
    v_cvt_pk_bf16_f32 v224, v224, v225
    v_cvt_pk_bf16_f32 v225, v226, v227
    v_mfma_f32_16x16x32_bf16 v[108:111], v[132:135], v[68:71], v[32:35]
    v_cvt_pk_bf16_f32 v194, v196, v197
    v_cvt_pk_bf16_f32 v195, v198, v199
    v_mfma_f32_16x16x32_bf16 v[112:115], v[132:135], v[72:75], v[28:31]
    v_cvt_pk_bf16_f32 v226, v228, v229
    v_cvt_pk_bf16_f32 v227, v230, v231
    v_mfma_f32_16x16x32_bf16 v[116:119], v[136:139], v[72:75], v[32:35]
    v_cvt_pk_bf16_f32 v196, v200, v201
    v_cvt_pk_bf16_f32 v197, v202, v203
    v_mfma_f32_16x16x32_bf16 v[120:123], v[136:139], v[76:79], v[28:31]
    v_cvt_pk_bf16_f32 v228, v232, v233
    v_cvt_pk_bf16_f32 v229, v234, v235
    v_mfma_f32_16x16x32_bf16 v[124:127], v[140:143], v[76:79], v[32:35]
    v_cvt_pk_bf16_f32 v198, v204, v205
    v_cvt_pk_bf16_f32 v199, v206, v207
    v_mfma_f32_16x16x32_bf16 v[164:167], v[144:147], v[80:83], v[32:35]
    v_cvt_pk_bf16_f32 v230, v236, v237
    v_cvt_pk_bf16_f32 v231, v238, v239
    v_mfma_f32_16x16x32_bf16 v[168:171], v[144:147], v[84:87], v[28:31]
    v_cvt_pk_bf16_f32 v200, v208, v209
    v_cvt_pk_bf16_f32 v201, v210, v211
    v_mfma_f32_16x16x32_bf16 v[172:175], v[148:151], v[84:87], v[32:35]
    v_cvt_pk_bf16_f32 v232, v240, v241
    v_cvt_pk_bf16_f32 v233, v242, v243
    v_mfma_f32_16x16x32_bf16 v[176:179], v[148:151], v[88:91], v[28:31]
    v_cvt_pk_bf16_f32 v202, v212, v213
    v_cvt_pk_bf16_f32 v203, v214, v215
    v_mfma_f32_16x16x32_bf16 v[180:183], v[152:155], v[88:91], v[32:35]
    v_cvt_pk_bf16_f32 v234, v244, v245
    v_cvt_pk_bf16_f32 v235, v246, v247
    v_mfma_f32_16x16x32_bf16 v[184:187], v[152:155], v[92:95], v[28:31]
    v_cvt_pk_bf16_f32 v204, v216, v217
    v_cvt_pk_bf16_f32 v205, v218, v219
    v_mfma_f32_16x16x32_bf16 v[188:191], v[156:159], v[92:95], v[32:35]
    v_cvt_pk_bf16_f32 v236, v248, v249
    v_cvt_pk_bf16_f32 v237, v250, v251
    v_cvt_pk_bf16_f32 v206, v220, v221
    v_cvt_pk_bf16_f32 v207, v222, v223
    v_cvt_pk_bf16_f32 v238, v252, v253
    v_cvt_pk_bf16_f32 v239, v254, v255
    v_mul_f32 v39, 0x3e8b97f6, v39
    v_mul_f32 v41, 0x3e8b97f6, v41
    v_mul_f32 v43, 0x3e8b97f6, v43
    v_mul_f32 v45, 0x3e8b97f6, v45
    v_mul_f32 v47, 0x3e8b97f6, v47
    v_mul_f32 v49, 0x3e8b97f6, v49
    v_mul_f32 v51, 0x3e8b97f6, v51
    v_mul_f32 v53, 0x3e8b97f6, v53
    v_max3_f32 v10, v100, v101, v102
    v_max_f32_e64 v10, v10, v103
    v_max3_f32 v11, v104, v105, v106
    v_max3_f32 v11, v11, v107, v108
    v_max3_f32 v11, v11, v109, v110
    v_max_f32_e64 v11, v11, v111
    v_max3_f32 v12, v112, v113, v114
    v_max3_f32 v12, v12, v115, v116
    v_max3_f32 v12, v12, v117, v118
    v_max_f32_e64 v12, v12, v119
    v_max3_f32 v13, v120, v121, v122
    v_max3_f32 v13, v13, v123, v124
    v_max3_f32 v13, v13, v125, v126
    v_max_f32_e64 v13, v13, v127
    v_max3_f32 v22, v164, v165, v166
    v_max_f32_e64 v22, v22, v167
    v_max3_f32 v23, v168, v169, v170
    v_max3_f32 v23, v23, v171, v172
    v_max3_f32 v23, v23, v173, v174
    v_max_f32_e64 v23, v23, v175
    v_max3_f32 v24, v176, v177, v178
    v_max3_f32 v24, v24, v179, v180
    v_max3_f32 v24, v24, v181, v182
    v_max_f32_e64 v24, v24, v183
    v_max3_f32 v25, v184, v185, v186
    v_max3_f32 v25, v25, v187, v188
    v_max3_f32 v25, v25, v189, v190
    v_max_f32 v25, v25, v191
    v_permlane32_swap_b32 v10, v11
    v_permlane32_swap_b32 v12, v13
    v_permlane32_swap_b32 v22, v23
    v_permlane32_swap_b32 v24, v25
    v_max_f32 v10, v10, v11
    v_max_f32 v12, v12, v13
    v_max_f32 v22, v22, v23
    v_max_f32 v24, v24, v25
    v_permlane16_swap_b32 v10, v12
    s_nop 0
    v_permlane16_swap_b32 v22, v24
    v_max_f32 v10, v10, v12
    v_max_f32 v22, v22, v24
    v_mov_b32 v12, v10
    v_mov_b32 v24, v22
    v_mov_b32 v2, 0x3f803f80
    v_mov_b32 v3, 0x3f803f80
    v_permlane16_swap_b32 v10, v12
    v_permlane16_swap_b32 v22, v24
    v_mov_b32 v11, v10
    v_mov_b32 v13, v12
    v_mov_b32 v23, v22
    v_mov_b32 v25, v24
    v_mov_b32 v4, 0x3f803f80
    v_mov_b32 v5, 0x3f803f80
    v_permlane32_swap_b32 v10, v11
    v_permlane32_swap_b32 v12, v13
    v_permlane32_swap_b32 v22, v23
    v_permlane32_swap_b32 v24, v25
    v_mul_f32 v38, v10, v39
    v_mul_f32 v40, v11, v41
    v_mul_f32 v42, v12, v43
    v_mul_f32 v44, v13, v45
    v_mul_f32 v46, v22, v47
    v_mul_f32 v48, v23, v49
    v_mul_f32 v50, v24, v51
    v_mul_f32 v52, v25, v53
    v_pk_fma_f32 v[100:101], v[100:101], v[38:39], v[38:39] op_sel:[0,1,0] op_sel_hi:[1,1,0] neg_lo:[0,0,1] neg_hi:[0,0,1]
    v_pk_fma_f32 v[102:103], v[102:103], v[38:39], v[38:39] op_sel:[0,1,0] op_sel_hi:[1,1,0] neg_lo:[0,0,1] neg_hi:[0,0,1]
    v_exp_f32 v100, v100
    v_exp_f32 v101, v101
    v_exp_f32 v102, v102
    v_exp_f32 v103, v103
    v_cvt_pk_bf16_f32 v56, v100, v101
    v_cvt_pk_bf16_f32 v57, v102, v103
    v_mov_b32 v58, 0
    v_mov_b32 v59, 0
    v_pk_fma_f32 v[104:105], v[104:105], v[40:41], v[40:41] op_sel:[0,1,0] op_sel_hi:[1,1,0] neg_lo:[0,0,1] neg_hi:[0,0,1]
    v_pk_fma_f32 v[106:107], v[106:107], v[40:41], v[40:41] op_sel:[0,1,0] op_sel_hi:[1,1,0] neg_lo:[0,0,1] neg_hi:[0,0,1]
    v_pk_fma_f32 v[108:109], v[108:109], v[40:41], v[40:41] op_sel:[0,1,0] op_sel_hi:[1,1,0] neg_lo:[0,0,1] neg_hi:[0,0,1]
    v_pk_fma_f32 v[110:111], v[110:111], v[40:41], v[40:41] op_sel:[0,1,0] op_sel_hi:[1,1,0] neg_lo:[0,0,1] neg_hi:[0,0,1]
    v_mfma_f32_16x16x32_bf16 v[136:139], v[2:5], v[56:59], 0
    v_exp_f32_e64 v104, v104
    v_mfma_f32_16x16x32_bf16 v[128:131], v[192:195], v[56:59], 0
    v_exp_f32_e64 v105, v105
    v_mfma_f32_16x16x32_bf16 v[132:135], v[224:227], v[56:59], 0
    v_exp_f32_e64 v106, v106
    v_exp_f32 v107, v107
    v_exp_f32 v108, v108
    v_exp_f32 v109, v109
    v_exp_f32 v110, v110
    v_exp_f32 v111, v111
    v_rcp_f32 v136, v136
    v_cvt_pk_bf16_f32 v60, v104, v105
    v_cvt_pk_bf16_f32 v61, v106, v107
    v_cvt_pk_bf16_f32 v62, v108, v109
    v_cvt_pk_bf16_f32 v63, v110, v111
    v_pk_mul_f32 v[128:129], v[128:129], v[136:137] op_sel_hi:[1,0]
    v_pk_mul_f32 v[130:131], v[130:131], v[136:137] op_sel_hi:[1,0]
    v_pk_mul_f32 v[132:133], v[132:133], v[136:137] op_sel_hi:[1,0]
    v_pk_mul_f32 v[134:135], v[134:135], v[136:137] op_sel_hi:[1,0]
    v_cvt_pk_bf16_f32 v64, v128, v129
    v_cvt_pk_bf16_f32 v65, v130, v131
    v_cvt_pk_bf16_f32 v66, v132, v133
    v_cvt_pk_bf16_f32 v67, v134, v135
    v_pk_fma_f32 v[112:113], v[112:113], v[42:43], v[42:43] op_sel:[0,1,0] op_sel_hi:[1,1,0] neg_lo:[0,0,1] neg_hi:[0,0,1]
    v_pk_fma_f32 v[114:115], v[114:115], v[42:43], v[42:43] op_sel:[0,1,0] op_sel_hi:[1,1,0] neg_lo:[0,0,1] neg_hi:[0,0,1]
    v_pk_fma_f32 v[116:117], v[116:117], v[42:43], v[42:43] op_sel:[0,1,0] op_sel_hi:[1,1,0] neg_lo:[0,0,1] neg_hi:[0,0,1]
    v_pk_fma_f32 v[118:119], v[118:119], v[42:43], v[42:43] op_sel:[0,1,0] op_sel_hi:[1,1,0] neg_lo:[0,0,1] neg_hi:[0,0,1]
    v_mfma_f32_16x16x32_bf16 v[148:151], v[2:5], v[60:63], 0
    v_exp_f32_e64 v112, v112
    v_mfma_f32_16x16x32_bf16 v[140:143], v[192:195], v[60:63], 0
    v_exp_f32_e64 v113, v113
    v_mfma_f32_16x16x32_bf16 v[144:147], v[224:227], v[60:63], 0
    v_exp_f32_e64 v114, v114
    v_exp_f32 v115, v115
    v_exp_f32 v116, v116
    v_exp_f32 v117, v117
    v_exp_f32 v118, v118
    v_exp_f32 v119, v119
    v_rcp_f32 v148, v148
    v_cvt_pk_bf16_f32 v56, v112, v113
    v_cvt_pk_bf16_f32 v57, v114, v115
    v_cvt_pk_bf16_f32 v58, v116, v117
    v_cvt_pk_bf16_f32 v59, v118, v119
    v_pk_mul_f32 v[140:141], v[140:141], v[148:149] op_sel_hi:[1,0]
    v_pk_mul_f32 v[142:143], v[142:143], v[148:149] op_sel_hi:[1,0]
    v_pk_mul_f32 v[144:145], v[144:145], v[148:149] op_sel_hi:[1,0]
    v_pk_mul_f32 v[146:147], v[146:147], v[148:149] op_sel_hi:[1,0]
    v_cvt_pk_bf16_f32 v68, v140, v141
    v_cvt_pk_bf16_f32 v69, v142, v143
    v_cvt_pk_bf16_f32 v70, v144, v145
    v_cvt_pk_bf16_f32 v71, v146, v147
    v_pk_fma_f32 v[120:121], v[120:121], v[44:45], v[44:45] op_sel:[0,1,0] op_sel_hi:[1,1,0] neg_lo:[0,0,1] neg_hi:[0,0,1]
    v_pk_fma_f32 v[122:123], v[122:123], v[44:45], v[44:45] op_sel:[0,1,0] op_sel_hi:[1,1,0] neg_lo:[0,0,1] neg_hi:[0,0,1]
    v_pk_fma_f32 v[124:125], v[124:125], v[44:45], v[44:45] op_sel:[0,1,0] op_sel_hi:[1,1,0] neg_lo:[0,0,1] neg_hi:[0,0,1]
    v_pk_fma_f32 v[126:127], v[126:127], v[44:45], v[44:45] op_sel:[0,1,0] op_sel_hi:[1,1,0] neg_lo:[0,0,1] neg_hi:[0,0,1]
    v_mfma_f32_16x16x32_bf16 v[136:139], v[2:5], v[56:59], 0
    v_exp_f32_e64 v120, v120
    v_mfma_f32_16x16x32_bf16 v[128:131], v[194:197], v[56:59], 0
    v_exp_f32_e64 v121, v121
    v_mfma_f32_16x16x32_bf16 v[132:135], v[226:229], v[56:59], 0
    v_exp_f32_e64 v122, v122
    v_exp_f32 v123, v123
    v_exp_f32 v124, v124
    v_exp_f32 v125, v125
    v_exp_f32 v126, v126
    v_exp_f32 v127, v127
    v_rcp_f32 v136, v136
    v_cvt_pk_bf16_f32 v60, v120, v121
    v_cvt_pk_bf16_f32 v61, v122, v123
    v_cvt_pk_bf16_f32 v62, v124, v125
    v_cvt_pk_bf16_f32 v63, v126, v127
    v_pk_mul_f32 v[128:129], v[128:129], v[136:137] op_sel_hi:[1,0]
    v_pk_mul_f32 v[130:131], v[130:131], v[136:137] op_sel_hi:[1,0]
    v_pk_mul_f32 v[132:133], v[132:133], v[136:137] op_sel_hi:[1,0]
    v_pk_mul_f32 v[134:135], v[134:135], v[136:137] op_sel_hi:[1,0]
    v_cvt_pk_bf16_f32 v72, v128, v129
    v_cvt_pk_bf16_f32 v73, v130, v131
    v_cvt_pk_bf16_f32 v74, v132, v133
    v_cvt_pk_bf16_f32 v75, v134, v135
    v_pk_fma_f32 v[164:165], v[164:165], v[46:47], v[46:47] op_sel:[0,1,0] op_sel_hi:[1,1,0] neg_lo:[0,0,1] neg_hi:[0,0,1]
    v_pk_fma_f32 v[166:167], v[166:167], v[46:47], v[46:47] op_sel:[0,1,0] op_sel_hi:[1,1,0] neg_lo:[0,0,1] neg_hi:[0,0,1]
    v_mfma_f32_16x16x32_bf16 v[148:151], v[2:5], v[60:63], 0
    v_exp_f32_e64 v164, v164
    v_mfma_f32_16x16x32_bf16 v[140:143], v[196:199], v[60:63], 0
    v_exp_f32_e64 v165, v165
    v_mfma_f32_16x16x32_bf16 v[144:147], v[228:231], v[60:63], 0
    v_exp_f32 v166, v166
    v_exp_f32 v167, v167
    s_nop 1
    v_rcp_f32 v148, v148
    v_cvt_pk_bf16_f32 v56, v164, v165
    v_cvt_pk_bf16_f32 v57, v166, v167
    v_mov_b32 v58, 0
    v_mov_b32 v59, 0
    v_pk_mul_f32 v[140:141], v[140:141], v[148:149] op_sel_hi:[1,0]
    v_pk_mul_f32 v[142:143], v[142:143], v[148:149] op_sel_hi:[1,0]
    v_pk_mul_f32 v[144:145], v[144:145], v[148:149] op_sel_hi:[1,0]
    v_pk_mul_f32 v[146:147], v[146:147], v[148:149] op_sel_hi:[1,0]
    v_cvt_pk_bf16_f32 v76, v140, v141
    v_cvt_pk_bf16_f32 v77, v142, v143
    v_cvt_pk_bf16_f32 v78, v144, v145
    v_cvt_pk_bf16_f32 v79, v146, v147
    v_permlane32_swap_b32 v64, v72
    v_permlane32_swap_b32 v68, v76
    v_permlane32_swap_b32 v65, v73
    v_permlane32_swap_b32 v69, v77
    v_permlane32_swap_b32 v66, v74
    v_permlane32_swap_b32 v70, v78
    v_permlane32_swap_b32 v67, v75
    v_permlane32_swap_b32 v71, v79
    v_permlane16_swap_b32 v64, v68
    v_permlane16_swap_b32 v65, v69
    v_permlane16_swap_b32 v66, v70
    v_permlane16_swap_b32 v67, v71
    buffer_store_dwordx4 v[64:67], v20, s[36:39], s70 offen offset:0 sc1
    buffer_store_dwordx4 v[68:71], v20, s[36:39], s70 offen offset:256 sc1
    v_permlane16_swap_b32 v72, v76
    v_permlane16_swap_b32 v73, v77
    v_permlane16_swap_b32 v74, v78
    v_permlane16_swap_b32 v75, v79
    buffer_store_dwordx4 v[72:75], v20, s[36:39], s70 offen offset:512 sc1
    buffer_store_dwordx4 v[76:79], v20, s[36:39], s70 offen offset:768 sc1
    v_pk_fma_f32 v[168:169], v[168:169], v[48:49], v[48:49] op_sel:[0,1,0] op_sel_hi:[1,1,0] neg_lo:[0,0,1] neg_hi:[0,0,1]
    v_pk_fma_f32 v[170:171], v[170:171], v[48:49], v[48:49] op_sel:[0,1,0] op_sel_hi:[1,1,0] neg_lo:[0,0,1] neg_hi:[0,0,1]
    v_pk_fma_f32 v[172:173], v[172:173], v[48:49], v[48:49] op_sel:[0,1,0] op_sel_hi:[1,1,0] neg_lo:[0,0,1] neg_hi:[0,0,1]
    v_pk_fma_f32 v[174:175], v[174:175], v[48:49], v[48:49] op_sel:[0,1,0] op_sel_hi:[1,1,0] neg_lo:[0,0,1] neg_hi:[0,0,1]
    v_mfma_f32_16x16x32_bf16 v[136:139], v[2:5], v[56:59], 0
    v_exp_f32_e64 v168, v168
    v_mfma_f32_16x16x32_bf16 v[128:131], v[200:203], v[56:59], 0
    v_exp_f32_e64 v169, v169
    v_mfma_f32_16x16x32_bf16 v[132:135], v[232:235], v[56:59], 0
    v_exp_f32_e64 v170, v170
    v_exp_f32 v171, v171
    v_exp_f32 v172, v172
    v_exp_f32 v173, v173
    v_exp_f32 v174, v174
    v_exp_f32 v175, v175
    v_rcp_f32 v136, v136
    v_cvt_pk_bf16_f32 v60, v168, v169
    v_cvt_pk_bf16_f32 v61, v170, v171
    v_cvt_pk_bf16_f32 v62, v172, v173
    v_cvt_pk_bf16_f32 v63, v174, v175
    v_pk_mul_f32 v[128:129], v[128:129], v[136:137] op_sel_hi:[1,0]
    v_pk_mul_f32 v[130:131], v[130:131], v[136:137] op_sel_hi:[1,0]
    v_pk_mul_f32 v[132:133], v[132:133], v[136:137] op_sel_hi:[1,0]
    v_pk_mul_f32 v[134:135], v[134:135], v[136:137] op_sel_hi:[1,0]
    v_cvt_pk_bf16_f32 v80, v128, v129
    v_cvt_pk_bf16_f32 v81, v130, v131
    v_cvt_pk_bf16_f32 v82, v132, v133
    v_cvt_pk_bf16_f32 v83, v134, v135
    v_pk_fma_f32 v[176:177], v[176:177], v[50:51], v[50:51] op_sel:[0,1,0] op_sel_hi:[1,1,0] neg_lo:[0,0,1] neg_hi:[0,0,1]
    v_pk_fma_f32 v[178:179], v[178:179], v[50:51], v[50:51] op_sel:[0,1,0] op_sel_hi:[1,1,0] neg_lo:[0,0,1] neg_hi:[0,0,1]
    v_pk_fma_f32 v[180:181], v[180:181], v[50:51], v[50:51] op_sel:[0,1,0] op_sel_hi:[1,1,0] neg_lo:[0,0,1] neg_hi:[0,0,1]
    v_pk_fma_f32 v[182:183], v[182:183], v[50:51], v[50:51] op_sel:[0,1,0] op_sel_hi:[1,1,0] neg_lo:[0,0,1] neg_hi:[0,0,1]
    v_mfma_f32_16x16x32_bf16 v[148:151], v[2:5], v[60:63], 0
    v_exp_f32_e64 v176, v176
    v_mfma_f32_16x16x32_bf16 v[140:143], v[200:203], v[60:63], 0
    v_exp_f32_e64 v177, v177
    v_mfma_f32_16x16x32_bf16 v[144:147], v[232:235], v[60:63], 0
    v_exp_f32_e64 v178, v178
    v_exp_f32 v179, v179
    v_exp_f32 v180, v180
    v_exp_f32 v181, v181
    v_exp_f32 v182, v182
    v_exp_f32 v183, v183
    v_rcp_f32 v148, v148
    v_cvt_pk_bf16_f32 v56, v176, v177
    v_cvt_pk_bf16_f32 v57, v178, v179
    v_cvt_pk_bf16_f32 v58, v180, v181
    v_cvt_pk_bf16_f32 v59, v182, v183
    v_pk_mul_f32 v[140:141], v[140:141], v[148:149] op_sel_hi:[1,0]
    v_pk_mul_f32 v[142:143], v[142:143], v[148:149] op_sel_hi:[1,0]
    v_pk_mul_f32 v[144:145], v[144:145], v[148:149] op_sel_hi:[1,0]
    v_pk_mul_f32 v[146:147], v[146:147], v[148:149] op_sel_hi:[1,0]
    v_cvt_pk_bf16_f32 v84, v140, v141
    v_cvt_pk_bf16_f32 v85, v142, v143
    v_cvt_pk_bf16_f32 v86, v144, v145
    v_cvt_pk_bf16_f32 v87, v146, v147
    v_pk_fma_f32 v[184:185], v[184:185], v[52:53], v[52:53] op_sel:[0,1,0] op_sel_hi:[1,1,0] neg_lo:[0,0,1] neg_hi:[0,0,1]
    v_pk_fma_f32 v[186:187], v[186:187], v[52:53], v[52:53] op_sel:[0,1,0] op_sel_hi:[1,1,0] neg_lo:[0,0,1] neg_hi:[0,0,1]
    v_pk_fma_f32 v[188:189], v[188:189], v[52:53], v[52:53] op_sel:[0,1,0] op_sel_hi:[1,1,0] neg_lo:[0,0,1] neg_hi:[0,0,1]
    v_pk_fma_f32 v[190:191], v[190:191], v[52:53], v[52:53] op_sel:[0,1,0] op_sel_hi:[1,1,0] neg_lo:[0,0,1] neg_hi:[0,0,1]
    v_mfma_f32_16x16x32_bf16 v[136:139], v[2:5], v[56:59], 0
    v_exp_f32_e64 v184, v184
    v_mfma_f32_16x16x32_bf16 v[128:131], v[202:205], v[56:59], 0
    v_exp_f32_e64 v185, v185
    v_mfma_f32_16x16x32_bf16 v[132:135], v[234:237], v[56:59], 0
    v_exp_f32_e64 v186, v186
    v_exp_f32 v187, v187
    v_exp_f32 v188, v188
    v_exp_f32 v189, v189
    v_exp_f32 v190, v190
    v_exp_f32 v191, v191
    v_rcp_f32 v136, v136
    v_cvt_pk_bf16_f32 v60, v184, v185
    v_cvt_pk_bf16_f32 v61, v186, v187
    v_cvt_pk_bf16_f32 v62, v188, v189
    v_cvt_pk_bf16_f32 v63, v190, v191
    v_pk_mul_f32 v[128:129], v[128:129], v[136:137] op_sel_hi:[1,0]
    v_pk_mul_f32 v[130:131], v[130:131], v[136:137] op_sel_hi:[1,0]
    v_pk_mul_f32 v[132:133], v[132:133], v[136:137] op_sel_hi:[1,0]
    v_pk_mul_f32 v[134:135], v[134:135], v[136:137] op_sel_hi:[1,0]
    v_cvt_pk_bf16_f32 v88, v128, v129
    v_cvt_pk_bf16_f32 v89, v130, v131
    v_cvt_pk_bf16_f32 v90, v132, v133
    v_cvt_pk_bf16_f32 v91, v134, v135
    v_mfma_f32_16x16x32_bf16 v[148:151], v[2:5], v[60:63], 0
    v_mfma_f32_16x16x32_bf16 v[140:143], v[204:207], v[60:63], 0
    v_mfma_f32_16x16x32_bf16 v[144:147], v[236:239], v[60:63], 0
    s_nop 5
    v_rcp_f32_e64 v148, v148
    s_nop 0
    v_pk_mul_f32 v[140:141], v[140:141], v[148:149] op_sel_hi:[1,0]
    v_pk_mul_f32 v[142:143], v[142:143], v[148:149] op_sel_hi:[1,0]
    v_pk_mul_f32 v[144:145], v[144:145], v[148:149] op_sel_hi:[1,0]
    v_pk_mul_f32 v[146:147], v[146:147], v[148:149] op_sel_hi:[1,0]
    v_cvt_pk_bf16_f32 v92, v140, v141
    v_cvt_pk_bf16_f32 v93, v142, v143
    v_cvt_pk_bf16_f32 v94, v144, v145
    v_cvt_pk_bf16_f32 v95, v146, v147
    v_permlane32_swap_b32 v80, v88
    v_permlane32_swap_b32 v84, v92
    v_permlane32_swap_b32 v81, v89
    v_permlane32_swap_b32 v85, v93
    v_permlane32_swap_b32 v82, v90
    v_permlane32_swap_b32 v86, v94
    v_permlane32_swap_b32 v83, v91
    v_permlane32_swap_b32 v87, v95
    v_permlane16_swap_b32 v80, v84
    v_permlane16_swap_b32 v81, v85
    v_permlane16_swap_b32 v82, v86
    v_permlane16_swap_b32 v83, v87
    buffer_store_dwordx4 v[80:83], v21, s[36:39], s70 offen offset:0 sc1
    buffer_store_dwordx4 v[84:87], v21, s[36:39], s70 offen offset:256 sc1
    v_permlane16_swap_b32 v88, v92
    v_permlane16_swap_b32 v89, v93
    v_permlane16_swap_b32 v90, v94
    v_permlane16_swap_b32 v91, v95
    buffer_store_dwordx4 v[88:91], v21, s[36:39], s70 offen offset:512 sc1
    buffer_store_dwordx4 v[92:95], v21, s[36:39], s70 offen offset:768 sc1
    v_mov_b32 v2, 1
    s_waitcnt vmcnt(0)
    buffer_atomic_add v2, v17, s[36:39], s3 offen sc1
    s_endpgm
L_idle1:
    s_mul_i32 s61, s60, 10240
    s_add_u32 s61, s61, 9637888
    v_lshl_add_u32 v2, v0, 4, s61
    v_add_u32 v3, 4096, v2
    global_store_dwordx4 v2, v[4:7], s[22:23] offset:-4096 sc1
    global_store_dwordx4 v2, v[4:7], s[22:23] offset:-3072 sc1
    global_store_dwordx4 v2, v[4:7], s[22:23] offset:-2048 sc1
    global_store_dwordx4 v2, v[4:7], s[22:23] offset:-1024 sc1
    global_store_dwordx4 v2, v[4:7], s[22:23] offset:0 sc1
    global_store_dwordx4 v2, v[4:7], s[22:23] offset:1024 sc1
    global_store_dwordx4 v2, v[4:7], s[22:23] offset:2048 sc1
    global_store_dwordx4 v2, v[4:7], s[22:23] offset:3072 sc1
    global_store_dwordx4 v3, v[4:7], s[22:23] offset:0 sc1
    global_store_dwordx4 v3, v[4:7], s[22:23] offset:1024 sc1
    s_lshl_b32 s61, s60, 12
    s_add_u32 s61, s61, 9568256
    v_lshl_add_u32 v2, v0, 4, s61
    global_store_dwordx4 v2, v[4:7], s[22:23] offset:0 sc1
    global_store_dwordx4 v2, v[4:7], s[22:23] offset:1024 sc1
    global_store_dwordx4 v2, v[4:7], s[22:23] offset:2048 sc1
    global_store_dwordx4 v2, v[4:7], s[22:23] offset:3072 sc1
L_idle:
    s_mov_b64 s[36:37], s[22:23]
    s_mov_b32 s38, 9699328
    s_mov_b32 s39, 0x20000
    s_mov_b64 s[52:53], s[20:21]
    s_mov_b32 s54, 256
    s_mov_b32 s55, 0x20000
    s_mov_b64 s[24:25], s[4:5]
    s_lshl_b32 s64, s62, 7
    s_cmp_eq_u32 s60, 0
    s_cselect_b32 s64, s64, 2147483632
    v_mov_b32 v8, 1
    v_lshl_add_u32 v9, v0, 8, s64
    s_waitcnt vmcnt(0)
    s_barrier
    buffer_store_dword v8, v9, s[52:55], 0 offen sc1
    buffer_load_dwordx4 v[38:41], v48, s[24:27], s70 offen
    buffer_load_dwordx4 v[42:45], v48, s[24:27], s70 offen offset:448
    v_and_b32_e64 v48, 1, v0
    v_cmp_eq_u32 s[80:81], 1, v48
    v_lshlrev_b32_e64 v48, 5, v48
    v_lshl_add_u32 v48, v46, 2, v48
    v_bfe_u32 v47, v0, 4, 1
    v_lshlrev_b32 v47, 6, v47
    v_sub_u32 v48, v48, v47
    s_lshl3_add_u32 s61, s60, 163776
    v_cmp_eq_u32 vcc, 0, v0
    v_add_u32 v48, s61, v48
    v_mov_b32 v46, 0
    v_cndmask_b32 v1, v49, v46, vcc
    s_waitcnt vmcnt(0)
    v_lshlrev_b32 v52, 16, v38
    v_and_b32 v53, 0xffff0000, v38
    v_pk_add_f32 v[46:47], v[52:53], 0
    v_pk_mul_f32 v[50:51], v[52:53], v[52:53]
    v_lshlrev_b32_e64 v52, 16, v39
    v_and_b32 v53, 0xffff0000, v39
    v_pk_add_f32 v[46:47], v[46:47], v[52:53]
    v_pk_fma_f32 v[50:51], v[52:53], v[52:53], v[50:51]
    v_lshlrev_b32_e64 v52, 16, v40
    v_and_b32 v53, 0xffff0000, v40
    v_pk_add_f32 v[46:47], v[46:47], v[52:53]
    v_pk_fma_f32 v[50:51], v[52:53], v[52:53], v[50:51]
    v_lshlrev_b32_e64 v52, 16, v41
    v_and_b32 v53, 0xffff0000, v41
    v_pk_add_f32 v[46:47], v[46:47], v[52:53]
    v_pk_fma_f32 v[50:51], v[52:53], v[52:53], v[50:51]
    v_lshlrev_b32_e64 v52, 16, v42
    v_and_b32 v53, 0xffff0000, v42
    v_pk_add_f32 v[46:47], v[46:47], v[52:53]
    v_pk_fma_f32 v[50:51], v[52:53], v[52:53], v[50:51]
    v_lshlrev_b32_e64 v52, 16, v43
    v_and_b32 v53, 0xffff0000, v43
    v_pk_add_f32 v[46:47], v[46:47], v[52:53]
    v_pk_fma_f32 v[50:51], v[52:53], v[52:53], v[50:51]
    v_lshlrev_b32_e64 v52, 16, v44
    v_and_b32 v53, 0xffff0000, v44
    v_pk_add_f32 v[46:47], v[46:47], v[52:53]
    v_pk_fma_f32 v[50:51], v[52:53], v[52:53], v[50:51]
    v_lshlrev_b32_e64 v52, 16, v45
    v_and_b32 v53, 0xffff0000, v45
    v_pk_add_f32 v[46:47], v[46:47], v[52:53]
    v_pk_fma_f32 v[50:51], v[52:53], v[52:53], v[50:51]
    v_add_f32_e64 v51, v50, v51
    v_add_f32 v50, v46, v47
    s_nop 0
    v_add_f32_dpp v51, v51, v51 quad_perm:[1,0,3,2] row_mask:0xf bank_mask:0xf
    v_add_f32_dpp v50, v50, v50 quad_perm:[1,0,3,2] row_mask:0xf bank_mask:0xf
    s_nop 0
    v_add_f32_dpp v51, v51, v51 quad_perm:[2,3,0,1] row_mask:0xf bank_mask:0xf
    v_add_f32_dpp v50, v50, v50 quad_perm:[2,3,0,1] row_mask:0xf bank_mask:0xf
    s_nop 0
    v_add_f32_dpp v51, v51, v51 row_half_mirror row_mask:0xf bank_mask:0xf
    v_add_f32_dpp v50, v50, v50 row_half_mirror row_mask:0xf bank_mask:0xf
    s_nop 0
    v_add_f32_dpp v51, v51, v51 row_mirror row_mask:0xf bank_mask:0xf
    v_add_f32_dpp v50, v50, v50 row_mirror row_mask:0xf bank_mask:0xf
    s_nop 0
    v_add_f32_dpp v51, v51, v51 row_bcast:15 row_mask:0xa bank_mask:0xf
    v_add_f32_dpp v50, v50, v50 row_bcast:15 row_mask:0xa bank_mask:0xf
    v_mul_f32 v50, 0x3b124925, v50
    v_mul_f32 v51, 0x3b124925, v51
    v_fma_f32 v51, -v50, v50, v51
    v_max_f32_e64 v51, 0, v51
    v_cvt_pk_bf16_f32 v50, -v50, v51
    v_and_b32 v51, 0xffff0000, v50
    v_lshlrev_b32_e64 v50, 16, v50
    v_add_f32 v51, 0x3727c5ac, v51
    v_cvt_pk_bf16_f32 v51, v51, v51
    v_and_b32 v51, 0xffff0000, v51
    v_sqrt_f32 v51, v51
    s_nop 0
    v_cvt_pk_bf16_f32 v51, v51, v51
    v_and_b32 v51, 0xffff0000, v51
    v_rcp_f32 v51, v51
    s_nop 0
    v_cndmask_b32 v50, v50, v51, s[80:81]
    v_or_b32_e64 v50, 1, v50
    ds_write_b32 v48, v50
    s_waitcnt lgkmcnt(0)
    s_barrier
    v_and_b32 v42, 3, v0
    v_lshlrev_b32 v42, 4, v42
    v_add_u32 v42, 163712, v42
    ds_read_b128 v[38:41], v42
    s_lshl_b32 s61, s71, 6
    s_add_u32 s61, s61, 9511040
    s_cmp_eq_u32 s60, 0
    s_cselect_b32 s61, s61, 2147483632
    v_add_u32 v42, s61, v42
    v_cmp_gt_u32 vcc, 4, v0
    s_nop 1
    v_cndmask_b32 v42, v1, v42, vcc
    buffer_load_dword v43, off, s[52:55], 0 offset:0 sc1
    s_waitcnt vmcnt(0) lgkmcnt(0)
    v_cmp_eq_u32 vcc, 0, v43
    s_nop 4
    s_cbranch_vccnz Li_cert
Li_cert_r:
    buffer_store_dwordx4 v[38:41], v42, s[36:39], 0 offen sc1
    s_endpgm
La_cert:
    s_mov_b32 s71, 0
La_cert_l:
    s_sleep 4
    buffer_load_dword v27, off, s[52:55], 0 offset:0 sc1
    s_add_u32 s71, s71, 1
    s_waitcnt vmcnt(0)
    v_cmp_eq_u32 vcc, 0, v27
    s_nop 4
    s_cbranch_vccz La_cert_r
    s_cmp_lt_u32 s71, 0x40000
    s_cbranch_scc1 La_cert_l
    s_branch La_cert_r
La_par:
    s_mov_b32 s71, 0
La_par_l:
    s_sleep 4
    buffer_load_dword v46, v44, s[36:39], s62 offen sc1
    buffer_load_dword v27, off, s[52:55], 0 offset:128 sc1
    s_add_u32 s71, s71, 1
    s_waitcnt vmcnt(0)
    v_min_u32 v27, v46, v27
    v_cmp_eq_u32 vcc, 0, v27
    s_nop 4
    s_cbranch_vccz La_par_r
    s_cmp_lt_u32 s71, 0x40000
    s_cbranch_scc1 La_par_l
    s_branch La_par_r
Lf_cert:
    s_mov_b32 s71, 0
Lf_cert_l:
    s_sleep 4
    buffer_load_dword v43, off, s[52:55], 0 offset:0 sc1
    s_add_u32 s71, s71, 1
    s_waitcnt vmcnt(0)
    v_cmp_eq_u32_e64 vcc, 0, v43
    s_nop 4
    s_cbranch_vccz Lf_cert_r
    s_cmp_lt_u32 s71, 0x40000
    s_cbranch_scc1 Lf_cert_l
    s_branch Lf_cert_r
Lf_par:
    s_mov_b32 s71, 0
Lf_par_l:
    s_sleep 4
    buffer_load_dword v47, v44, s[36:39], s62 offen sc1
    buffer_load_dword v48, v45, s[36:39], s62 offen sc1
    buffer_load_dword v43, off, s[52:55], 0 offset:128 sc1
    s_add_u32 s71, s71, 1
    s_waitcnt vmcnt(0)
    v_min3_u32 v43, v47, v48, v43
    v_cmp_eq_u32_e64 vcc, 0, v43
    s_nop 4
    s_cbranch_vccz Lf_par_r
    s_cmp_lt_u32 s71, 0x40000
    s_cbranch_scc1 Lf_par_l
    s_branch Lf_par_r
Lf_p0:
    s_mov_b32 s71, 0
Lf_p0_l:
    s_load_dword s72, s[76:77], 0 glc
    s_add_u32 s71, s71, 1
    s_waitcnt lgkmcnt(0)
    s_cmp_eq_u32 s72, 14
    s_cbranch_scc1 Lf_p0_r
    s_sleep 3
    s_cmp_lt_u32 s71, 0x40000
    s_cbranch_scc1 Lf_p0_l
    s_branch Lf_p0_r
Lf_p1:
    s_mov_b32 s71, 0
Lf_p1_l:
    s_load_dword s79, s[76:77], 8192 glc
    s_add_u32 s71, s71, 1
    s_waitcnt lgkmcnt(0)
    s_cmp_eq_u32 s79, 14
    s_cbranch_scc1 Lf_p1_r
    s_sleep 3
    s_cmp_lt_u32 s71, 0x40000
    s_cbranch_scc1 Lf_p1_l
    s_branch Lf_p1_r
Lf_p2:
    s_mov_b32 s71, 0
Lf_p2_l:
    s_load_dword s72, s[76:77], 16384 glc
    s_add_u32 s71, s71, 1
    s_waitcnt lgkmcnt(0)
    s_cmp_eq_u32 s72, 14
    s_cbranch_scc1 Lf_p2_r
    s_sleep 3
    s_cmp_lt_u32 s71, 0x40000
    s_cbranch_scc1 Lf_p2_l
    s_branch Lf_p2_r
Lf_p3:
    s_mov_b32 s71, 0
Lf_p3_l:
    s_load_dword s79, s[76:77], 24576 glc
    s_add_u32 s71, s71, 1
    s_waitcnt lgkmcnt(0)
    s_cmp_eq_u32 s79, 14
    s_cbranch_scc1 Lf_p3_r
    s_sleep 3
    s_cmp_lt_u32 s71, 0x40000
    s_cbranch_scc1 Lf_p3_l
    s_branch Lf_p3_r
Lf_p4:
    s_mov_b32 s71, 0
Lf_p4_l:
    s_load_dword s72, s[76:77], 32768 glc
    s_add_u32 s71, s71, 1
    s_waitcnt lgkmcnt(0)
    s_cmp_eq_u32 s72, s78
    s_cbranch_scc1 Lf_p4_r
    s_sleep 3
    s_cmp_lt_u32 s71, 0x40000
    s_cbranch_scc1 Lf_p4_l
    s_branch Lf_p4_r
Li_cert:
    s_mov_b32 s71, 0
Li_cert_l:
    s_sleep 4
    buffer_load_dword v43, off, s[52:55], 0 offset:0 sc1
    s_add_u32 s71, s71, 1
    s_waitcnt vmcnt(0)
    v_cmp_eq_u32_e64 vcc, 0, v43
    s_nop 4
    s_cbranch_vccz Li_cert_r
    s_cmp_lt_u32 s71, 0x40000
    s_cbranch_scc1 Li_cert_l
    s_branch Li_cert_r
L_end:
.fill 3072, 4, 0xbf810000
.section .rodata,"a"
.p2align 6
.amdhsa_kernel parallel_sum__sliding_local_dilated__swiglu_ffn__prompt_kernel
  .amdhsa_next_free_vgpr 512
  .amdhsa_next_free_sgpr 102
  .amdhsa_accum_offset 256
  .amdhsa_group_segment_fixed_size 0
  .amdhsa_kernarg_size 80
  .amdhsa_user_sgpr_count 2
  .amdhsa_user_sgpr_kernarg_segment_ptr 1
  .amdhsa_system_sgpr_workgroup_id_x 1
  .amdhsa_float_denorm_mode_32 3
.end_amdhsa_kernel
```
